```python
import torch

def _softmax(x, axis=-1):
    return torch.softmax(x, dim=axis)
def _gelu(x):
    return torch.nn.functional.gelu(x, approximate="tanh")
def _silu(x):
    return torch.nn.functional.silu(x)
def _sigmoid(x):
    return torch.sigmoid(x)
def _layernorm(x, axis=-1, eps=1e-5):
    m = x.mean(dim=axis, keepdim=True)
    v = x.var(dim=axis, keepdim=True, unbiased=False)
    return (x - m) / torch.sqrt(v + eps)
def _scatter_add(tgt, idx, src, axis=0):
    return tgt.clone().index_add_(axis, idx, src)
def _segment_sum(src, seg, n):
    out = torch.zeros((n,) + src.shape[1:], dtype=src.dtype)
    return out.index_add_(0, seg, src)
def _pad(x, pw):
    flat = tuple(v for pair in reversed(pw) for v in pair)
    return torch.nn.functional.pad(x, flat)

kernel_name = 'gather_scatter__molecular_angular_gemnet__graph'

def setup_inputs():

    _w = (lambda a: (lambda t: t.to(torch.bfloat16) if t.is_floating_point() else t)(torch.as_tensor(a)))
    N, deg, De, L = 25000, 32, 4, 1
    E = N * deg
    T = E * deg
    NR = 8
    dist = torch.rand(E).to(float)
    angle = (torch.rand(T) * torch.pi).to(float)
    centers = torch.linspace(0.0, 1.0, NR).to(float)
    ang_freq = torch.arange(1, L + 1).to(float)
    return {
        "m": _w((lambda *s: torch.randn(*s, dtype=torch.bfloat16) * 0.05)(E, De)),
        "idx_in": _w((lambda lo, hi, *s: torch.randint(lo, hi, s))(0, E, T).to(torch.int64)),
        "idx_out": _w((lambda lo, hi, *s: torch.randint(lo, hi, s))(0, E, T).to(torch.int64)),
        "dist": _w(dist),
        "angle": _w(angle),
        "centers": _w(centers),
        "ang_freq": _w(ang_freq),
        "w_rbf": _w((lambda *s: torch.randn(*s, dtype=torch.bfloat16) * 0.2)(NR, De)),
        "w_sbf": _w((lambda *s: torch.randn(*s, dtype=torch.bfloat16) * 0.2)(NR * L, De)),
        "w_down": _w((lambda *s: torch.randn(*s, dtype=torch.bfloat16) * 0.2)(De, De)),
        "w_up": _w((lambda *s: torch.randn(*s, dtype=torch.bfloat16) * 0.2)(De, De)),
    }

def reference(m, idx_in, idx_out, dist, angle, centers, ang_freq, w_rbf, w_sbf, w_down, w_up):
    E, De = m.shape[0], m.shape[1]
    NR = centers.shape[0]
    L = ang_freq.shape[0]
    rbf = torch.exp(-10.0 * (dist[:, None] - centers[None, :]) ** 2)
    cbf = torch.cos(ang_freq[None, :] * angle[:, None])
    rbf_t = rbf[idx_out]
    sbf = torch.reshape(rbf_t[:, :, None] * cbf[:, None, :], (-1, NR * L))
    x = (m[idx_in] @ w_down) * (sbf @ w_sbf)
    agg = _segment_sum(x, idx_out, E)
    return m + (agg @ w_up) * (rbf @ w_rbf)
```

```asm
; @launch kernel=part_kernel grid=(256,1,1) block=(1024,1,1) lds=143360
; @launch kernel=gath_kernel grid=(256,1,1) block=(1024,1,1) lds=161280
; @launch kernel=acc_kernel grid=(256,1,1) block=(1024,1,1) lds=100368
.amdgcn_target "amdgcn-amd-amdhsa--gfx950"
.text
.globl part_kernel
.p2align 8
.type part_kernel,@function
part_kernel:
s_cmp_ge_u32 s2, 256
s_cbranch_scc1 k1_end
s_load_dwordx2 s[4:5], s[0:1], 8
s_load_dwordx2 s[6:7], s[0:1], 16
s_load_dwordx2 s[42:43], s[0:1], 32
s_load_dwordx2 s[44:45], s[0:1], 104
s_load_dwordx2 s[46:47], s[0:1], 0
s_load_dwordx2 s[48:49], s[0:1], 48
v_lshlrev_b32 v1, 4, v0
v_lshlrev_b32 v2, 3, v0
v_mov_b32 v4, 0
v_mov_b32 v5, 0
v_mov_b32 v6, 0
v_mov_b32 v7, 0
v_mov_b32 v127, 1
v_and_b32 v126, 63, v0
v_lshlrev_b32 v126, 4, v126
v_mov_b32 v108, 2147483648
v_cmp_gt_u32 vcc, 904, v0
s_nop 1
s_mov_b64 s[56:57], vcc
v_cndmask_b32 v124, v108, v1, vcc
v_cndmask_b32 v125, v108, v2, vcc
v_lshrrev_b32 v108, 6, v0
s_nop 0
v_readfirstlane_b32 s58, v108
s_waitcnt lgkmcnt(0)
s_load_dword s40, s[48:49], 0
s_mov_b32 s8, s4
s_and_b32 s9, s5, 0xffff
s_mov_b32 s10, 102400000
s_mov_b32 s11, 0x00020000
s_mov_b32 s12, s6
s_and_b32 s13, s7, 0xffff
s_mov_b32 s14, 102400000
s_mov_b32 s15, 0x00020000
s_mov_b32 s16, s42
s_and_b32 s17, s43, 0xffff
s_mov_b32 s18, 51200000
s_mov_b32 s19, 0x00020000
s_mov_b32 s32, s46
s_and_b32 s33, s47, 0xffff
s_mov_b32 s34, 6400000
s_mov_b32 s35, 0x00020000
s_add_u32 s28, s44, 398295040
s_addc_u32 s29, s45, 0
s_and_b32 s29, s29, 0xffff
s_mov_b32 s30, 1310720
s_mov_b32 s31, 0x00020000
s_add_u32 s36, s44, 401440768
s_addc_u32 s37, s45, 0
s_and_b32 s37, s37, 0xffff
s_mov_b32 s38, 1028
s_mov_b32 s39, 0x00020000
s_add_u32 s52, s44, 0
s_addc_u32 s53, s45, 0
s_mov_b32 s20, s52
s_and_b32 s21, s53, 0xffff
s_mov_b32 s22, 0
s_mov_b32 s23, 0x00020000
s_mul_i32 s59, s2, 400000
s_mul_i32 s60, s2, 5
s_add_u32 s50, s59, 0
s_lshr_b32 s51, s50, 1
buffer_load_dwordx4 v[8:11], v1, s[8:11], s50 offen nt
buffer_load_dwordx4 v[28:31], v1, s[12:15], s50 offen nt
buffer_load_dwordx2 v[48:49], v2, s[16:19], s51 offen nt
s_add_u32 s50, s59, 16384
s_lshr_b32 s51, s50, 1
buffer_load_dwordx4 v[12:15], v1, s[8:11], s50 offen nt
buffer_load_dwordx4 v[32:35], v1, s[12:15], s50 offen nt
buffer_load_dwordx2 v[50:51], v2, s[16:19], s51 offen nt
s_add_u32 s50, s59, 32768
s_lshr_b32 s51, s50, 1
buffer_load_dwordx4 v[16:19], v1, s[8:11], s50 offen nt
buffer_load_dwordx4 v[36:39], v1, s[12:15], s50 offen nt
buffer_load_dwordx2 v[52:53], v2, s[16:19], s51 offen nt
s_add_u32 s50, s59, 49152
s_lshr_b32 s51, s50, 1
buffer_load_dwordx4 v[20:23], v1, s[8:11], s50 offen nt
buffer_load_dwordx4 v[40:43], v1, s[12:15], s50 offen nt
buffer_load_dwordx2 v[54:55], v2, s[16:19], s51 offen nt
s_add_u32 s50, s59, 65536
s_lshr_b32 s51, s50, 1
buffer_load_dwordx4 v[24:27], v124, s[8:11], s50 offen nt
buffer_load_dwordx4 v[44:47], v124, s[12:15], s50 offen nt
buffer_load_dwordx2 v[56:57], v125, s[16:19], s51 offen nt
s_mul_i32 s50, s2, 25000
v_mov_b32 v116, 2147483648
v_cmp_gt_u32 vcc, 53, v0
s_nop 1
v_cndmask_b32 v116, v116, v2, vcc
s_add_u32 s51, s50, 0
buffer_load_dwordx2 v[108:109], v2, s[32:35], s51 offen
s_add_u32 s51, s50, 8192
buffer_load_dwordx2 v[110:111], v2, s[32:35], s51 offen
s_add_u32 s51, s50, 16384
buffer_load_dwordx2 v[112:113], v2, s[32:35], s51 offen
s_add_u32 s51, s50, 24576
buffer_load_dwordx2 v[114:115], v116, s[32:35], s51 offen
v_cmp_gt_u32 vcc, 256, v0
s_nop 1
s_and_saveexec_b64 s[62:63], vcc
ds_write_b128 v1, v[4:7]
s_mov_b64 exec, s[62:63]
s_waitcnt lgkmcnt(0)
s_lshl_b32 s40, s40, 16
v_mov_b32 v3, 0x3e22f983
v_mul_f32 v3, s40, v3
s_barrier
s_waitcnt vmcnt(0)
v_and_b32 v108, 0x7fff7fff, v108
v_and_b32 v109, 0x7fff7fff, v109
v_and_b32 v110, 0x7fff7fff, v110
v_and_b32 v111, 0x7fff7fff, v111
v_and_b32 v112, 0x7fff7fff, v112
v_and_b32 v113, 0x7fff7fff, v113
v_and_b32 v114, 0x7fff7fff, v114
v_and_b32 v115, 0x7fff7fff, v115
v_pk_max_u16 v108, v108, v109
v_pk_max_u16 v108, v108, v110
v_pk_max_u16 v108, v108, v111
v_pk_max_u16 v108, v108, v112
v_pk_max_u16 v108, v108, v113
v_pk_max_u16 v108, v108, v114
v_pk_max_u16 v108, v108, v115
v_lshrrev_b32 v109, 16, v108
v_and_b32 v108, 0xffff, v108
v_max_u32 v108, v108, v109
s_nop 1
v_max_u32_dpp v108, v108, v108 row_shr:1 row_mask:0xf bank_mask:0xf bound_ctrl:0
s_nop 1
v_max_u32_dpp v108, v108, v108 row_shr:2 row_mask:0xf bank_mask:0xf bound_ctrl:0
s_nop 1
v_max_u32_dpp v108, v108, v108 row_shr:4 row_mask:0xf bank_mask:0xf bound_ctrl:0
s_nop 1
v_max_u32_dpp v108, v108, v108 row_shr:8 row_mask:0xf bank_mask:0xf bound_ctrl:0
s_nop 1
v_max_u32_dpp v108, v108, v108 row_bcast:15 row_mask:0xa bank_mask:0xf
s_nop 1
v_max_u32_dpp v108, v108, v108 row_bcast:31 row_mask:0xc bank_mask:0xf
v_mov_b32 v109, 3072
s_mov_b64 s[62:63], exec
s_mov_b32 exec_lo, 0
s_mov_b32 exec_hi, 0x80000000
ds_max_u32 v109, v108
s_mov_b64 exec, s[62:63]
v_lshrrev_b32 v116, 8, v8
v_lshrrev_b32 v117, 2, v8
v_bfi_b32 v116, 15, v8, v116
v_lshl_or_b32 v8, v28, 12, v116
v_and_b32 v28, 0x3fc, v117
ds_add_rtn_u32 v108, v28, v127 offset:0
v_lshrrev_b32 v116, 8, v9
v_lshrrev_b32 v117, 2, v9
v_bfi_b32 v116, 15, v9, v116
v_lshl_or_b32 v9, v29, 12, v116
v_and_b32 v29, 0x3fc, v117
ds_add_rtn_u32 v109, v29, v127 offset:0
v_lshrrev_b32 v116, 8, v10
v_lshrrev_b32 v117, 2, v10
v_bfi_b32 v116, 15, v10, v116
v_lshl_or_b32 v10, v30, 12, v116
v_and_b32 v30, 0x3fc, v117
ds_add_rtn_u32 v110, v30, v127 offset:0
v_lshrrev_b32 v116, 8, v11
v_lshrrev_b32 v117, 2, v11
v_bfi_b32 v116, 15, v11, v116
v_lshl_or_b32 v11, v31, 12, v116
v_and_b32 v31, 0x3fc, v117
ds_add_rtn_u32 v111, v31, v127 offset:0
v_lshlrev_b32 v118, 16, v48
v_and_b32 v119, 0xffff0000, v48
v_mul_f32 v118, v3, v118
v_mul_f32 v119, v3, v119
v_fract_f32 v118, v118
v_fract_f32 v119, v119
v_cos_f32 v118, v118
v_cos_f32 v119, v119
s_nop 0
v_cvt_pk_f16_f32 v48, v118, v119
v_lshlrev_b32 v118, 16, v49
v_and_b32 v119, 0xffff0000, v49
v_mul_f32 v118, v3, v118
v_mul_f32 v119, v3, v119
v_fract_f32 v118, v118
v_fract_f32 v119, v119
v_cos_f32 v118, v118
v_cos_f32 v119, v119
s_nop 0
v_cvt_pk_f16_f32 v49, v118, v119
v_lshrrev_b32 v116, 8, v12
v_lshrrev_b32 v117, 2, v12
v_bfi_b32 v116, 15, v12, v116
v_lshl_or_b32 v12, v32, 12, v116
v_and_b32 v32, 0x3fc, v117
ds_add_rtn_u32 v112, v32, v127 offset:0
v_lshrrev_b32 v116, 8, v13
v_lshrrev_b32 v117, 2, v13
v_bfi_b32 v116, 15, v13, v116
v_lshl_or_b32 v13, v33, 12, v116
v_and_b32 v33, 0x3fc, v117
ds_add_rtn_u32 v113, v33, v127 offset:0
v_lshrrev_b32 v116, 8, v14
v_lshrrev_b32 v117, 2, v14
v_bfi_b32 v116, 15, v14, v116
v_lshl_or_b32 v14, v34, 12, v116
v_and_b32 v34, 0x3fc, v117
ds_add_rtn_u32 v114, v34, v127 offset:0
v_lshrrev_b32 v116, 8, v15
v_lshrrev_b32 v117, 2, v15
v_bfi_b32 v116, 15, v15, v116
v_lshl_or_b32 v15, v35, 12, v116
v_and_b32 v35, 0x3fc, v117
ds_add_rtn_u32 v115, v35, v127 offset:0
v_lshlrev_b32 v118, 16, v50
v_and_b32 v119, 0xffff0000, v50
v_mul_f32 v118, v3, v118
v_mul_f32 v119, v3, v119
v_fract_f32 v118, v118
v_fract_f32 v119, v119
v_cos_f32 v118, v118
v_cos_f32 v119, v119
s_nop 0
v_cvt_pk_f16_f32 v50, v118, v119
v_lshlrev_b32 v118, 16, v51
v_and_b32 v119, 0xffff0000, v51
v_mul_f32 v118, v3, v118
v_mul_f32 v119, v3, v119
v_fract_f32 v118, v118
v_fract_f32 v119, v119
v_cos_f32 v118, v118
v_cos_f32 v119, v119
s_nop 0
v_cvt_pk_f16_f32 v51, v118, v119
s_waitcnt lgkmcnt(4)
v_lshl_or_b32 v28, v108, 10, v28
v_lshl_or_b32 v29, v109, 10, v29
v_lshl_or_b32 v30, v110, 10, v30
v_lshl_or_b32 v31, v111, 10, v31
v_lshrrev_b32 v116, 8, v16
v_lshrrev_b32 v117, 2, v16
v_bfi_b32 v116, 15, v16, v116
v_lshl_or_b32 v16, v36, 12, v116
v_and_b32 v36, 0x3fc, v117
ds_add_rtn_u32 v108, v36, v127 offset:0
v_lshrrev_b32 v116, 8, v17
v_lshrrev_b32 v117, 2, v17
v_bfi_b32 v116, 15, v17, v116
v_lshl_or_b32 v17, v37, 12, v116
v_and_b32 v37, 0x3fc, v117
ds_add_rtn_u32 v109, v37, v127 offset:0
v_lshrrev_b32 v116, 8, v18
v_lshrrev_b32 v117, 2, v18
v_bfi_b32 v116, 15, v18, v116
v_lshl_or_b32 v18, v38, 12, v116
v_and_b32 v38, 0x3fc, v117
ds_add_rtn_u32 v110, v38, v127 offset:0
v_lshrrev_b32 v116, 8, v19
v_lshrrev_b32 v117, 2, v19
v_bfi_b32 v116, 15, v19, v116
v_lshl_or_b32 v19, v39, 12, v116
v_and_b32 v39, 0x3fc, v117
ds_add_rtn_u32 v111, v39, v127 offset:0
v_lshlrev_b32 v118, 16, v52
v_and_b32 v119, 0xffff0000, v52
v_mul_f32 v118, v3, v118
v_mul_f32 v119, v3, v119
v_fract_f32 v118, v118
v_fract_f32 v119, v119
v_cos_f32 v118, v118
v_cos_f32 v119, v119
s_nop 0
v_cvt_pk_f16_f32 v52, v118, v119
v_lshlrev_b32 v118, 16, v53
v_and_b32 v119, 0xffff0000, v53
v_mul_f32 v118, v3, v118
v_mul_f32 v119, v3, v119
v_fract_f32 v118, v118
v_fract_f32 v119, v119
v_cos_f32 v118, v118
v_cos_f32 v119, v119
s_nop 0
v_cvt_pk_f16_f32 v53, v118, v119
s_waitcnt lgkmcnt(4)
v_lshl_or_b32 v32, v112, 10, v32
v_lshl_or_b32 v33, v113, 10, v33
v_lshl_or_b32 v34, v114, 10, v34
v_lshl_or_b32 v35, v115, 10, v35
v_lshrrev_b32 v116, 8, v20
v_lshrrev_b32 v117, 2, v20
v_bfi_b32 v116, 15, v20, v116
v_lshl_or_b32 v20, v40, 12, v116
v_and_b32 v40, 0x3fc, v117
ds_add_rtn_u32 v112, v40, v127 offset:0
v_lshrrev_b32 v116, 8, v21
v_lshrrev_b32 v117, 2, v21
v_bfi_b32 v116, 15, v21, v116
v_lshl_or_b32 v21, v41, 12, v116
v_and_b32 v41, 0x3fc, v117
ds_add_rtn_u32 v113, v41, v127 offset:0
v_lshrrev_b32 v116, 8, v22
v_lshrrev_b32 v117, 2, v22
v_bfi_b32 v116, 15, v22, v116
v_lshl_or_b32 v22, v42, 12, v116
v_and_b32 v42, 0x3fc, v117
ds_add_rtn_u32 v114, v42, v127 offset:0
v_lshrrev_b32 v116, 8, v23
v_lshrrev_b32 v117, 2, v23
v_bfi_b32 v116, 15, v23, v116
v_lshl_or_b32 v23, v43, 12, v116
v_and_b32 v43, 0x3fc, v117
ds_add_rtn_u32 v115, v43, v127 offset:0
v_lshlrev_b32 v118, 16, v54
v_and_b32 v119, 0xffff0000, v54
v_mul_f32 v118, v3, v118
v_mul_f32 v119, v3, v119
v_fract_f32 v118, v118
v_fract_f32 v119, v119
v_cos_f32 v118, v118
v_cos_f32 v119, v119
s_nop 0
v_cvt_pk_f16_f32 v54, v118, v119
v_lshlrev_b32 v118, 16, v55
v_and_b32 v119, 0xffff0000, v55
v_mul_f32 v118, v3, v118
v_mul_f32 v119, v3, v119
v_fract_f32 v118, v118
v_fract_f32 v119, v119
v_cos_f32 v118, v118
v_cos_f32 v119, v119
s_nop 0
v_cvt_pk_f16_f32 v55, v118, v119
s_waitcnt lgkmcnt(4)
v_lshl_or_b32 v36, v108, 10, v36
v_lshl_or_b32 v37, v109, 10, v37
v_lshl_or_b32 v38, v110, 10, v38
v_lshl_or_b32 v39, v111, 10, v39
s_waitcnt lgkmcnt(0)
v_lshl_or_b32 v40, v112, 10, v40
v_lshl_or_b32 v41, v113, 10, v41
v_lshl_or_b32 v42, v114, 10, v42
v_lshl_or_b32 v43, v115, 10, v43
s_mov_b64 exec, s[56:57]
v_lshrrev_b32 v116, 8, v24
v_lshrrev_b32 v117, 2, v24
v_bfi_b32 v116, 15, v24, v116
v_lshl_or_b32 v24, v44, 12, v116
v_and_b32 v44, 0x3fc, v117
ds_add_rtn_u32 v108, v44, v127 offset:0
v_lshrrev_b32 v116, 8, v25
v_lshrrev_b32 v117, 2, v25
v_bfi_b32 v116, 15, v25, v116
v_lshl_or_b32 v25, v45, 12, v116
v_and_b32 v45, 0x3fc, v117
ds_add_rtn_u32 v109, v45, v127 offset:0
v_lshrrev_b32 v116, 8, v26
v_lshrrev_b32 v117, 2, v26
v_bfi_b32 v116, 15, v26, v116
v_lshl_or_b32 v26, v46, 12, v116
v_and_b32 v46, 0x3fc, v117
ds_add_rtn_u32 v110, v46, v127 offset:0
v_lshrrev_b32 v116, 8, v27
v_lshrrev_b32 v117, 2, v27
v_bfi_b32 v116, 15, v27, v116
v_lshl_or_b32 v27, v47, 12, v116
v_and_b32 v47, 0x3fc, v117
ds_add_rtn_u32 v111, v47, v127 offset:0
v_lshlrev_b32 v118, 16, v56
v_and_b32 v119, 0xffff0000, v56
v_mul_f32 v118, v3, v118
v_mul_f32 v119, v3, v119
v_fract_f32 v118, v118
v_fract_f32 v119, v119
v_cos_f32 v118, v118
v_cos_f32 v119, v119
s_nop 0
v_cvt_pk_f16_f32 v56, v118, v119
v_lshlrev_b32 v118, 16, v57
v_and_b32 v119, 0xffff0000, v57
v_mul_f32 v118, v3, v118
v_mul_f32 v119, v3, v119
v_fract_f32 v118, v118
v_fract_f32 v119, v119
v_cos_f32 v118, v118
v_cos_f32 v119, v119
s_nop 0
v_cvt_pk_f16_f32 v57, v118, v119
s_waitcnt lgkmcnt(0)
v_lshl_or_b32 v44, v108, 10, v44
v_lshl_or_b32 v45, v109, 10, v45
v_lshl_or_b32 v46, v110, 10, v46
v_lshl_or_b32 v47, v111, 10, v47
s_mov_b64 exec, -1
s_barrier
s_add_u32 s50, s59, 80000
s_lshr_b32 s51, s50, 1
buffer_load_dwordx4 v[58:61], v1, s[8:11], s50 offen nt
buffer_load_dwordx4 v[78:81], v1, s[12:15], s50 offen nt
buffer_load_dwordx2 v[98:99], v2, s[16:19], s51 offen nt
s_add_u32 s50, s59, 96384
s_lshr_b32 s51, s50, 1
buffer_load_dwordx4 v[62:65], v1, s[8:11], s50 offen nt
buffer_load_dwordx4 v[82:85], v1, s[12:15], s50 offen nt
buffer_load_dwordx2 v[100:101], v2, s[16:19], s51 offen nt
s_add_u32 s50, s59, 112768
s_lshr_b32 s51, s50, 1
buffer_load_dwordx4 v[66:69], v1, s[8:11], s50 offen nt
buffer_load_dwordx4 v[86:89], v1, s[12:15], s50 offen nt
buffer_load_dwordx2 v[102:103], v2, s[16:19], s51 offen nt
s_add_u32 s50, s59, 129152
s_lshr_b32 s51, s50, 1
buffer_load_dwordx4 v[70:73], v1, s[8:11], s50 offen nt
buffer_load_dwordx4 v[90:93], v1, s[12:15], s50 offen nt
buffer_load_dwordx2 v[104:105], v2, s[16:19], s51 offen nt
s_add_u32 s50, s59, 145536
s_lshr_b32 s51, s50, 1
buffer_load_dwordx4 v[74:77], v124, s[8:11], s50 offen nt
buffer_load_dwordx4 v[94:97], v124, s[12:15], s50 offen nt
buffer_load_dwordx2 v[106:107], v125, s[16:19], s51 offen nt
ds_read_b128 v[108:111], v126 offset:0
s_waitcnt lgkmcnt(0)
v_add_u32 v112, 3, v108
v_lshrrev_b32 v112, 2, v112
v_add_u32 v113, 3, v109
v_lshrrev_b32 v113, 2, v113
v_add_u32 v114, 3, v110
v_lshrrev_b32 v114, 2, v114
v_add_u32 v115, 3, v111
v_lshrrev_b32 v115, 2, v115
v_add_u32 v118, v112, v113
v_add_u32 v119, v118, v114
v_add_u32 v120, v119, v115
v_mov_b32 v121, v120
s_nop 1
v_add_u32_dpp v121, v121, v121 row_shr:1 row_mask:0xf bank_mask:0xf bound_ctrl:0
s_nop 1
v_add_u32_dpp v121, v121, v121 row_shr:2 row_mask:0xf bank_mask:0xf bound_ctrl:0
s_nop 1
v_add_u32_dpp v121, v121, v121 row_shr:4 row_mask:0xf bank_mask:0xf bound_ctrl:0
s_nop 1
v_add_u32_dpp v121, v121, v121 row_shr:8 row_mask:0xf bank_mask:0xf bound_ctrl:0
s_nop 1
v_add_u32_dpp v121, v121, v121 row_bcast:15 row_mask:0xa bank_mask:0xf
s_nop 1
v_add_u32_dpp v121, v121, v121 row_bcast:31 row_mask:0xc bank_mask:0xf
v_sub_u32 v116, v121, v120
v_add_u32 v117, v116, v112
v_add_u32 v118, v116, v118
v_add_u32 v119, v116, v119
v_readlane_b32 s61, v121, 63
v_lshl_or_b32 v112, v112, 16, v116
v_lshl_or_b32 v113, v113, 16, v117
v_lshl_or_b32 v114, v114, 16, v118
v_lshl_or_b32 v115, v115, 16, v119
v_mul_u32_u24 v116, 24, v116
v_mul_u32_u24 v117, 24, v117
v_mul_u32_u24 v118, 24, v118
v_mul_u32_u24 v119, 24, v119
ds_write_b128 v126, v[116:119] offset:2048
ds_write_b128 v126, v[4:7] offset:1024
s_cmp_lg_u32 s58, 0
s_cbranch_scc1 k1w0_1
s_add_u32 s50, s60, 0
s_lshl_b32 s50, s50, 10
buffer_store_dwordx4 v[112:115], v126, s[28:31], s50 offen
v_mov_b32 v108, 3072
ds_read_b32 v109, v108
s_lshl_b32 s50, s2, 2
v_mov_b32 v108, 0
s_waitcnt lgkmcnt(0)
s_mov_b64 s[62:63], exec
s_mov_b64 exec, 1
buffer_store_dword v109, v108, s[36:39], s50 offen
buffer_store_dword v108, v108, s[36:39], 0 offen offset:1024
s_mov_b64 exec, s[62:63]
k1w0_1:
s_cmp_lg_u32 s58, 1
s_cbranch_scc1 k1w1_2
v_lshrrev_b32 v120, 2, v108
v_mad_u32_u24 v120, v120, 24, v116
v_and_b32 v121, 3, v108
v_add_u32 v121, -1, v121
v_cmp_gt_u32 vcc, 1, v121
v_mov_b32 v123, 196608
s_nop 0
v_cndmask_b32 v123, v123, v120, vcc
ds_write_b16 v123, v4 offset:3106
v_cmp_gt_u32 vcc, 2, v121
v_mov_b32 v123, 196608
s_nop 0
v_cndmask_b32 v123, v123, v120, vcc
ds_write_b16 v123, v4 offset:3108
v_cmp_gt_u32 vcc, 3, v121
v_mov_b32 v123, 196608
s_nop 0
v_cndmask_b32 v123, v123, v120, vcc
ds_write_b16 v123, v4 offset:3110
v_lshrrev_b32 v120, 2, v109
v_mad_u32_u24 v120, v120, 24, v117
v_and_b32 v121, 3, v109
v_add_u32 v121, -1, v121
v_cmp_gt_u32 vcc, 1, v121
v_mov_b32 v123, 196608
s_nop 0
v_cndmask_b32 v123, v123, v120, vcc
ds_write_b16 v123, v4 offset:3106
v_cmp_gt_u32 vcc, 2, v121
v_mov_b32 v123, 196608
s_nop 0
v_cndmask_b32 v123, v123, v120, vcc
ds_write_b16 v123, v4 offset:3108
v_cmp_gt_u32 vcc, 3, v121
v_mov_b32 v123, 196608
s_nop 0
v_cndmask_b32 v123, v123, v120, vcc
ds_write_b16 v123, v4 offset:3110
v_lshrrev_b32 v120, 2, v110
v_mad_u32_u24 v120, v120, 24, v118
v_and_b32 v121, 3, v110
v_add_u32 v121, -1, v121
v_cmp_gt_u32 vcc, 1, v121
v_mov_b32 v123, 196608
s_nop 0
v_cndmask_b32 v123, v123, v120, vcc
ds_write_b16 v123, v4 offset:3106
v_cmp_gt_u32 vcc, 2, v121
v_mov_b32 v123, 196608
s_nop 0
v_cndmask_b32 v123, v123, v120, vcc
ds_write_b16 v123, v4 offset:3108
v_cmp_gt_u32 vcc, 3, v121
v_mov_b32 v123, 196608
s_nop 0
v_cndmask_b32 v123, v123, v120, vcc
ds_write_b16 v123, v4 offset:3110
v_lshrrev_b32 v120, 2, v111
v_mad_u32_u24 v120, v120, 24, v119
v_and_b32 v121, 3, v111
v_add_u32 v121, -1, v121
v_cmp_gt_u32 vcc, 1, v121
v_mov_b32 v123, 196608
s_nop 0
v_cndmask_b32 v123, v123, v120, vcc
ds_write_b16 v123, v4 offset:3106
v_cmp_gt_u32 vcc, 2, v121
v_mov_b32 v123, 196608
s_nop 0
v_cndmask_b32 v123, v123, v120, vcc
ds_write_b16 v123, v4 offset:3108
v_cmp_gt_u32 vcc, 3, v121
v_mov_b32 v123, 196608
s_nop 0
v_cndmask_b32 v123, v123, v120, vcc
ds_write_b16 v123, v4 offset:3110
k1w1_2:
s_add_u32 s50, s60, 0
s_mul_i32 s51, s50, 124800
s_add_u32 s20, s52, s51
s_addc_u32 s21, s53, 0
s_and_b32 s21, s21, 0xffff
s_mul_i32 s22, s61, 24
s_add_u32 s22, s22, 127
s_and_b32 s22, s22, 0xffffff80
s_waitcnt lgkmcnt(0)
v_and_b32 v108, 0x3ff, v28
ds_read_b32 v108, v108 offset:2048
v_and_b32 v109, 0x3ff, v29
ds_read_b32 v109, v109 offset:2048
v_and_b32 v110, 0x3ff, v30
ds_read_b32 v110, v110 offset:2048
v_and_b32 v111, 0x3ff, v31
ds_read_b32 v111, v111 offset:2048
v_and_b32 v112, 0x3ff, v32
ds_read_b32 v112, v112 offset:2048
v_and_b32 v113, 0x3ff, v33
ds_read_b32 v113, v113 offset:2048
v_and_b32 v114, 0x3ff, v34
ds_read_b32 v114, v114 offset:2048
v_and_b32 v115, 0x3ff, v35
ds_read_b32 v115, v115 offset:2048
s_waitcnt lgkmcnt(0)
v_lshrrev_b32 v28, 10, v28
v_mad_u32_u24 v108, v28, 6, v108
v_and_b32 v116, 3, v28
v_mad_i32_i24 v117, v116, -2, v108
v_mad_i32_i24 v108, v116, -4, v108
ds_write_b32 v117, v8 offset:3088
ds_write_b16 v108, v48 offset:3104
v_lshrrev_b32 v29, 10, v29
v_mad_u32_u24 v109, v29, 6, v109
v_and_b32 v116, 3, v29
v_mad_i32_i24 v117, v116, -2, v109
v_mad_i32_i24 v109, v116, -4, v109
ds_write_b32 v117, v9 offset:3088
ds_write_b16_d16_hi v109, v48 offset:3104
v_lshrrev_b32 v30, 10, v30
v_mad_u32_u24 v110, v30, 6, v110
v_and_b32 v116, 3, v30
v_mad_i32_i24 v117, v116, -2, v110
v_mad_i32_i24 v110, v116, -4, v110
ds_write_b32 v117, v10 offset:3088
ds_write_b16 v110, v49 offset:3104
v_lshrrev_b32 v31, 10, v31
v_mad_u32_u24 v111, v31, 6, v111
v_and_b32 v116, 3, v31
v_mad_i32_i24 v117, v116, -2, v111
v_mad_i32_i24 v111, v116, -4, v111
ds_write_b32 v117, v11 offset:3088
ds_write_b16_d16_hi v111, v49 offset:3104
v_lshrrev_b32 v32, 10, v32
v_mad_u32_u24 v112, v32, 6, v112
v_and_b32 v116, 3, v32
v_mad_i32_i24 v117, v116, -2, v112
v_mad_i32_i24 v112, v116, -4, v112
ds_write_b32 v117, v12 offset:3088
ds_write_b16 v112, v50 offset:3104
v_lshrrev_b32 v33, 10, v33
v_mad_u32_u24 v113, v33, 6, v113
v_and_b32 v116, 3, v33
v_mad_i32_i24 v117, v116, -2, v113
v_mad_i32_i24 v113, v116, -4, v113
ds_write_b32 v117, v13 offset:3088
ds_write_b16_d16_hi v113, v50 offset:3104
v_lshrrev_b32 v34, 10, v34
v_mad_u32_u24 v114, v34, 6, v114
v_and_b32 v116, 3, v34
v_mad_i32_i24 v117, v116, -2, v114
v_mad_i32_i24 v114, v116, -4, v114
ds_write_b32 v117, v14 offset:3088
ds_write_b16 v114, v51 offset:3104
v_lshrrev_b32 v35, 10, v35
v_mad_u32_u24 v115, v35, 6, v115
v_and_b32 v116, 3, v35
v_mad_i32_i24 v117, v116, -2, v115
v_mad_i32_i24 v115, v116, -4, v115
ds_write_b32 v117, v15 offset:3088
ds_write_b16_d16_hi v115, v51 offset:3104
v_and_b32 v108, 0x3ff, v36
ds_read_b32 v108, v108 offset:2048
v_and_b32 v109, 0x3ff, v37
ds_read_b32 v109, v109 offset:2048
v_and_b32 v110, 0x3ff, v38
ds_read_b32 v110, v110 offset:2048
v_and_b32 v111, 0x3ff, v39
ds_read_b32 v111, v111 offset:2048
v_and_b32 v112, 0x3ff, v40
ds_read_b32 v112, v112 offset:2048
v_and_b32 v113, 0x3ff, v41
ds_read_b32 v113, v113 offset:2048
v_and_b32 v114, 0x3ff, v42
ds_read_b32 v114, v114 offset:2048
v_and_b32 v115, 0x3ff, v43
ds_read_b32 v115, v115 offset:2048
s_waitcnt lgkmcnt(0)
v_lshrrev_b32 v36, 10, v36
v_mad_u32_u24 v108, v36, 6, v108
v_and_b32 v116, 3, v36
v_mad_i32_i24 v117, v116, -2, v108
v_mad_i32_i24 v108, v116, -4, v108
ds_write_b32 v117, v16 offset:3088
ds_write_b16 v108, v52 offset:3104
v_lshrrev_b32 v37, 10, v37
v_mad_u32_u24 v109, v37, 6, v109
v_and_b32 v116, 3, v37
v_mad_i32_i24 v117, v116, -2, v109
v_mad_i32_i24 v109, v116, -4, v109
ds_write_b32 v117, v17 offset:3088
ds_write_b16_d16_hi v109, v52 offset:3104
v_lshrrev_b32 v38, 10, v38
v_mad_u32_u24 v110, v38, 6, v110
v_and_b32 v116, 3, v38
v_mad_i32_i24 v117, v116, -2, v110
v_mad_i32_i24 v110, v116, -4, v110
ds_write_b32 v117, v18 offset:3088
ds_write_b16 v110, v53 offset:3104
v_lshrrev_b32 v39, 10, v39
v_mad_u32_u24 v111, v39, 6, v111
v_and_b32 v116, 3, v39
v_mad_i32_i24 v117, v116, -2, v111
v_mad_i32_i24 v111, v116, -4, v111
ds_write_b32 v117, v19 offset:3088
ds_write_b16_d16_hi v111, v53 offset:3104
v_lshrrev_b32 v40, 10, v40
v_mad_u32_u24 v112, v40, 6, v112
v_and_b32 v116, 3, v40
v_mad_i32_i24 v117, v116, -2, v112
v_mad_i32_i24 v112, v116, -4, v112
ds_write_b32 v117, v20 offset:3088
ds_write_b16 v112, v54 offset:3104
v_lshrrev_b32 v41, 10, v41
v_mad_u32_u24 v113, v41, 6, v113
v_and_b32 v116, 3, v41
v_mad_i32_i24 v117, v116, -2, v113
v_mad_i32_i24 v113, v116, -4, v113
ds_write_b32 v117, v21 offset:3088
ds_write_b16_d16_hi v113, v54 offset:3104
v_lshrrev_b32 v42, 10, v42
v_mad_u32_u24 v114, v42, 6, v114
v_and_b32 v116, 3, v42
v_mad_i32_i24 v117, v116, -2, v114
v_mad_i32_i24 v114, v116, -4, v114
ds_write_b32 v117, v22 offset:3088
ds_write_b16 v114, v55 offset:3104
v_lshrrev_b32 v43, 10, v43
v_mad_u32_u24 v115, v43, 6, v115
v_and_b32 v116, 3, v43
v_mad_i32_i24 v117, v116, -2, v115
v_mad_i32_i24 v115, v116, -4, v115
ds_write_b32 v117, v23 offset:3088
ds_write_b16_d16_hi v115, v55 offset:3104
s_mov_b64 exec, s[56:57]
v_and_b32 v108, 0x3ff, v44
ds_read_b32 v108, v108 offset:2048
v_and_b32 v109, 0x3ff, v45
ds_read_b32 v109, v109 offset:2048
v_and_b32 v110, 0x3ff, v46
ds_read_b32 v110, v110 offset:2048
v_and_b32 v111, 0x3ff, v47
ds_read_b32 v111, v111 offset:2048
s_waitcnt lgkmcnt(0)
v_lshrrev_b32 v44, 10, v44
v_mad_u32_u24 v108, v44, 6, v108
v_and_b32 v116, 3, v44
v_mad_i32_i24 v117, v116, -2, v108
v_mad_i32_i24 v108, v116, -4, v108
ds_write_b32 v117, v24 offset:3088
ds_write_b16 v108, v56 offset:3104
v_lshrrev_b32 v45, 10, v45
v_mad_u32_u24 v109, v45, 6, v109
v_and_b32 v116, 3, v45
v_mad_i32_i24 v117, v116, -2, v109
v_mad_i32_i24 v109, v116, -4, v109
ds_write_b32 v117, v25 offset:3088
ds_write_b16_d16_hi v109, v56 offset:3104
v_lshrrev_b32 v46, 10, v46
v_mad_u32_u24 v110, v46, 6, v110
v_and_b32 v116, 3, v46
v_mad_i32_i24 v117, v116, -2, v110
v_mad_i32_i24 v110, v116, -4, v110
ds_write_b32 v117, v26 offset:3088
ds_write_b16 v110, v57 offset:3104
v_lshrrev_b32 v47, 10, v47
v_mad_u32_u24 v111, v47, 6, v111
v_and_b32 v116, 3, v47
v_mad_i32_i24 v117, v116, -2, v111
v_mad_i32_i24 v111, v116, -4, v111
ds_write_b32 v117, v27 offset:3088
ds_write_b16_d16_hi v111, v57 offset:3104
s_mov_b64 exec, -1
s_waitcnt lgkmcnt(0)
s_barrier
v_add_u32 v108, 0, v1
ds_read_b128 v[8:11], v108 offset:3088
v_add_u32 v109, 16384, v1
ds_read_b128 v[12:15], v109 offset:3088
v_add_u32 v110, 32768, v1
ds_read_b128 v[16:19], v110 offset:3088
v_add_u32 v111, 49152, v1
ds_read_b128 v[20:23], v111 offset:3088
v_add_u32 v112, 65536, v1
ds_read_b128 v[24:27], v112 offset:3088
v_add_u32 v113, 81920, v1
ds_read_b128 v[28:31], v113 offset:3088
v_add_u32 v114, 98304, v1
ds_read_b128 v[32:35], v114 offset:3088
v_add_u32 v115, 114688, v1
ds_read_b128 v[36:39], v115 offset:3088
s_waitcnt lgkmcnt(7)
buffer_store_dwordx4 v[8:11], v108, s[20:23], 0 offen sc1
s_waitcnt lgkmcnt(6)
buffer_store_dwordx4 v[12:15], v109, s[20:23], 0 offen sc1
s_waitcnt lgkmcnt(5)
buffer_store_dwordx4 v[16:19], v110, s[20:23], 0 offen sc1
s_waitcnt lgkmcnt(4)
buffer_store_dwordx4 v[20:23], v111, s[20:23], 0 offen sc1
s_waitcnt lgkmcnt(3)
buffer_store_dwordx4 v[24:27], v112, s[20:23], 0 offen sc1
s_waitcnt lgkmcnt(2)
buffer_store_dwordx4 v[28:31], v113, s[20:23], 0 offen sc1
s_waitcnt lgkmcnt(1)
buffer_store_dwordx4 v[32:35], v114, s[20:23], 0 offen sc1
s_waitcnt lgkmcnt(0)
buffer_store_dwordx4 v[36:39], v115, s[20:23], 0 offen sc1
s_waitcnt vmcnt(8)
v_lshrrev_b32 v116, 8, v58
v_lshrrev_b32 v117, 2, v58
v_bfi_b32 v116, 15, v58, v116
v_lshl_or_b32 v58, v78, 12, v116
v_and_b32 v78, 0x3fc, v117
ds_add_rtn_u32 v108, v78, v127 offset:1024
v_lshrrev_b32 v116, 8, v59
v_lshrrev_b32 v117, 2, v59
v_bfi_b32 v116, 15, v59, v116
v_lshl_or_b32 v59, v79, 12, v116
v_and_b32 v79, 0x3fc, v117
ds_add_rtn_u32 v109, v79, v127 offset:1024
v_lshrrev_b32 v116, 8, v60
v_lshrrev_b32 v117, 2, v60
v_bfi_b32 v116, 15, v60, v116
v_lshl_or_b32 v60, v80, 12, v116
v_and_b32 v80, 0x3fc, v117
ds_add_rtn_u32 v110, v80, v127 offset:1024
v_lshrrev_b32 v116, 8, v61
v_lshrrev_b32 v117, 2, v61
v_bfi_b32 v116, 15, v61, v116
v_lshl_or_b32 v61, v81, 12, v116
v_and_b32 v81, 0x3fc, v117
ds_add_rtn_u32 v111, v81, v127 offset:1024
v_lshlrev_b32 v118, 16, v98
v_and_b32 v119, 0xffff0000, v98
v_mul_f32 v118, v3, v118
v_mul_f32 v119, v3, v119
v_fract_f32 v118, v118
v_fract_f32 v119, v119
v_cos_f32 v118, v118
v_cos_f32 v119, v119
s_nop 0
v_cvt_pk_f16_f32 v98, v118, v119
v_lshlrev_b32 v118, 16, v99
v_and_b32 v119, 0xffff0000, v99
v_mul_f32 v118, v3, v118
v_mul_f32 v119, v3, v119
v_fract_f32 v118, v118
v_fract_f32 v119, v119
v_cos_f32 v118, v118
v_cos_f32 v119, v119
s_nop 0
v_cvt_pk_f16_f32 v99, v118, v119
v_lshrrev_b32 v116, 8, v62
v_lshrrev_b32 v117, 2, v62
v_bfi_b32 v116, 15, v62, v116
v_lshl_or_b32 v62, v82, 12, v116
v_and_b32 v82, 0x3fc, v117
ds_add_rtn_u32 v112, v82, v127 offset:1024
v_lshrrev_b32 v116, 8, v63
v_lshrrev_b32 v117, 2, v63
v_bfi_b32 v116, 15, v63, v116
v_lshl_or_b32 v63, v83, 12, v116
v_and_b32 v83, 0x3fc, v117
ds_add_rtn_u32 v113, v83, v127 offset:1024
v_lshrrev_b32 v116, 8, v64
v_lshrrev_b32 v117, 2, v64
v_bfi_b32 v116, 15, v64, v116
v_lshl_or_b32 v64, v84, 12, v116
v_and_b32 v84, 0x3fc, v117
ds_add_rtn_u32 v114, v84, v127 offset:1024
v_lshrrev_b32 v116, 8, v65
v_lshrrev_b32 v117, 2, v65
v_bfi_b32 v116, 15, v65, v116
v_lshl_or_b32 v65, v85, 12, v116
v_and_b32 v85, 0x3fc, v117
ds_add_rtn_u32 v115, v85, v127 offset:1024
v_lshlrev_b32 v118, 16, v100
v_and_b32 v119, 0xffff0000, v100
v_mul_f32 v118, v3, v118
v_mul_f32 v119, v3, v119
v_fract_f32 v118, v118
v_fract_f32 v119, v119
v_cos_f32 v118, v118
v_cos_f32 v119, v119
s_nop 0
v_cvt_pk_f16_f32 v100, v118, v119
v_lshlrev_b32 v118, 16, v101
v_and_b32 v119, 0xffff0000, v101
v_mul_f32 v118, v3, v118
v_mul_f32 v119, v3, v119
v_fract_f32 v118, v118
v_fract_f32 v119, v119
v_cos_f32 v118, v118
v_cos_f32 v119, v119
s_nop 0
v_cvt_pk_f16_f32 v101, v118, v119
s_waitcnt lgkmcnt(4)
v_lshl_or_b32 v78, v108, 10, v78
v_lshl_or_b32 v79, v109, 10, v79
v_lshl_or_b32 v80, v110, 10, v80
v_lshl_or_b32 v81, v111, 10, v81
v_lshrrev_b32 v116, 8, v66
v_lshrrev_b32 v117, 2, v66
v_bfi_b32 v116, 15, v66, v116
v_lshl_or_b32 v66, v86, 12, v116
v_and_b32 v86, 0x3fc, v117
ds_add_rtn_u32 v108, v86, v127 offset:1024
v_lshrrev_b32 v116, 8, v67
v_lshrrev_b32 v117, 2, v67
v_bfi_b32 v116, 15, v67, v116
v_lshl_or_b32 v67, v87, 12, v116
v_and_b32 v87, 0x3fc, v117
ds_add_rtn_u32 v109, v87, v127 offset:1024
v_lshrrev_b32 v116, 8, v68
v_lshrrev_b32 v117, 2, v68
v_bfi_b32 v116, 15, v68, v116
v_lshl_or_b32 v68, v88, 12, v116
v_and_b32 v88, 0x3fc, v117
ds_add_rtn_u32 v110, v88, v127 offset:1024
v_lshrrev_b32 v116, 8, v69
v_lshrrev_b32 v117, 2, v69
v_bfi_b32 v116, 15, v69, v116
v_lshl_or_b32 v69, v89, 12, v116
v_and_b32 v89, 0x3fc, v117
ds_add_rtn_u32 v111, v89, v127 offset:1024
v_lshlrev_b32 v118, 16, v102
v_and_b32 v119, 0xffff0000, v102
v_mul_f32 v118, v3, v118
v_mul_f32 v119, v3, v119
v_fract_f32 v118, v118
v_fract_f32 v119, v119
v_cos_f32 v118, v118
v_cos_f32 v119, v119
s_nop 0
v_cvt_pk_f16_f32 v102, v118, v119
v_lshlrev_b32 v118, 16, v103
v_and_b32 v119, 0xffff0000, v103
v_mul_f32 v118, v3, v118
v_mul_f32 v119, v3, v119
v_fract_f32 v118, v118
v_fract_f32 v119, v119
v_cos_f32 v118, v118
v_cos_f32 v119, v119
s_nop 0
v_cvt_pk_f16_f32 v103, v118, v119
s_waitcnt lgkmcnt(4)
v_lshl_or_b32 v82, v112, 10, v82
v_lshl_or_b32 v83, v113, 10, v83
v_lshl_or_b32 v84, v114, 10, v84
v_lshl_or_b32 v85, v115, 10, v85
v_lshrrev_b32 v116, 8, v70
v_lshrrev_b32 v117, 2, v70
v_bfi_b32 v116, 15, v70, v116
v_lshl_or_b32 v70, v90, 12, v116
v_and_b32 v90, 0x3fc, v117
ds_add_rtn_u32 v112, v90, v127 offset:1024
v_lshrrev_b32 v116, 8, v71
v_lshrrev_b32 v117, 2, v71
v_bfi_b32 v116, 15, v71, v116
v_lshl_or_b32 v71, v91, 12, v116
v_and_b32 v91, 0x3fc, v117
ds_add_rtn_u32 v113, v91, v127 offset:1024
v_lshrrev_b32 v116, 8, v72
v_lshrrev_b32 v117, 2, v72
v_bfi_b32 v116, 15, v72, v116
v_lshl_or_b32 v72, v92, 12, v116
v_and_b32 v92, 0x3fc, v117
ds_add_rtn_u32 v114, v92, v127 offset:1024
v_lshrrev_b32 v116, 8, v73
v_lshrrev_b32 v117, 2, v73
v_bfi_b32 v116, 15, v73, v116
v_lshl_or_b32 v73, v93, 12, v116
v_and_b32 v93, 0x3fc, v117
ds_add_rtn_u32 v115, v93, v127 offset:1024
v_lshlrev_b32 v118, 16, v104
v_and_b32 v119, 0xffff0000, v104
v_mul_f32 v118, v3, v118
v_mul_f32 v119, v3, v119
v_fract_f32 v118, v118
v_fract_f32 v119, v119
v_cos_f32 v118, v118
v_cos_f32 v119, v119
s_nop 0
v_cvt_pk_f16_f32 v104, v118, v119
v_lshlrev_b32 v118, 16, v105
v_and_b32 v119, 0xffff0000, v105
v_mul_f32 v118, v3, v118
v_mul_f32 v119, v3, v119
v_fract_f32 v118, v118
v_fract_f32 v119, v119
v_cos_f32 v118, v118
v_cos_f32 v119, v119
s_nop 0
v_cvt_pk_f16_f32 v105, v118, v119
s_waitcnt lgkmcnt(4)
v_lshl_or_b32 v86, v108, 10, v86
v_lshl_or_b32 v87, v109, 10, v87
v_lshl_or_b32 v88, v110, 10, v88
v_lshl_or_b32 v89, v111, 10, v89
s_waitcnt lgkmcnt(0)
v_lshl_or_b32 v90, v112, 10, v90
v_lshl_or_b32 v91, v113, 10, v91
v_lshl_or_b32 v92, v114, 10, v92
v_lshl_or_b32 v93, v115, 10, v93
s_mov_b64 exec, s[56:57]
v_lshrrev_b32 v116, 8, v74
v_lshrrev_b32 v117, 2, v74
v_bfi_b32 v116, 15, v74, v116
v_lshl_or_b32 v74, v94, 12, v116
v_and_b32 v94, 0x3fc, v117
ds_add_rtn_u32 v108, v94, v127 offset:1024
v_lshrrev_b32 v116, 8, v75
v_lshrrev_b32 v117, 2, v75
v_bfi_b32 v116, 15, v75, v116
v_lshl_or_b32 v75, v95, 12, v116
v_and_b32 v95, 0x3fc, v117
ds_add_rtn_u32 v109, v95, v127 offset:1024
v_lshrrev_b32 v116, 8, v76
v_lshrrev_b32 v117, 2, v76
v_bfi_b32 v116, 15, v76, v116
v_lshl_or_b32 v76, v96, 12, v116
v_and_b32 v96, 0x3fc, v117
ds_add_rtn_u32 v110, v96, v127 offset:1024
v_lshrrev_b32 v116, 8, v77
v_lshrrev_b32 v117, 2, v77
v_bfi_b32 v116, 15, v77, v116
v_lshl_or_b32 v77, v97, 12, v116
v_and_b32 v97, 0x3fc, v117
ds_add_rtn_u32 v111, v97, v127 offset:1024
v_lshlrev_b32 v118, 16, v106
v_and_b32 v119, 0xffff0000, v106
v_mul_f32 v118, v3, v118
v_mul_f32 v119, v3, v119
v_fract_f32 v118, v118
v_fract_f32 v119, v119
v_cos_f32 v118, v118
v_cos_f32 v119, v119
s_nop 0
v_cvt_pk_f16_f32 v106, v118, v119
v_lshlrev_b32 v118, 16, v107
v_and_b32 v119, 0xffff0000, v107
v_mul_f32 v118, v3, v118
v_mul_f32 v119, v3, v119
v_fract_f32 v118, v118
v_fract_f32 v119, v119
v_cos_f32 v118, v118
v_cos_f32 v119, v119
s_nop 0
v_cvt_pk_f16_f32 v107, v118, v119
s_waitcnt lgkmcnt(0)
v_lshl_or_b32 v94, v108, 10, v94
v_lshl_or_b32 v95, v109, 10, v95
v_lshl_or_b32 v96, v110, 10, v96
v_lshl_or_b32 v97, v111, 10, v97
s_mov_b64 exec, -1
s_barrier
s_add_u32 s50, s59, 160000
s_lshr_b32 s51, s50, 1
buffer_load_dwordx4 v[8:11], v1, s[8:11], s50 offen nt
buffer_load_dwordx4 v[28:31], v1, s[12:15], s50 offen nt
buffer_load_dwordx2 v[48:49], v2, s[16:19], s51 offen nt
s_add_u32 s50, s59, 176384
s_lshr_b32 s51, s50, 1
buffer_load_dwordx4 v[12:15], v1, s[8:11], s50 offen nt
buffer_load_dwordx4 v[32:35], v1, s[12:15], s50 offen nt
buffer_load_dwordx2 v[50:51], v2, s[16:19], s51 offen nt
s_add_u32 s50, s59, 192768
s_lshr_b32 s51, s50, 1
buffer_load_dwordx4 v[16:19], v1, s[8:11], s50 offen nt
buffer_load_dwordx4 v[36:39], v1, s[12:15], s50 offen nt
buffer_load_dwordx2 v[52:53], v2, s[16:19], s51 offen nt
s_add_u32 s50, s59, 209152
s_lshr_b32 s51, s50, 1
buffer_load_dwordx4 v[20:23], v1, s[8:11], s50 offen nt
buffer_load_dwordx4 v[40:43], v1, s[12:15], s50 offen nt
buffer_load_dwordx2 v[54:55], v2, s[16:19], s51 offen nt
s_add_u32 s50, s59, 225536
s_lshr_b32 s51, s50, 1
buffer_load_dwordx4 v[24:27], v124, s[8:11], s50 offen nt
buffer_load_dwordx4 v[44:47], v124, s[12:15], s50 offen nt
buffer_load_dwordx2 v[56:57], v125, s[16:19], s51 offen nt
ds_read_b128 v[108:111], v126 offset:1024
s_waitcnt lgkmcnt(0)
v_add_u32 v112, 3, v108
v_lshrrev_b32 v112, 2, v112
v_add_u32 v113, 3, v109
v_lshrrev_b32 v113, 2, v113
v_add_u32 v114, 3, v110
v_lshrrev_b32 v114, 2, v114
v_add_u32 v115, 3, v111
v_lshrrev_b32 v115, 2, v115
v_add_u32 v118, v112, v113
v_add_u32 v119, v118, v114
v_add_u32 v120, v119, v115
v_mov_b32 v121, v120
s_nop 1
v_add_u32_dpp v121, v121, v121 row_shr:1 row_mask:0xf bank_mask:0xf bound_ctrl:0
s_nop 1
v_add_u32_dpp v121, v121, v121 row_shr:2 row_mask:0xf bank_mask:0xf bound_ctrl:0
s_nop 1
v_add_u32_dpp v121, v121, v121 row_shr:4 row_mask:0xf bank_mask:0xf bound_ctrl:0
s_nop 1
v_add_u32_dpp v121, v121, v121 row_shr:8 row_mask:0xf bank_mask:0xf bound_ctrl:0
s_nop 1
v_add_u32_dpp v121, v121, v121 row_bcast:15 row_mask:0xa bank_mask:0xf
s_nop 1
v_add_u32_dpp v121, v121, v121 row_bcast:31 row_mask:0xc bank_mask:0xf
v_sub_u32 v116, v121, v120
v_add_u32 v117, v116, v112
v_add_u32 v118, v116, v118
v_add_u32 v119, v116, v119
v_readlane_b32 s61, v121, 63
v_lshl_or_b32 v112, v112, 16, v116
v_lshl_or_b32 v113, v113, 16, v117
v_lshl_or_b32 v114, v114, 16, v118
v_lshl_or_b32 v115, v115, 16, v119
v_mul_u32_u24 v116, 24, v116
v_mul_u32_u24 v117, 24, v117
v_mul_u32_u24 v118, 24, v118
v_mul_u32_u24 v119, 24, v119
ds_write_b128 v126, v[116:119] offset:2048
ds_write_b128 v126, v[4:7] offset:0
s_cmp_lg_u32 s58, 0
s_cbranch_scc1 k1w0_3
s_add_u32 s50, s60, 1
s_lshl_b32 s50, s50, 10
buffer_store_dwordx4 v[112:115], v126, s[28:31], s50 offen
k1w0_3:
s_cmp_lg_u32 s58, 1
s_cbranch_scc1 k1w1_4
v_lshrrev_b32 v120, 2, v108
v_mad_u32_u24 v120, v120, 24, v116
v_and_b32 v121, 3, v108
v_add_u32 v121, -1, v121
v_cmp_gt_u32 vcc, 1, v121
v_mov_b32 v123, 196608
s_nop 0
v_cndmask_b32 v123, v123, v120, vcc
ds_write_b16 v123, v4 offset:3106
v_cmp_gt_u32 vcc, 2, v121
v_mov_b32 v123, 196608
s_nop 0
v_cndmask_b32 v123, v123, v120, vcc
ds_write_b16 v123, v4 offset:3108
v_cmp_gt_u32 vcc, 3, v121
v_mov_b32 v123, 196608
s_nop 0
v_cndmask_b32 v123, v123, v120, vcc
ds_write_b16 v123, v4 offset:3110
v_lshrrev_b32 v120, 2, v109
v_mad_u32_u24 v120, v120, 24, v117
v_and_b32 v121, 3, v109
v_add_u32 v121, -1, v121
v_cmp_gt_u32 vcc, 1, v121
v_mov_b32 v123, 196608
s_nop 0
v_cndmask_b32 v123, v123, v120, vcc
ds_write_b16 v123, v4 offset:3106
v_cmp_gt_u32 vcc, 2, v121
v_mov_b32 v123, 196608
s_nop 0
v_cndmask_b32 v123, v123, v120, vcc
ds_write_b16 v123, v4 offset:3108
v_cmp_gt_u32 vcc, 3, v121
v_mov_b32 v123, 196608
s_nop 0
v_cndmask_b32 v123, v123, v120, vcc
ds_write_b16 v123, v4 offset:3110
v_lshrrev_b32 v120, 2, v110
v_mad_u32_u24 v120, v120, 24, v118
v_and_b32 v121, 3, v110
v_add_u32 v121, -1, v121
v_cmp_gt_u32 vcc, 1, v121
v_mov_b32 v123, 196608
s_nop 0
v_cndmask_b32 v123, v123, v120, vcc
ds_write_b16 v123, v4 offset:3106
v_cmp_gt_u32 vcc, 2, v121
v_mov_b32 v123, 196608
s_nop 0
v_cndmask_b32 v123, v123, v120, vcc
ds_write_b16 v123, v4 offset:3108
v_cmp_gt_u32 vcc, 3, v121
v_mov_b32 v123, 196608
s_nop 0
v_cndmask_b32 v123, v123, v120, vcc
ds_write_b16 v123, v4 offset:3110
v_lshrrev_b32 v120, 2, v111
v_mad_u32_u24 v120, v120, 24, v119
v_and_b32 v121, 3, v111
v_add_u32 v121, -1, v121
v_cmp_gt_u32 vcc, 1, v121
v_mov_b32 v123, 196608
s_nop 0
v_cndmask_b32 v123, v123, v120, vcc
ds_write_b16 v123, v4 offset:3106
v_cmp_gt_u32 vcc, 2, v121
v_mov_b32 v123, 196608
s_nop 0
v_cndmask_b32 v123, v123, v120, vcc
ds_write_b16 v123, v4 offset:3108
v_cmp_gt_u32 vcc, 3, v121
v_mov_b32 v123, 196608
s_nop 0
v_cndmask_b32 v123, v123, v120, vcc
ds_write_b16 v123, v4 offset:3110
k1w1_4:
s_add_u32 s50, s60, 1
s_mul_i32 s51, s50, 124800
s_add_u32 s20, s52, s51
s_addc_u32 s21, s53, 0
s_and_b32 s21, s21, 0xffff
s_mul_i32 s22, s61, 24
s_add_u32 s22, s22, 127
s_and_b32 s22, s22, 0xffffff80
s_waitcnt lgkmcnt(0)
v_and_b32 v108, 0x3ff, v78
ds_read_b32 v108, v108 offset:2048
v_and_b32 v109, 0x3ff, v79
ds_read_b32 v109, v109 offset:2048
v_and_b32 v110, 0x3ff, v80
ds_read_b32 v110, v110 offset:2048
v_and_b32 v111, 0x3ff, v81
ds_read_b32 v111, v111 offset:2048
v_and_b32 v112, 0x3ff, v82
ds_read_b32 v112, v112 offset:2048
v_and_b32 v113, 0x3ff, v83
ds_read_b32 v113, v113 offset:2048
v_and_b32 v114, 0x3ff, v84
ds_read_b32 v114, v114 offset:2048
v_and_b32 v115, 0x3ff, v85
ds_read_b32 v115, v115 offset:2048
s_waitcnt lgkmcnt(0)
v_lshrrev_b32 v78, 10, v78
v_mad_u32_u24 v108, v78, 6, v108
v_and_b32 v116, 3, v78
v_mad_i32_i24 v117, v116, -2, v108
v_mad_i32_i24 v108, v116, -4, v108
ds_write_b32 v117, v58 offset:3088
ds_write_b16 v108, v98 offset:3104
v_lshrrev_b32 v79, 10, v79
v_mad_u32_u24 v109, v79, 6, v109
v_and_b32 v116, 3, v79
v_mad_i32_i24 v117, v116, -2, v109
v_mad_i32_i24 v109, v116, -4, v109
ds_write_b32 v117, v59 offset:3088
ds_write_b16_d16_hi v109, v98 offset:3104
v_lshrrev_b32 v80, 10, v80
v_mad_u32_u24 v110, v80, 6, v110
v_and_b32 v116, 3, v80
v_mad_i32_i24 v117, v116, -2, v110
v_mad_i32_i24 v110, v116, -4, v110
ds_write_b32 v117, v60 offset:3088
ds_write_b16 v110, v99 offset:3104
v_lshrrev_b32 v81, 10, v81
v_mad_u32_u24 v111, v81, 6, v111
v_and_b32 v116, 3, v81
v_mad_i32_i24 v117, v116, -2, v111
v_mad_i32_i24 v111, v116, -4, v111
ds_write_b32 v117, v61 offset:3088
ds_write_b16_d16_hi v111, v99 offset:3104
v_lshrrev_b32 v82, 10, v82
v_mad_u32_u24 v112, v82, 6, v112
v_and_b32 v116, 3, v82
v_mad_i32_i24 v117, v116, -2, v112
v_mad_i32_i24 v112, v116, -4, v112
ds_write_b32 v117, v62 offset:3088
ds_write_b16 v112, v100 offset:3104
v_lshrrev_b32 v83, 10, v83
v_mad_u32_u24 v113, v83, 6, v113
v_and_b32 v116, 3, v83
v_mad_i32_i24 v117, v116, -2, v113
v_mad_i32_i24 v113, v116, -4, v113
ds_write_b32 v117, v63 offset:3088
ds_write_b16_d16_hi v113, v100 offset:3104
v_lshrrev_b32 v84, 10, v84
v_mad_u32_u24 v114, v84, 6, v114
v_and_b32 v116, 3, v84
v_mad_i32_i24 v117, v116, -2, v114
v_mad_i32_i24 v114, v116, -4, v114
ds_write_b32 v117, v64 offset:3088
ds_write_b16 v114, v101 offset:3104
v_lshrrev_b32 v85, 10, v85
v_mad_u32_u24 v115, v85, 6, v115
v_and_b32 v116, 3, v85
v_mad_i32_i24 v117, v116, -2, v115
v_mad_i32_i24 v115, v116, -4, v115
ds_write_b32 v117, v65 offset:3088
ds_write_b16_d16_hi v115, v101 offset:3104
v_and_b32 v108, 0x3ff, v86
ds_read_b32 v108, v108 offset:2048
v_and_b32 v109, 0x3ff, v87
ds_read_b32 v109, v109 offset:2048
v_and_b32 v110, 0x3ff, v88
ds_read_b32 v110, v110 offset:2048
v_and_b32 v111, 0x3ff, v89
ds_read_b32 v111, v111 offset:2048
v_and_b32 v112, 0x3ff, v90
ds_read_b32 v112, v112 offset:2048
v_and_b32 v113, 0x3ff, v91
ds_read_b32 v113, v113 offset:2048
v_and_b32 v114, 0x3ff, v92
ds_read_b32 v114, v114 offset:2048
v_and_b32 v115, 0x3ff, v93
ds_read_b32 v115, v115 offset:2048
s_waitcnt lgkmcnt(0)
v_lshrrev_b32 v86, 10, v86
v_mad_u32_u24 v108, v86, 6, v108
v_and_b32 v116, 3, v86
v_mad_i32_i24 v117, v116, -2, v108
v_mad_i32_i24 v108, v116, -4, v108
ds_write_b32 v117, v66 offset:3088
ds_write_b16 v108, v102 offset:3104
v_lshrrev_b32 v87, 10, v87
v_mad_u32_u24 v109, v87, 6, v109
v_and_b32 v116, 3, v87
v_mad_i32_i24 v117, v116, -2, v109
v_mad_i32_i24 v109, v116, -4, v109
ds_write_b32 v117, v67 offset:3088
ds_write_b16_d16_hi v109, v102 offset:3104
v_lshrrev_b32 v88, 10, v88
v_mad_u32_u24 v110, v88, 6, v110
v_and_b32 v116, 3, v88
v_mad_i32_i24 v117, v116, -2, v110
v_mad_i32_i24 v110, v116, -4, v110
ds_write_b32 v117, v68 offset:3088
ds_write_b16 v110, v103 offset:3104
v_lshrrev_b32 v89, 10, v89
v_mad_u32_u24 v111, v89, 6, v111
v_and_b32 v116, 3, v89
v_mad_i32_i24 v117, v116, -2, v111
v_mad_i32_i24 v111, v116, -4, v111
ds_write_b32 v117, v69 offset:3088
ds_write_b16_d16_hi v111, v103 offset:3104
v_lshrrev_b32 v90, 10, v90
v_mad_u32_u24 v112, v90, 6, v112
v_and_b32 v116, 3, v90
v_mad_i32_i24 v117, v116, -2, v112
v_mad_i32_i24 v112, v116, -4, v112
ds_write_b32 v117, v70 offset:3088
ds_write_b16 v112, v104 offset:3104
v_lshrrev_b32 v91, 10, v91
v_mad_u32_u24 v113, v91, 6, v113
v_and_b32 v116, 3, v91
v_mad_i32_i24 v117, v116, -2, v113
v_mad_i32_i24 v113, v116, -4, v113
ds_write_b32 v117, v71 offset:3088
ds_write_b16_d16_hi v113, v104 offset:3104
v_lshrrev_b32 v92, 10, v92
v_mad_u32_u24 v114, v92, 6, v114
v_and_b32 v116, 3, v92
v_mad_i32_i24 v117, v116, -2, v114
v_mad_i32_i24 v114, v116, -4, v114
ds_write_b32 v117, v72 offset:3088
ds_write_b16 v114, v105 offset:3104
v_lshrrev_b32 v93, 10, v93
v_mad_u32_u24 v115, v93, 6, v115
v_and_b32 v116, 3, v93
v_mad_i32_i24 v117, v116, -2, v115
v_mad_i32_i24 v115, v116, -4, v115
ds_write_b32 v117, v73 offset:3088
ds_write_b16_d16_hi v115, v105 offset:3104
s_mov_b64 exec, s[56:57]
v_and_b32 v108, 0x3ff, v94
ds_read_b32 v108, v108 offset:2048
v_and_b32 v109, 0x3ff, v95
ds_read_b32 v109, v109 offset:2048
v_and_b32 v110, 0x3ff, v96
ds_read_b32 v110, v110 offset:2048
v_and_b32 v111, 0x3ff, v97
ds_read_b32 v111, v111 offset:2048
s_waitcnt lgkmcnt(0)
v_lshrrev_b32 v94, 10, v94
v_mad_u32_u24 v108, v94, 6, v108
v_and_b32 v116, 3, v94
v_mad_i32_i24 v117, v116, -2, v108
v_mad_i32_i24 v108, v116, -4, v108
ds_write_b32 v117, v74 offset:3088
ds_write_b16 v108, v106 offset:3104
v_lshrrev_b32 v95, 10, v95
v_mad_u32_u24 v109, v95, 6, v109
v_and_b32 v116, 3, v95
v_mad_i32_i24 v117, v116, -2, v109
v_mad_i32_i24 v109, v116, -4, v109
ds_write_b32 v117, v75 offset:3088
ds_write_b16_d16_hi v109, v106 offset:3104
v_lshrrev_b32 v96, 10, v96
v_mad_u32_u24 v110, v96, 6, v110
v_and_b32 v116, 3, v96
v_mad_i32_i24 v117, v116, -2, v110
v_mad_i32_i24 v110, v116, -4, v110
ds_write_b32 v117, v76 offset:3088
ds_write_b16 v110, v107 offset:3104
v_lshrrev_b32 v97, 10, v97
v_mad_u32_u24 v111, v97, 6, v111
v_and_b32 v116, 3, v97
v_mad_i32_i24 v117, v116, -2, v111
v_mad_i32_i24 v111, v116, -4, v111
ds_write_b32 v117, v77 offset:3088
ds_write_b16_d16_hi v111, v107 offset:3104
s_mov_b64 exec, -1
s_waitcnt lgkmcnt(0)
s_barrier
v_add_u32 v108, 0, v1
ds_read_b128 v[58:61], v108 offset:3088
v_add_u32 v109, 16384, v1
ds_read_b128 v[62:65], v109 offset:3088
v_add_u32 v110, 32768, v1
ds_read_b128 v[66:69], v110 offset:3088
v_add_u32 v111, 49152, v1
ds_read_b128 v[70:73], v111 offset:3088
v_add_u32 v112, 65536, v1
ds_read_b128 v[74:77], v112 offset:3088
v_add_u32 v113, 81920, v1
ds_read_b128 v[78:81], v113 offset:3088
v_add_u32 v114, 98304, v1
ds_read_b128 v[82:85], v114 offset:3088
v_add_u32 v115, 114688, v1
ds_read_b128 v[86:89], v115 offset:3088
s_waitcnt lgkmcnt(7)
buffer_store_dwordx4 v[58:61], v108, s[20:23], 0 offen sc1
s_waitcnt lgkmcnt(6)
buffer_store_dwordx4 v[62:65], v109, s[20:23], 0 offen sc1
s_waitcnt lgkmcnt(5)
buffer_store_dwordx4 v[66:69], v110, s[20:23], 0 offen sc1
s_waitcnt lgkmcnt(4)
buffer_store_dwordx4 v[70:73], v111, s[20:23], 0 offen sc1
s_waitcnt lgkmcnt(3)
buffer_store_dwordx4 v[74:77], v112, s[20:23], 0 offen sc1
s_waitcnt lgkmcnt(2)
buffer_store_dwordx4 v[78:81], v113, s[20:23], 0 offen sc1
s_waitcnt lgkmcnt(1)
buffer_store_dwordx4 v[82:85], v114, s[20:23], 0 offen sc1
s_waitcnt lgkmcnt(0)
buffer_store_dwordx4 v[86:89], v115, s[20:23], 0 offen sc1
s_waitcnt vmcnt(8)
v_lshrrev_b32 v116, 8, v8
v_lshrrev_b32 v117, 2, v8
v_bfi_b32 v116, 15, v8, v116
v_lshl_or_b32 v8, v28, 12, v116
v_and_b32 v28, 0x3fc, v117
ds_add_rtn_u32 v108, v28, v127 offset:0
v_lshrrev_b32 v116, 8, v9
v_lshrrev_b32 v117, 2, v9
v_bfi_b32 v116, 15, v9, v116
v_lshl_or_b32 v9, v29, 12, v116
v_and_b32 v29, 0x3fc, v117
ds_add_rtn_u32 v109, v29, v127 offset:0
v_lshrrev_b32 v116, 8, v10
v_lshrrev_b32 v117, 2, v10
v_bfi_b32 v116, 15, v10, v116
v_lshl_or_b32 v10, v30, 12, v116
v_and_b32 v30, 0x3fc, v117
ds_add_rtn_u32 v110, v30, v127 offset:0
v_lshrrev_b32 v116, 8, v11
v_lshrrev_b32 v117, 2, v11
v_bfi_b32 v116, 15, v11, v116
v_lshl_or_b32 v11, v31, 12, v116
v_and_b32 v31, 0x3fc, v117
ds_add_rtn_u32 v111, v31, v127 offset:0
v_lshlrev_b32 v118, 16, v48
v_and_b32 v119, 0xffff0000, v48
v_mul_f32 v118, v3, v118
v_mul_f32 v119, v3, v119
v_fract_f32 v118, v118
v_fract_f32 v119, v119
v_cos_f32 v118, v118
v_cos_f32 v119, v119
s_nop 0
v_cvt_pk_f16_f32 v48, v118, v119
v_lshlrev_b32 v118, 16, v49
v_and_b32 v119, 0xffff0000, v49
v_mul_f32 v118, v3, v118
v_mul_f32 v119, v3, v119
v_fract_f32 v118, v118
v_fract_f32 v119, v119
v_cos_f32 v118, v118
v_cos_f32 v119, v119
s_nop 0
v_cvt_pk_f16_f32 v49, v118, v119
v_lshrrev_b32 v116, 8, v12
v_lshrrev_b32 v117, 2, v12
v_bfi_b32 v116, 15, v12, v116
v_lshl_or_b32 v12, v32, 12, v116
v_and_b32 v32, 0x3fc, v117
ds_add_rtn_u32 v112, v32, v127 offset:0
v_lshrrev_b32 v116, 8, v13
v_lshrrev_b32 v117, 2, v13
v_bfi_b32 v116, 15, v13, v116
v_lshl_or_b32 v13, v33, 12, v116
v_and_b32 v33, 0x3fc, v117
ds_add_rtn_u32 v113, v33, v127 offset:0
v_lshrrev_b32 v116, 8, v14
v_lshrrev_b32 v117, 2, v14
v_bfi_b32 v116, 15, v14, v116
v_lshl_or_b32 v14, v34, 12, v116
v_and_b32 v34, 0x3fc, v117
ds_add_rtn_u32 v114, v34, v127 offset:0
v_lshrrev_b32 v116, 8, v15
v_lshrrev_b32 v117, 2, v15
v_bfi_b32 v116, 15, v15, v116
v_lshl_or_b32 v15, v35, 12, v116
v_and_b32 v35, 0x3fc, v117
ds_add_rtn_u32 v115, v35, v127 offset:0
v_lshlrev_b32 v118, 16, v50
v_and_b32 v119, 0xffff0000, v50
v_mul_f32 v118, v3, v118
v_mul_f32 v119, v3, v119
v_fract_f32 v118, v118
v_fract_f32 v119, v119
v_cos_f32 v118, v118
v_cos_f32 v119, v119
s_nop 0
v_cvt_pk_f16_f32 v50, v118, v119
v_lshlrev_b32 v118, 16, v51
v_and_b32 v119, 0xffff0000, v51
v_mul_f32 v118, v3, v118
v_mul_f32 v119, v3, v119
v_fract_f32 v118, v118
v_fract_f32 v119, v119
v_cos_f32 v118, v118
v_cos_f32 v119, v119
s_nop 0
v_cvt_pk_f16_f32 v51, v118, v119
s_waitcnt lgkmcnt(4)
v_lshl_or_b32 v28, v108, 10, v28
v_lshl_or_b32 v29, v109, 10, v29
v_lshl_or_b32 v30, v110, 10, v30
v_lshl_or_b32 v31, v111, 10, v31
v_lshrrev_b32 v116, 8, v16
v_lshrrev_b32 v117, 2, v16
v_bfi_b32 v116, 15, v16, v116
v_lshl_or_b32 v16, v36, 12, v116
v_and_b32 v36, 0x3fc, v117
ds_add_rtn_u32 v108, v36, v127 offset:0
v_lshrrev_b32 v116, 8, v17
v_lshrrev_b32 v117, 2, v17
v_bfi_b32 v116, 15, v17, v116
v_lshl_or_b32 v17, v37, 12, v116
v_and_b32 v37, 0x3fc, v117
ds_add_rtn_u32 v109, v37, v127 offset:0
v_lshrrev_b32 v116, 8, v18
v_lshrrev_b32 v117, 2, v18
v_bfi_b32 v116, 15, v18, v116
v_lshl_or_b32 v18, v38, 12, v116
v_and_b32 v38, 0x3fc, v117
ds_add_rtn_u32 v110, v38, v127 offset:0
v_lshrrev_b32 v116, 8, v19
v_lshrrev_b32 v117, 2, v19
v_bfi_b32 v116, 15, v19, v116
v_lshl_or_b32 v19, v39, 12, v116
v_and_b32 v39, 0x3fc, v117
ds_add_rtn_u32 v111, v39, v127 offset:0
v_lshlrev_b32 v118, 16, v52
v_and_b32 v119, 0xffff0000, v52
v_mul_f32 v118, v3, v118
v_mul_f32 v119, v3, v119
v_fract_f32 v118, v118
v_fract_f32 v119, v119
v_cos_f32 v118, v118
v_cos_f32 v119, v119
s_nop 0
v_cvt_pk_f16_f32 v52, v118, v119
v_lshlrev_b32 v118, 16, v53
v_and_b32 v119, 0xffff0000, v53
v_mul_f32 v118, v3, v118
v_mul_f32 v119, v3, v119
v_fract_f32 v118, v118
v_fract_f32 v119, v119
v_cos_f32 v118, v118
v_cos_f32 v119, v119
s_nop 0
v_cvt_pk_f16_f32 v53, v118, v119
s_waitcnt lgkmcnt(4)
v_lshl_or_b32 v32, v112, 10, v32
v_lshl_or_b32 v33, v113, 10, v33
v_lshl_or_b32 v34, v114, 10, v34
v_lshl_or_b32 v35, v115, 10, v35
v_lshrrev_b32 v116, 8, v20
v_lshrrev_b32 v117, 2, v20
v_bfi_b32 v116, 15, v20, v116
v_lshl_or_b32 v20, v40, 12, v116
v_and_b32 v40, 0x3fc, v117
ds_add_rtn_u32 v112, v40, v127 offset:0
v_lshrrev_b32 v116, 8, v21
v_lshrrev_b32 v117, 2, v21
v_bfi_b32 v116, 15, v21, v116
v_lshl_or_b32 v21, v41, 12, v116
v_and_b32 v41, 0x3fc, v117
ds_add_rtn_u32 v113, v41, v127 offset:0
v_lshrrev_b32 v116, 8, v22
v_lshrrev_b32 v117, 2, v22
v_bfi_b32 v116, 15, v22, v116
v_lshl_or_b32 v22, v42, 12, v116
v_and_b32 v42, 0x3fc, v117
ds_add_rtn_u32 v114, v42, v127 offset:0
v_lshrrev_b32 v116, 8, v23
v_lshrrev_b32 v117, 2, v23
v_bfi_b32 v116, 15, v23, v116
v_lshl_or_b32 v23, v43, 12, v116
v_and_b32 v43, 0x3fc, v117
ds_add_rtn_u32 v115, v43, v127 offset:0
v_lshlrev_b32 v118, 16, v54
v_and_b32 v119, 0xffff0000, v54
v_mul_f32 v118, v3, v118
v_mul_f32 v119, v3, v119
v_fract_f32 v118, v118
v_fract_f32 v119, v119
v_cos_f32 v118, v118
v_cos_f32 v119, v119
s_nop 0
v_cvt_pk_f16_f32 v54, v118, v119
v_lshlrev_b32 v118, 16, v55
v_and_b32 v119, 0xffff0000, v55
v_mul_f32 v118, v3, v118
v_mul_f32 v119, v3, v119
v_fract_f32 v118, v118
v_fract_f32 v119, v119
v_cos_f32 v118, v118
v_cos_f32 v119, v119
s_nop 0
v_cvt_pk_f16_f32 v55, v118, v119
s_waitcnt lgkmcnt(4)
v_lshl_or_b32 v36, v108, 10, v36
v_lshl_or_b32 v37, v109, 10, v37
v_lshl_or_b32 v38, v110, 10, v38
v_lshl_or_b32 v39, v111, 10, v39
s_waitcnt lgkmcnt(0)
v_lshl_or_b32 v40, v112, 10, v40
v_lshl_or_b32 v41, v113, 10, v41
v_lshl_or_b32 v42, v114, 10, v42
v_lshl_or_b32 v43, v115, 10, v43
s_mov_b64 exec, s[56:57]
v_lshrrev_b32 v116, 8, v24
v_lshrrev_b32 v117, 2, v24
v_bfi_b32 v116, 15, v24, v116
v_lshl_or_b32 v24, v44, 12, v116
v_and_b32 v44, 0x3fc, v117
ds_add_rtn_u32 v108, v44, v127 offset:0
v_lshrrev_b32 v116, 8, v25
v_lshrrev_b32 v117, 2, v25
v_bfi_b32 v116, 15, v25, v116
v_lshl_or_b32 v25, v45, 12, v116
v_and_b32 v45, 0x3fc, v117
ds_add_rtn_u32 v109, v45, v127 offset:0
v_lshrrev_b32 v116, 8, v26
v_lshrrev_b32 v117, 2, v26
v_bfi_b32 v116, 15, v26, v116
v_lshl_or_b32 v26, v46, 12, v116
v_and_b32 v46, 0x3fc, v117
ds_add_rtn_u32 v110, v46, v127 offset:0
v_lshrrev_b32 v116, 8, v27
v_lshrrev_b32 v117, 2, v27
v_bfi_b32 v116, 15, v27, v116
v_lshl_or_b32 v27, v47, 12, v116
v_and_b32 v47, 0x3fc, v117
ds_add_rtn_u32 v111, v47, v127 offset:0
v_lshlrev_b32 v118, 16, v56
v_and_b32 v119, 0xffff0000, v56
v_mul_f32 v118, v3, v118
v_mul_f32 v119, v3, v119
v_fract_f32 v118, v118
v_fract_f32 v119, v119
v_cos_f32 v118, v118
v_cos_f32 v119, v119
s_nop 0
v_cvt_pk_f16_f32 v56, v118, v119
v_lshlrev_b32 v118, 16, v57
v_and_b32 v119, 0xffff0000, v57
v_mul_f32 v118, v3, v118
v_mul_f32 v119, v3, v119
v_fract_f32 v118, v118
v_fract_f32 v119, v119
v_cos_f32 v118, v118
v_cos_f32 v119, v119
s_nop 0
v_cvt_pk_f16_f32 v57, v118, v119
s_waitcnt lgkmcnt(0)
v_lshl_or_b32 v44, v108, 10, v44
v_lshl_or_b32 v45, v109, 10, v45
v_lshl_or_b32 v46, v110, 10, v46
v_lshl_or_b32 v47, v111, 10, v47
s_mov_b64 exec, -1
s_barrier
s_add_u32 s50, s59, 240000
s_lshr_b32 s51, s50, 1
buffer_load_dwordx4 v[58:61], v1, s[8:11], s50 offen nt
buffer_load_dwordx4 v[78:81], v1, s[12:15], s50 offen nt
buffer_load_dwordx2 v[98:99], v2, s[16:19], s51 offen nt
s_add_u32 s50, s59, 256384
s_lshr_b32 s51, s50, 1
buffer_load_dwordx4 v[62:65], v1, s[8:11], s50 offen nt
buffer_load_dwordx4 v[82:85], v1, s[12:15], s50 offen nt
buffer_load_dwordx2 v[100:101], v2, s[16:19], s51 offen nt
s_add_u32 s50, s59, 272768
s_lshr_b32 s51, s50, 1
buffer_load_dwordx4 v[66:69], v1, s[8:11], s50 offen nt
buffer_load_dwordx4 v[86:89], v1, s[12:15], s50 offen nt
buffer_load_dwordx2 v[102:103], v2, s[16:19], s51 offen nt
s_add_u32 s50, s59, 289152
s_lshr_b32 s51, s50, 1
buffer_load_dwordx4 v[70:73], v1, s[8:11], s50 offen nt
buffer_load_dwordx4 v[90:93], v1, s[12:15], s50 offen nt
buffer_load_dwordx2 v[104:105], v2, s[16:19], s51 offen nt
s_add_u32 s50, s59, 305536
s_lshr_b32 s51, s50, 1
buffer_load_dwordx4 v[74:77], v124, s[8:11], s50 offen nt
buffer_load_dwordx4 v[94:97], v124, s[12:15], s50 offen nt
buffer_load_dwordx2 v[106:107], v125, s[16:19], s51 offen nt
ds_read_b128 v[108:111], v126 offset:0
s_waitcnt lgkmcnt(0)
v_add_u32 v112, 3, v108
v_lshrrev_b32 v112, 2, v112
v_add_u32 v113, 3, v109
v_lshrrev_b32 v113, 2, v113
v_add_u32 v114, 3, v110
v_lshrrev_b32 v114, 2, v114
v_add_u32 v115, 3, v111
v_lshrrev_b32 v115, 2, v115
v_add_u32 v118, v112, v113
v_add_u32 v119, v118, v114
v_add_u32 v120, v119, v115
v_mov_b32 v121, v120
s_nop 1
v_add_u32_dpp v121, v121, v121 row_shr:1 row_mask:0xf bank_mask:0xf bound_ctrl:0
s_nop 1
v_add_u32_dpp v121, v121, v121 row_shr:2 row_mask:0xf bank_mask:0xf bound_ctrl:0
s_nop 1
v_add_u32_dpp v121, v121, v121 row_shr:4 row_mask:0xf bank_mask:0xf bound_ctrl:0
s_nop 1
v_add_u32_dpp v121, v121, v121 row_shr:8 row_mask:0xf bank_mask:0xf bound_ctrl:0
s_nop 1
v_add_u32_dpp v121, v121, v121 row_bcast:15 row_mask:0xa bank_mask:0xf
s_nop 1
v_add_u32_dpp v121, v121, v121 row_bcast:31 row_mask:0xc bank_mask:0xf
v_sub_u32 v116, v121, v120
v_add_u32 v117, v116, v112
v_add_u32 v118, v116, v118
v_add_u32 v119, v116, v119
v_readlane_b32 s61, v121, 63
v_lshl_or_b32 v112, v112, 16, v116
v_lshl_or_b32 v113, v113, 16, v117
v_lshl_or_b32 v114, v114, 16, v118
v_lshl_or_b32 v115, v115, 16, v119
v_mul_u32_u24 v116, 24, v116
v_mul_u32_u24 v117, 24, v117
v_mul_u32_u24 v118, 24, v118
v_mul_u32_u24 v119, 24, v119
ds_write_b128 v126, v[116:119] offset:2048
ds_write_b128 v126, v[4:7] offset:1024
s_cmp_lg_u32 s58, 0
s_cbranch_scc1 k1w0_5
s_add_u32 s50, s60, 2
s_lshl_b32 s50, s50, 10
buffer_store_dwordx4 v[112:115], v126, s[28:31], s50 offen
k1w0_5:
s_cmp_lg_u32 s58, 1
s_cbranch_scc1 k1w1_6
v_lshrrev_b32 v120, 2, v108
v_mad_u32_u24 v120, v120, 24, v116
v_and_b32 v121, 3, v108
v_add_u32 v121, -1, v121
v_cmp_gt_u32 vcc, 1, v121
v_mov_b32 v123, 196608
s_nop 0
v_cndmask_b32 v123, v123, v120, vcc
ds_write_b16 v123, v4 offset:3106
v_cmp_gt_u32 vcc, 2, v121
v_mov_b32 v123, 196608
s_nop 0
v_cndmask_b32 v123, v123, v120, vcc
ds_write_b16 v123, v4 offset:3108
v_cmp_gt_u32 vcc, 3, v121
v_mov_b32 v123, 196608
s_nop 0
v_cndmask_b32 v123, v123, v120, vcc
ds_write_b16 v123, v4 offset:3110
v_lshrrev_b32 v120, 2, v109
v_mad_u32_u24 v120, v120, 24, v117
v_and_b32 v121, 3, v109
v_add_u32 v121, -1, v121
v_cmp_gt_u32 vcc, 1, v121
v_mov_b32 v123, 196608
s_nop 0
v_cndmask_b32 v123, v123, v120, vcc
ds_write_b16 v123, v4 offset:3106
v_cmp_gt_u32 vcc, 2, v121
v_mov_b32 v123, 196608
s_nop 0
v_cndmask_b32 v123, v123, v120, vcc
ds_write_b16 v123, v4 offset:3108
v_cmp_gt_u32 vcc, 3, v121
v_mov_b32 v123, 196608
s_nop 0
v_cndmask_b32 v123, v123, v120, vcc
ds_write_b16 v123, v4 offset:3110
v_lshrrev_b32 v120, 2, v110
v_mad_u32_u24 v120, v120, 24, v118
v_and_b32 v121, 3, v110
v_add_u32 v121, -1, v121
v_cmp_gt_u32 vcc, 1, v121
v_mov_b32 v123, 196608
s_nop 0
v_cndmask_b32 v123, v123, v120, vcc
ds_write_b16 v123, v4 offset:3106
v_cmp_gt_u32 vcc, 2, v121
v_mov_b32 v123, 196608
s_nop 0
v_cndmask_b32 v123, v123, v120, vcc
ds_write_b16 v123, v4 offset:3108
v_cmp_gt_u32 vcc, 3, v121
v_mov_b32 v123, 196608
s_nop 0
v_cndmask_b32 v123, v123, v120, vcc
ds_write_b16 v123, v4 offset:3110
v_lshrrev_b32 v120, 2, v111
v_mad_u32_u24 v120, v120, 24, v119
v_and_b32 v121, 3, v111
v_add_u32 v121, -1, v121
v_cmp_gt_u32 vcc, 1, v121
v_mov_b32 v123, 196608
s_nop 0
v_cndmask_b32 v123, v123, v120, vcc
ds_write_b16 v123, v4 offset:3106
v_cmp_gt_u32 vcc, 2, v121
v_mov_b32 v123, 196608
s_nop 0
v_cndmask_b32 v123, v123, v120, vcc
ds_write_b16 v123, v4 offset:3108
v_cmp_gt_u32 vcc, 3, v121
v_mov_b32 v123, 196608
s_nop 0
v_cndmask_b32 v123, v123, v120, vcc
ds_write_b16 v123, v4 offset:3110
k1w1_6:
s_add_u32 s50, s60, 2
s_mul_i32 s51, s50, 124800
s_add_u32 s20, s52, s51
s_addc_u32 s21, s53, 0
s_and_b32 s21, s21, 0xffff
s_mul_i32 s22, s61, 24
s_add_u32 s22, s22, 127
s_and_b32 s22, s22, 0xffffff80
s_waitcnt lgkmcnt(0)
v_and_b32 v108, 0x3ff, v28
ds_read_b32 v108, v108 offset:2048
v_and_b32 v109, 0x3ff, v29
ds_read_b32 v109, v109 offset:2048
v_and_b32 v110, 0x3ff, v30
ds_read_b32 v110, v110 offset:2048
v_and_b32 v111, 0x3ff, v31
ds_read_b32 v111, v111 offset:2048
v_and_b32 v112, 0x3ff, v32
ds_read_b32 v112, v112 offset:2048
v_and_b32 v113, 0x3ff, v33
ds_read_b32 v113, v113 offset:2048
v_and_b32 v114, 0x3ff, v34
ds_read_b32 v114, v114 offset:2048
v_and_b32 v115, 0x3ff, v35
ds_read_b32 v115, v115 offset:2048
s_waitcnt lgkmcnt(0)
v_lshrrev_b32 v28, 10, v28
v_mad_u32_u24 v108, v28, 6, v108
v_and_b32 v116, 3, v28
v_mad_i32_i24 v117, v116, -2, v108
v_mad_i32_i24 v108, v116, -4, v108
ds_write_b32 v117, v8 offset:3088
ds_write_b16 v108, v48 offset:3104
v_lshrrev_b32 v29, 10, v29
v_mad_u32_u24 v109, v29, 6, v109
v_and_b32 v116, 3, v29
v_mad_i32_i24 v117, v116, -2, v109
v_mad_i32_i24 v109, v116, -4, v109
ds_write_b32 v117, v9 offset:3088
ds_write_b16_d16_hi v109, v48 offset:3104
v_lshrrev_b32 v30, 10, v30
v_mad_u32_u24 v110, v30, 6, v110
v_and_b32 v116, 3, v30
v_mad_i32_i24 v117, v116, -2, v110
v_mad_i32_i24 v110, v116, -4, v110
ds_write_b32 v117, v10 offset:3088
ds_write_b16 v110, v49 offset:3104
v_lshrrev_b32 v31, 10, v31
v_mad_u32_u24 v111, v31, 6, v111
v_and_b32 v116, 3, v31
v_mad_i32_i24 v117, v116, -2, v111
v_mad_i32_i24 v111, v116, -4, v111
ds_write_b32 v117, v11 offset:3088
ds_write_b16_d16_hi v111, v49 offset:3104
v_lshrrev_b32 v32, 10, v32
v_mad_u32_u24 v112, v32, 6, v112
v_and_b32 v116, 3, v32
v_mad_i32_i24 v117, v116, -2, v112
v_mad_i32_i24 v112, v116, -4, v112
ds_write_b32 v117, v12 offset:3088
ds_write_b16 v112, v50 offset:3104
v_lshrrev_b32 v33, 10, v33
v_mad_u32_u24 v113, v33, 6, v113
v_and_b32 v116, 3, v33
v_mad_i32_i24 v117, v116, -2, v113
v_mad_i32_i24 v113, v116, -4, v113
ds_write_b32 v117, v13 offset:3088
ds_write_b16_d16_hi v113, v50 offset:3104
v_lshrrev_b32 v34, 10, v34
v_mad_u32_u24 v114, v34, 6, v114
v_and_b32 v116, 3, v34
v_mad_i32_i24 v117, v116, -2, v114
v_mad_i32_i24 v114, v116, -4, v114
ds_write_b32 v117, v14 offset:3088
ds_write_b16 v114, v51 offset:3104
v_lshrrev_b32 v35, 10, v35
v_mad_u32_u24 v115, v35, 6, v115
v_and_b32 v116, 3, v35
v_mad_i32_i24 v117, v116, -2, v115
v_mad_i32_i24 v115, v116, -4, v115
ds_write_b32 v117, v15 offset:3088
ds_write_b16_d16_hi v115, v51 offset:3104
v_and_b32 v108, 0x3ff, v36
ds_read_b32 v108, v108 offset:2048
v_and_b32 v109, 0x3ff, v37
ds_read_b32 v109, v109 offset:2048
v_and_b32 v110, 0x3ff, v38
ds_read_b32 v110, v110 offset:2048
v_and_b32 v111, 0x3ff, v39
ds_read_b32 v111, v111 offset:2048
v_and_b32 v112, 0x3ff, v40
ds_read_b32 v112, v112 offset:2048
v_and_b32 v113, 0x3ff, v41
ds_read_b32 v113, v113 offset:2048
v_and_b32 v114, 0x3ff, v42
ds_read_b32 v114, v114 offset:2048
v_and_b32 v115, 0x3ff, v43
ds_read_b32 v115, v115 offset:2048
s_waitcnt lgkmcnt(0)
v_lshrrev_b32 v36, 10, v36
v_mad_u32_u24 v108, v36, 6, v108
v_and_b32 v116, 3, v36
v_mad_i32_i24 v117, v116, -2, v108
v_mad_i32_i24 v108, v116, -4, v108
ds_write_b32 v117, v16 offset:3088
ds_write_b16 v108, v52 offset:3104
v_lshrrev_b32 v37, 10, v37
v_mad_u32_u24 v109, v37, 6, v109
v_and_b32 v116, 3, v37
v_mad_i32_i24 v117, v116, -2, v109
v_mad_i32_i24 v109, v116, -4, v109
ds_write_b32 v117, v17 offset:3088
ds_write_b16_d16_hi v109, v52 offset:3104
v_lshrrev_b32 v38, 10, v38
v_mad_u32_u24 v110, v38, 6, v110
v_and_b32 v116, 3, v38
v_mad_i32_i24 v117, v116, -2, v110
v_mad_i32_i24 v110, v116, -4, v110
ds_write_b32 v117, v18 offset:3088
ds_write_b16 v110, v53 offset:3104
v_lshrrev_b32 v39, 10, v39
v_mad_u32_u24 v111, v39, 6, v111
v_and_b32 v116, 3, v39
v_mad_i32_i24 v117, v116, -2, v111
v_mad_i32_i24 v111, v116, -4, v111
ds_write_b32 v117, v19 offset:3088
ds_write_b16_d16_hi v111, v53 offset:3104
v_lshrrev_b32 v40, 10, v40
v_mad_u32_u24 v112, v40, 6, v112
v_and_b32 v116, 3, v40
v_mad_i32_i24 v117, v116, -2, v112
v_mad_i32_i24 v112, v116, -4, v112
ds_write_b32 v117, v20 offset:3088
ds_write_b16 v112, v54 offset:3104
v_lshrrev_b32 v41, 10, v41
v_mad_u32_u24 v113, v41, 6, v113
v_and_b32 v116, 3, v41
v_mad_i32_i24 v117, v116, -2, v113
v_mad_i32_i24 v113, v116, -4, v113
ds_write_b32 v117, v21 offset:3088
ds_write_b16_d16_hi v113, v54 offset:3104
v_lshrrev_b32 v42, 10, v42
v_mad_u32_u24 v114, v42, 6, v114
v_and_b32 v116, 3, v42
v_mad_i32_i24 v117, v116, -2, v114
v_mad_i32_i24 v114, v116, -4, v114
ds_write_b32 v117, v22 offset:3088
ds_write_b16 v114, v55 offset:3104
v_lshrrev_b32 v43, 10, v43
v_mad_u32_u24 v115, v43, 6, v115
v_and_b32 v116, 3, v43
v_mad_i32_i24 v117, v116, -2, v115
v_mad_i32_i24 v115, v116, -4, v115
ds_write_b32 v117, v23 offset:3088
ds_write_b16_d16_hi v115, v55 offset:3104
s_mov_b64 exec, s[56:57]
v_and_b32 v108, 0x3ff, v44
ds_read_b32 v108, v108 offset:2048
v_and_b32 v109, 0x3ff, v45
ds_read_b32 v109, v109 offset:2048
v_and_b32 v110, 0x3ff, v46
ds_read_b32 v110, v110 offset:2048
v_and_b32 v111, 0x3ff, v47
ds_read_b32 v111, v111 offset:2048
s_waitcnt lgkmcnt(0)
v_lshrrev_b32 v44, 10, v44
v_mad_u32_u24 v108, v44, 6, v108
v_and_b32 v116, 3, v44
v_mad_i32_i24 v117, v116, -2, v108
v_mad_i32_i24 v108, v116, -4, v108
ds_write_b32 v117, v24 offset:3088
ds_write_b16 v108, v56 offset:3104
v_lshrrev_b32 v45, 10, v45
v_mad_u32_u24 v109, v45, 6, v109
v_and_b32 v116, 3, v45
v_mad_i32_i24 v117, v116, -2, v109
v_mad_i32_i24 v109, v116, -4, v109
ds_write_b32 v117, v25 offset:3088
ds_write_b16_d16_hi v109, v56 offset:3104
v_lshrrev_b32 v46, 10, v46
v_mad_u32_u24 v110, v46, 6, v110
v_and_b32 v116, 3, v46
v_mad_i32_i24 v117, v116, -2, v110
v_mad_i32_i24 v110, v116, -4, v110
ds_write_b32 v117, v26 offset:3088
ds_write_b16 v110, v57 offset:3104
v_lshrrev_b32 v47, 10, v47
v_mad_u32_u24 v111, v47, 6, v111
v_and_b32 v116, 3, v47
v_mad_i32_i24 v117, v116, -2, v111
v_mad_i32_i24 v111, v116, -4, v111
ds_write_b32 v117, v27 offset:3088
ds_write_b16_d16_hi v111, v57 offset:3104
s_mov_b64 exec, -1
s_waitcnt lgkmcnt(0)
s_barrier
v_add_u32 v108, 0, v1
ds_read_b128 v[8:11], v108 offset:3088
v_add_u32 v109, 16384, v1
ds_read_b128 v[12:15], v109 offset:3088
v_add_u32 v110, 32768, v1
ds_read_b128 v[16:19], v110 offset:3088
v_add_u32 v111, 49152, v1
ds_read_b128 v[20:23], v111 offset:3088
v_add_u32 v112, 65536, v1
ds_read_b128 v[24:27], v112 offset:3088
v_add_u32 v113, 81920, v1
ds_read_b128 v[28:31], v113 offset:3088
v_add_u32 v114, 98304, v1
ds_read_b128 v[32:35], v114 offset:3088
v_add_u32 v115, 114688, v1
ds_read_b128 v[36:39], v115 offset:3088
s_waitcnt lgkmcnt(7)
buffer_store_dwordx4 v[8:11], v108, s[20:23], 0 offen sc1
s_waitcnt lgkmcnt(6)
buffer_store_dwordx4 v[12:15], v109, s[20:23], 0 offen sc1
s_waitcnt lgkmcnt(5)
buffer_store_dwordx4 v[16:19], v110, s[20:23], 0 offen sc1
s_waitcnt lgkmcnt(4)
buffer_store_dwordx4 v[20:23], v111, s[20:23], 0 offen sc1
s_waitcnt lgkmcnt(3)
buffer_store_dwordx4 v[24:27], v112, s[20:23], 0 offen sc1
s_waitcnt lgkmcnt(2)
buffer_store_dwordx4 v[28:31], v113, s[20:23], 0 offen sc1
s_waitcnt lgkmcnt(1)
buffer_store_dwordx4 v[32:35], v114, s[20:23], 0 offen sc1
s_waitcnt lgkmcnt(0)
buffer_store_dwordx4 v[36:39], v115, s[20:23], 0 offen sc1
s_waitcnt vmcnt(8)
v_lshrrev_b32 v116, 8, v58
v_lshrrev_b32 v117, 2, v58
v_bfi_b32 v116, 15, v58, v116
v_lshl_or_b32 v58, v78, 12, v116
v_and_b32 v78, 0x3fc, v117
ds_add_rtn_u32 v108, v78, v127 offset:1024
v_lshrrev_b32 v116, 8, v59
v_lshrrev_b32 v117, 2, v59
v_bfi_b32 v116, 15, v59, v116
v_lshl_or_b32 v59, v79, 12, v116
v_and_b32 v79, 0x3fc, v117
ds_add_rtn_u32 v109, v79, v127 offset:1024
v_lshrrev_b32 v116, 8, v60
v_lshrrev_b32 v117, 2, v60
v_bfi_b32 v116, 15, v60, v116
v_lshl_or_b32 v60, v80, 12, v116
v_and_b32 v80, 0x3fc, v117
ds_add_rtn_u32 v110, v80, v127 offset:1024
v_lshrrev_b32 v116, 8, v61
v_lshrrev_b32 v117, 2, v61
v_bfi_b32 v116, 15, v61, v116
v_lshl_or_b32 v61, v81, 12, v116
v_and_b32 v81, 0x3fc, v117
ds_add_rtn_u32 v111, v81, v127 offset:1024
v_lshlrev_b32 v118, 16, v98
v_and_b32 v119, 0xffff0000, v98
v_mul_f32 v118, v3, v118
v_mul_f32 v119, v3, v119
v_fract_f32 v118, v118
v_fract_f32 v119, v119
v_cos_f32 v118, v118
v_cos_f32 v119, v119
s_nop 0
v_cvt_pk_f16_f32 v98, v118, v119
v_lshlrev_b32 v118, 16, v99
v_and_b32 v119, 0xffff0000, v99
v_mul_f32 v118, v3, v118
v_mul_f32 v119, v3, v119
v_fract_f32 v118, v118
v_fract_f32 v119, v119
v_cos_f32 v118, v118
v_cos_f32 v119, v119
s_nop 0
v_cvt_pk_f16_f32 v99, v118, v119
v_lshrrev_b32 v116, 8, v62
v_lshrrev_b32 v117, 2, v62
v_bfi_b32 v116, 15, v62, v116
v_lshl_or_b32 v62, v82, 12, v116
v_and_b32 v82, 0x3fc, v117
ds_add_rtn_u32 v112, v82, v127 offset:1024
v_lshrrev_b32 v116, 8, v63
v_lshrrev_b32 v117, 2, v63
v_bfi_b32 v116, 15, v63, v116
v_lshl_or_b32 v63, v83, 12, v116
v_and_b32 v83, 0x3fc, v117
ds_add_rtn_u32 v113, v83, v127 offset:1024
v_lshrrev_b32 v116, 8, v64
v_lshrrev_b32 v117, 2, v64
v_bfi_b32 v116, 15, v64, v116
v_lshl_or_b32 v64, v84, 12, v116
v_and_b32 v84, 0x3fc, v117
ds_add_rtn_u32 v114, v84, v127 offset:1024
v_lshrrev_b32 v116, 8, v65
v_lshrrev_b32 v117, 2, v65
v_bfi_b32 v116, 15, v65, v116
v_lshl_or_b32 v65, v85, 12, v116
v_and_b32 v85, 0x3fc, v117
ds_add_rtn_u32 v115, v85, v127 offset:1024
v_lshlrev_b32 v118, 16, v100
v_and_b32 v119, 0xffff0000, v100
v_mul_f32 v118, v3, v118
v_mul_f32 v119, v3, v119
v_fract_f32 v118, v118
v_fract_f32 v119, v119
v_cos_f32 v118, v118
v_cos_f32 v119, v119
s_nop 0
v_cvt_pk_f16_f32 v100, v118, v119
v_lshlrev_b32 v118, 16, v101
v_and_b32 v119, 0xffff0000, v101
v_mul_f32 v118, v3, v118
v_mul_f32 v119, v3, v119
v_fract_f32 v118, v118
v_fract_f32 v119, v119
v_cos_f32 v118, v118
v_cos_f32 v119, v119
s_nop 0
v_cvt_pk_f16_f32 v101, v118, v119
s_waitcnt lgkmcnt(4)
v_lshl_or_b32 v78, v108, 10, v78
v_lshl_or_b32 v79, v109, 10, v79
v_lshl_or_b32 v80, v110, 10, v80
v_lshl_or_b32 v81, v111, 10, v81
v_lshrrev_b32 v116, 8, v66
v_lshrrev_b32 v117, 2, v66
v_bfi_b32 v116, 15, v66, v116
v_lshl_or_b32 v66, v86, 12, v116
v_and_b32 v86, 0x3fc, v117
ds_add_rtn_u32 v108, v86, v127 offset:1024
v_lshrrev_b32 v116, 8, v67
v_lshrrev_b32 v117, 2, v67
v_bfi_b32 v116, 15, v67, v116
v_lshl_or_b32 v67, v87, 12, v116
v_and_b32 v87, 0x3fc, v117
ds_add_rtn_u32 v109, v87, v127 offset:1024
v_lshrrev_b32 v116, 8, v68
v_lshrrev_b32 v117, 2, v68
v_bfi_b32 v116, 15, v68, v116
v_lshl_or_b32 v68, v88, 12, v116
v_and_b32 v88, 0x3fc, v117
ds_add_rtn_u32 v110, v88, v127 offset:1024
v_lshrrev_b32 v116, 8, v69
v_lshrrev_b32 v117, 2, v69
v_bfi_b32 v116, 15, v69, v116
v_lshl_or_b32 v69, v89, 12, v116
v_and_b32 v89, 0x3fc, v117
ds_add_rtn_u32 v111, v89, v127 offset:1024
v_lshlrev_b32 v118, 16, v102
v_and_b32 v119, 0xffff0000, v102
v_mul_f32 v118, v3, v118
v_mul_f32 v119, v3, v119
v_fract_f32 v118, v118
v_fract_f32 v119, v119
v_cos_f32 v118, v118
v_cos_f32 v119, v119
s_nop 0
v_cvt_pk_f16_f32 v102, v118, v119
v_lshlrev_b32 v118, 16, v103
v_and_b32 v119, 0xffff0000, v103
v_mul_f32 v118, v3, v118
v_mul_f32 v119, v3, v119
v_fract_f32 v118, v118
v_fract_f32 v119, v119
v_cos_f32 v118, v118
v_cos_f32 v119, v119
s_nop 0
v_cvt_pk_f16_f32 v103, v118, v119
s_waitcnt lgkmcnt(4)
v_lshl_or_b32 v82, v112, 10, v82
v_lshl_or_b32 v83, v113, 10, v83
v_lshl_or_b32 v84, v114, 10, v84
v_lshl_or_b32 v85, v115, 10, v85
v_lshrrev_b32 v116, 8, v70
v_lshrrev_b32 v117, 2, v70
v_bfi_b32 v116, 15, v70, v116
v_lshl_or_b32 v70, v90, 12, v116
v_and_b32 v90, 0x3fc, v117
ds_add_rtn_u32 v112, v90, v127 offset:1024
v_lshrrev_b32 v116, 8, v71
v_lshrrev_b32 v117, 2, v71
v_bfi_b32 v116, 15, v71, v116
v_lshl_or_b32 v71, v91, 12, v116
v_and_b32 v91, 0x3fc, v117
ds_add_rtn_u32 v113, v91, v127 offset:1024
v_lshrrev_b32 v116, 8, v72
v_lshrrev_b32 v117, 2, v72
v_bfi_b32 v116, 15, v72, v116
v_lshl_or_b32 v72, v92, 12, v116
v_and_b32 v92, 0x3fc, v117
ds_add_rtn_u32 v114, v92, v127 offset:1024
v_lshrrev_b32 v116, 8, v73
v_lshrrev_b32 v117, 2, v73
v_bfi_b32 v116, 15, v73, v116
v_lshl_or_b32 v73, v93, 12, v116
v_and_b32 v93, 0x3fc, v117
ds_add_rtn_u32 v115, v93, v127 offset:1024
v_lshlrev_b32 v118, 16, v104
v_and_b32 v119, 0xffff0000, v104
v_mul_f32 v118, v3, v118
v_mul_f32 v119, v3, v119
v_fract_f32 v118, v118
v_fract_f32 v119, v119
v_cos_f32 v118, v118
v_cos_f32 v119, v119
s_nop 0
v_cvt_pk_f16_f32 v104, v118, v119
v_lshlrev_b32 v118, 16, v105
v_and_b32 v119, 0xffff0000, v105
v_mul_f32 v118, v3, v118
v_mul_f32 v119, v3, v119
v_fract_f32 v118, v118
v_fract_f32 v119, v119
v_cos_f32 v118, v118
v_cos_f32 v119, v119
s_nop 0
v_cvt_pk_f16_f32 v105, v118, v119
s_waitcnt lgkmcnt(4)
v_lshl_or_b32 v86, v108, 10, v86
v_lshl_or_b32 v87, v109, 10, v87
v_lshl_or_b32 v88, v110, 10, v88
v_lshl_or_b32 v89, v111, 10, v89
s_waitcnt lgkmcnt(0)
v_lshl_or_b32 v90, v112, 10, v90
v_lshl_or_b32 v91, v113, 10, v91
v_lshl_or_b32 v92, v114, 10, v92
v_lshl_or_b32 v93, v115, 10, v93
s_mov_b64 exec, s[56:57]
v_lshrrev_b32 v116, 8, v74
v_lshrrev_b32 v117, 2, v74
v_bfi_b32 v116, 15, v74, v116
v_lshl_or_b32 v74, v94, 12, v116
v_and_b32 v94, 0x3fc, v117
ds_add_rtn_u32 v108, v94, v127 offset:1024
v_lshrrev_b32 v116, 8, v75
v_lshrrev_b32 v117, 2, v75
v_bfi_b32 v116, 15, v75, v116
v_lshl_or_b32 v75, v95, 12, v116
v_and_b32 v95, 0x3fc, v117
ds_add_rtn_u32 v109, v95, v127 offset:1024
v_lshrrev_b32 v116, 8, v76
v_lshrrev_b32 v117, 2, v76
v_bfi_b32 v116, 15, v76, v116
v_lshl_or_b32 v76, v96, 12, v116
v_and_b32 v96, 0x3fc, v117
ds_add_rtn_u32 v110, v96, v127 offset:1024
v_lshrrev_b32 v116, 8, v77
v_lshrrev_b32 v117, 2, v77
v_bfi_b32 v116, 15, v77, v116
v_lshl_or_b32 v77, v97, 12, v116
v_and_b32 v97, 0x3fc, v117
ds_add_rtn_u32 v111, v97, v127 offset:1024
v_lshlrev_b32 v118, 16, v106
v_and_b32 v119, 0xffff0000, v106
v_mul_f32 v118, v3, v118
v_mul_f32 v119, v3, v119
v_fract_f32 v118, v118
v_fract_f32 v119, v119
v_cos_f32 v118, v118
v_cos_f32 v119, v119
s_nop 0
v_cvt_pk_f16_f32 v106, v118, v119
v_lshlrev_b32 v118, 16, v107
v_and_b32 v119, 0xffff0000, v107
v_mul_f32 v118, v3, v118
v_mul_f32 v119, v3, v119
v_fract_f32 v118, v118
v_fract_f32 v119, v119
v_cos_f32 v118, v118
v_cos_f32 v119, v119
s_nop 0
v_cvt_pk_f16_f32 v107, v118, v119
s_waitcnt lgkmcnt(0)
v_lshl_or_b32 v94, v108, 10, v94
v_lshl_or_b32 v95, v109, 10, v95
v_lshl_or_b32 v96, v110, 10, v96
v_lshl_or_b32 v97, v111, 10, v97
s_mov_b64 exec, -1
s_barrier
s_add_u32 s50, s59, 320000
s_lshr_b32 s51, s50, 1
buffer_load_dwordx4 v[8:11], v1, s[8:11], s50 offen nt
buffer_load_dwordx4 v[28:31], v1, s[12:15], s50 offen nt
buffer_load_dwordx2 v[48:49], v2, s[16:19], s51 offen nt
s_add_u32 s50, s59, 336384
s_lshr_b32 s51, s50, 1
buffer_load_dwordx4 v[12:15], v1, s[8:11], s50 offen nt
buffer_load_dwordx4 v[32:35], v1, s[12:15], s50 offen nt
buffer_load_dwordx2 v[50:51], v2, s[16:19], s51 offen nt
s_add_u32 s50, s59, 352768
s_lshr_b32 s51, s50, 1
buffer_load_dwordx4 v[16:19], v1, s[8:11], s50 offen nt
buffer_load_dwordx4 v[36:39], v1, s[12:15], s50 offen nt
buffer_load_dwordx2 v[52:53], v2, s[16:19], s51 offen nt
s_add_u32 s50, s59, 369152
s_lshr_b32 s51, s50, 1
buffer_load_dwordx4 v[20:23], v1, s[8:11], s50 offen nt
buffer_load_dwordx4 v[40:43], v1, s[12:15], s50 offen nt
buffer_load_dwordx2 v[54:55], v2, s[16:19], s51 offen nt
s_add_u32 s50, s59, 385536
s_lshr_b32 s51, s50, 1
buffer_load_dwordx4 v[24:27], v124, s[8:11], s50 offen nt
buffer_load_dwordx4 v[44:47], v124, s[12:15], s50 offen nt
buffer_load_dwordx2 v[56:57], v125, s[16:19], s51 offen nt
ds_read_b128 v[108:111], v126 offset:1024
s_waitcnt lgkmcnt(0)
v_add_u32 v112, 3, v108
v_lshrrev_b32 v112, 2, v112
v_add_u32 v113, 3, v109
v_lshrrev_b32 v113, 2, v113
v_add_u32 v114, 3, v110
v_lshrrev_b32 v114, 2, v114
v_add_u32 v115, 3, v111
v_lshrrev_b32 v115, 2, v115
v_add_u32 v118, v112, v113
v_add_u32 v119, v118, v114
v_add_u32 v120, v119, v115
v_mov_b32 v121, v120
s_nop 1
v_add_u32_dpp v121, v121, v121 row_shr:1 row_mask:0xf bank_mask:0xf bound_ctrl:0
s_nop 1
v_add_u32_dpp v121, v121, v121 row_shr:2 row_mask:0xf bank_mask:0xf bound_ctrl:0
s_nop 1
v_add_u32_dpp v121, v121, v121 row_shr:4 row_mask:0xf bank_mask:0xf bound_ctrl:0
s_nop 1
v_add_u32_dpp v121, v121, v121 row_shr:8 row_mask:0xf bank_mask:0xf bound_ctrl:0
s_nop 1
v_add_u32_dpp v121, v121, v121 row_bcast:15 row_mask:0xa bank_mask:0xf
s_nop 1
v_add_u32_dpp v121, v121, v121 row_bcast:31 row_mask:0xc bank_mask:0xf
v_sub_u32 v116, v121, v120
v_add_u32 v117, v116, v112
v_add_u32 v118, v116, v118
v_add_u32 v119, v116, v119
v_readlane_b32 s61, v121, 63
v_lshl_or_b32 v112, v112, 16, v116
v_lshl_or_b32 v113, v113, 16, v117
v_lshl_or_b32 v114, v114, 16, v118
v_lshl_or_b32 v115, v115, 16, v119
v_mul_u32_u24 v116, 24, v116
v_mul_u32_u24 v117, 24, v117
v_mul_u32_u24 v118, 24, v118
v_mul_u32_u24 v119, 24, v119
ds_write_b128 v126, v[116:119] offset:2048
ds_write_b128 v126, v[4:7] offset:0
s_cmp_lg_u32 s58, 0
s_cbranch_scc1 k1w0_7
s_add_u32 s50, s60, 3
s_lshl_b32 s50, s50, 10
buffer_store_dwordx4 v[112:115], v126, s[28:31], s50 offen
k1w0_7:
s_cmp_lg_u32 s58, 1
s_cbranch_scc1 k1w1_8
v_lshrrev_b32 v120, 2, v108
v_mad_u32_u24 v120, v120, 24, v116
v_and_b32 v121, 3, v108
v_add_u32 v121, -1, v121
v_cmp_gt_u32 vcc, 1, v121
v_mov_b32 v123, 196608
s_nop 0
v_cndmask_b32 v123, v123, v120, vcc
ds_write_b16 v123, v4 offset:3106
v_cmp_gt_u32 vcc, 2, v121
v_mov_b32 v123, 196608
s_nop 0
v_cndmask_b32 v123, v123, v120, vcc
ds_write_b16 v123, v4 offset:3108
v_cmp_gt_u32 vcc, 3, v121
v_mov_b32 v123, 196608
s_nop 0
v_cndmask_b32 v123, v123, v120, vcc
ds_write_b16 v123, v4 offset:3110
v_lshrrev_b32 v120, 2, v109
v_mad_u32_u24 v120, v120, 24, v117
v_and_b32 v121, 3, v109
v_add_u32 v121, -1, v121
v_cmp_gt_u32 vcc, 1, v121
v_mov_b32 v123, 196608
s_nop 0
v_cndmask_b32 v123, v123, v120, vcc
ds_write_b16 v123, v4 offset:3106
v_cmp_gt_u32 vcc, 2, v121
v_mov_b32 v123, 196608
s_nop 0
v_cndmask_b32 v123, v123, v120, vcc
ds_write_b16 v123, v4 offset:3108
v_cmp_gt_u32 vcc, 3, v121
v_mov_b32 v123, 196608
s_nop 0
v_cndmask_b32 v123, v123, v120, vcc
ds_write_b16 v123, v4 offset:3110
v_lshrrev_b32 v120, 2, v110
v_mad_u32_u24 v120, v120, 24, v118
v_and_b32 v121, 3, v110
v_add_u32 v121, -1, v121
v_cmp_gt_u32 vcc, 1, v121
v_mov_b32 v123, 196608
s_nop 0
v_cndmask_b32 v123, v123, v120, vcc
ds_write_b16 v123, v4 offset:3106
v_cmp_gt_u32 vcc, 2, v121
v_mov_b32 v123, 196608
s_nop 0
v_cndmask_b32 v123, v123, v120, vcc
ds_write_b16 v123, v4 offset:3108
v_cmp_gt_u32 vcc, 3, v121
v_mov_b32 v123, 196608
s_nop 0
v_cndmask_b32 v123, v123, v120, vcc
ds_write_b16 v123, v4 offset:3110
v_lshrrev_b32 v120, 2, v111
v_mad_u32_u24 v120, v120, 24, v119
v_and_b32 v121, 3, v111
v_add_u32 v121, -1, v121
v_cmp_gt_u32 vcc, 1, v121
v_mov_b32 v123, 196608
s_nop 0
v_cndmask_b32 v123, v123, v120, vcc
ds_write_b16 v123, v4 offset:3106
v_cmp_gt_u32 vcc, 2, v121
v_mov_b32 v123, 196608
s_nop 0
v_cndmask_b32 v123, v123, v120, vcc
ds_write_b16 v123, v4 offset:3108
v_cmp_gt_u32 vcc, 3, v121
v_mov_b32 v123, 196608
s_nop 0
v_cndmask_b32 v123, v123, v120, vcc
ds_write_b16 v123, v4 offset:3110
k1w1_8:
s_add_u32 s50, s60, 3
s_mul_i32 s51, s50, 124800
s_add_u32 s20, s52, s51
s_addc_u32 s21, s53, 0
s_and_b32 s21, s21, 0xffff
s_mul_i32 s22, s61, 24
s_add_u32 s22, s22, 127
s_and_b32 s22, s22, 0xffffff80
s_waitcnt lgkmcnt(0)
v_and_b32 v108, 0x3ff, v78
ds_read_b32 v108, v108 offset:2048
v_and_b32 v109, 0x3ff, v79
ds_read_b32 v109, v109 offset:2048
v_and_b32 v110, 0x3ff, v80
ds_read_b32 v110, v110 offset:2048
v_and_b32 v111, 0x3ff, v81
ds_read_b32 v111, v111 offset:2048
v_and_b32 v112, 0x3ff, v82
ds_read_b32 v112, v112 offset:2048
v_and_b32 v113, 0x3ff, v83
ds_read_b32 v113, v113 offset:2048
v_and_b32 v114, 0x3ff, v84
ds_read_b32 v114, v114 offset:2048
v_and_b32 v115, 0x3ff, v85
ds_read_b32 v115, v115 offset:2048
s_waitcnt lgkmcnt(0)
v_lshrrev_b32 v78, 10, v78
v_mad_u32_u24 v108, v78, 6, v108
v_and_b32 v116, 3, v78
v_mad_i32_i24 v117, v116, -2, v108
v_mad_i32_i24 v108, v116, -4, v108
ds_write_b32 v117, v58 offset:3088
ds_write_b16 v108, v98 offset:3104
v_lshrrev_b32 v79, 10, v79
v_mad_u32_u24 v109, v79, 6, v109
v_and_b32 v116, 3, v79
v_mad_i32_i24 v117, v116, -2, v109
v_mad_i32_i24 v109, v116, -4, v109
ds_write_b32 v117, v59 offset:3088
ds_write_b16_d16_hi v109, v98 offset:3104
v_lshrrev_b32 v80, 10, v80
v_mad_u32_u24 v110, v80, 6, v110
v_and_b32 v116, 3, v80
v_mad_i32_i24 v117, v116, -2, v110
v_mad_i32_i24 v110, v116, -4, v110
ds_write_b32 v117, v60 offset:3088
ds_write_b16 v110, v99 offset:3104
v_lshrrev_b32 v81, 10, v81
v_mad_u32_u24 v111, v81, 6, v111
v_and_b32 v116, 3, v81
v_mad_i32_i24 v117, v116, -2, v111
v_mad_i32_i24 v111, v116, -4, v111
ds_write_b32 v117, v61 offset:3088
ds_write_b16_d16_hi v111, v99 offset:3104
v_lshrrev_b32 v82, 10, v82
v_mad_u32_u24 v112, v82, 6, v112
v_and_b32 v116, 3, v82
v_mad_i32_i24 v117, v116, -2, v112
v_mad_i32_i24 v112, v116, -4, v112
ds_write_b32 v117, v62 offset:3088
ds_write_b16 v112, v100 offset:3104
v_lshrrev_b32 v83, 10, v83
v_mad_u32_u24 v113, v83, 6, v113
v_and_b32 v116, 3, v83
v_mad_i32_i24 v117, v116, -2, v113
v_mad_i32_i24 v113, v116, -4, v113
ds_write_b32 v117, v63 offset:3088
ds_write_b16_d16_hi v113, v100 offset:3104
v_lshrrev_b32 v84, 10, v84
v_mad_u32_u24 v114, v84, 6, v114
v_and_b32 v116, 3, v84
v_mad_i32_i24 v117, v116, -2, v114
v_mad_i32_i24 v114, v116, -4, v114
ds_write_b32 v117, v64 offset:3088
ds_write_b16 v114, v101 offset:3104
v_lshrrev_b32 v85, 10, v85
v_mad_u32_u24 v115, v85, 6, v115
v_and_b32 v116, 3, v85
v_mad_i32_i24 v117, v116, -2, v115
v_mad_i32_i24 v115, v116, -4, v115
ds_write_b32 v117, v65 offset:3088
ds_write_b16_d16_hi v115, v101 offset:3104
v_and_b32 v108, 0x3ff, v86
ds_read_b32 v108, v108 offset:2048
v_and_b32 v109, 0x3ff, v87
ds_read_b32 v109, v109 offset:2048
v_and_b32 v110, 0x3ff, v88
ds_read_b32 v110, v110 offset:2048
v_and_b32 v111, 0x3ff, v89
ds_read_b32 v111, v111 offset:2048
v_and_b32 v112, 0x3ff, v90
ds_read_b32 v112, v112 offset:2048
v_and_b32 v113, 0x3ff, v91
ds_read_b32 v113, v113 offset:2048
v_and_b32 v114, 0x3ff, v92
ds_read_b32 v114, v114 offset:2048
v_and_b32 v115, 0x3ff, v93
ds_read_b32 v115, v115 offset:2048
s_waitcnt lgkmcnt(0)
v_lshrrev_b32 v86, 10, v86
v_mad_u32_u24 v108, v86, 6, v108
v_and_b32 v116, 3, v86
v_mad_i32_i24 v117, v116, -2, v108
v_mad_i32_i24 v108, v116, -4, v108
ds_write_b32 v117, v66 offset:3088
ds_write_b16 v108, v102 offset:3104
v_lshrrev_b32 v87, 10, v87
v_mad_u32_u24 v109, v87, 6, v109
v_and_b32 v116, 3, v87
v_mad_i32_i24 v117, v116, -2, v109
v_mad_i32_i24 v109, v116, -4, v109
ds_write_b32 v117, v67 offset:3088
ds_write_b16_d16_hi v109, v102 offset:3104
v_lshrrev_b32 v88, 10, v88
v_mad_u32_u24 v110, v88, 6, v110
v_and_b32 v116, 3, v88
v_mad_i32_i24 v117, v116, -2, v110
v_mad_i32_i24 v110, v116, -4, v110
ds_write_b32 v117, v68 offset:3088
ds_write_b16 v110, v103 offset:3104
v_lshrrev_b32 v89, 10, v89
v_mad_u32_u24 v111, v89, 6, v111
v_and_b32 v116, 3, v89
v_mad_i32_i24 v117, v116, -2, v111
v_mad_i32_i24 v111, v116, -4, v111
ds_write_b32 v117, v69 offset:3088
ds_write_b16_d16_hi v111, v103 offset:3104
v_lshrrev_b32 v90, 10, v90
v_mad_u32_u24 v112, v90, 6, v112
v_and_b32 v116, 3, v90
v_mad_i32_i24 v117, v116, -2, v112
v_mad_i32_i24 v112, v116, -4, v112
ds_write_b32 v117, v70 offset:3088
ds_write_b16 v112, v104 offset:3104
v_lshrrev_b32 v91, 10, v91
v_mad_u32_u24 v113, v91, 6, v113
v_and_b32 v116, 3, v91
v_mad_i32_i24 v117, v116, -2, v113
v_mad_i32_i24 v113, v116, -4, v113
ds_write_b32 v117, v71 offset:3088
ds_write_b16_d16_hi v113, v104 offset:3104
v_lshrrev_b32 v92, 10, v92
v_mad_u32_u24 v114, v92, 6, v114
v_and_b32 v116, 3, v92
v_mad_i32_i24 v117, v116, -2, v114
v_mad_i32_i24 v114, v116, -4, v114
ds_write_b32 v117, v72 offset:3088
ds_write_b16 v114, v105 offset:3104
v_lshrrev_b32 v93, 10, v93
v_mad_u32_u24 v115, v93, 6, v115
v_and_b32 v116, 3, v93
v_mad_i32_i24 v117, v116, -2, v115
v_mad_i32_i24 v115, v116, -4, v115
ds_write_b32 v117, v73 offset:3088
ds_write_b16_d16_hi v115, v105 offset:3104
s_mov_b64 exec, s[56:57]
v_and_b32 v108, 0x3ff, v94
ds_read_b32 v108, v108 offset:2048
v_and_b32 v109, 0x3ff, v95
ds_read_b32 v109, v109 offset:2048
v_and_b32 v110, 0x3ff, v96
ds_read_b32 v110, v110 offset:2048
v_and_b32 v111, 0x3ff, v97
ds_read_b32 v111, v111 offset:2048
s_waitcnt lgkmcnt(0)
v_lshrrev_b32 v94, 10, v94
v_mad_u32_u24 v108, v94, 6, v108
v_and_b32 v116, 3, v94
v_mad_i32_i24 v117, v116, -2, v108
v_mad_i32_i24 v108, v116, -4, v108
ds_write_b32 v117, v74 offset:3088
ds_write_b16 v108, v106 offset:3104
v_lshrrev_b32 v95, 10, v95
v_mad_u32_u24 v109, v95, 6, v109
v_and_b32 v116, 3, v95
v_mad_i32_i24 v117, v116, -2, v109
v_mad_i32_i24 v109, v116, -4, v109
ds_write_b32 v117, v75 offset:3088
ds_write_b16_d16_hi v109, v106 offset:3104
v_lshrrev_b32 v96, 10, v96
v_mad_u32_u24 v110, v96, 6, v110
v_and_b32 v116, 3, v96
v_mad_i32_i24 v117, v116, -2, v110
v_mad_i32_i24 v110, v116, -4, v110
ds_write_b32 v117, v76 offset:3088
ds_write_b16 v110, v107 offset:3104
v_lshrrev_b32 v97, 10, v97
v_mad_u32_u24 v111, v97, 6, v111
v_and_b32 v116, 3, v97
v_mad_i32_i24 v117, v116, -2, v111
v_mad_i32_i24 v111, v116, -4, v111
ds_write_b32 v117, v77 offset:3088
ds_write_b16_d16_hi v111, v107 offset:3104
s_mov_b64 exec, -1
s_waitcnt lgkmcnt(0)
s_barrier
v_add_u32 v108, 0, v1
ds_read_b128 v[58:61], v108 offset:3088
v_add_u32 v109, 16384, v1
ds_read_b128 v[62:65], v109 offset:3088
v_add_u32 v110, 32768, v1
ds_read_b128 v[66:69], v110 offset:3088
v_add_u32 v111, 49152, v1
ds_read_b128 v[70:73], v111 offset:3088
v_add_u32 v112, 65536, v1
ds_read_b128 v[74:77], v112 offset:3088
v_add_u32 v113, 81920, v1
ds_read_b128 v[78:81], v113 offset:3088
v_add_u32 v114, 98304, v1
ds_read_b128 v[82:85], v114 offset:3088
v_add_u32 v115, 114688, v1
ds_read_b128 v[86:89], v115 offset:3088
s_waitcnt lgkmcnt(7)
buffer_store_dwordx4 v[58:61], v108, s[20:23], 0 offen sc1
s_waitcnt lgkmcnt(6)
buffer_store_dwordx4 v[62:65], v109, s[20:23], 0 offen sc1
s_waitcnt lgkmcnt(5)
buffer_store_dwordx4 v[66:69], v110, s[20:23], 0 offen sc1
s_waitcnt lgkmcnt(4)
buffer_store_dwordx4 v[70:73], v111, s[20:23], 0 offen sc1
s_waitcnt lgkmcnt(3)
buffer_store_dwordx4 v[74:77], v112, s[20:23], 0 offen sc1
s_waitcnt lgkmcnt(2)
buffer_store_dwordx4 v[78:81], v113, s[20:23], 0 offen sc1
s_waitcnt lgkmcnt(1)
buffer_store_dwordx4 v[82:85], v114, s[20:23], 0 offen sc1
s_waitcnt lgkmcnt(0)
buffer_store_dwordx4 v[86:89], v115, s[20:23], 0 offen sc1
s_waitcnt vmcnt(8)
v_lshrrev_b32 v116, 8, v8
v_lshrrev_b32 v117, 2, v8
v_bfi_b32 v116, 15, v8, v116
v_lshl_or_b32 v8, v28, 12, v116
v_and_b32 v28, 0x3fc, v117
ds_add_rtn_u32 v108, v28, v127 offset:0
v_lshrrev_b32 v116, 8, v9
v_lshrrev_b32 v117, 2, v9
v_bfi_b32 v116, 15, v9, v116
v_lshl_or_b32 v9, v29, 12, v116
v_and_b32 v29, 0x3fc, v117
ds_add_rtn_u32 v109, v29, v127 offset:0
v_lshrrev_b32 v116, 8, v10
v_lshrrev_b32 v117, 2, v10
v_bfi_b32 v116, 15, v10, v116
v_lshl_or_b32 v10, v30, 12, v116
v_and_b32 v30, 0x3fc, v117
ds_add_rtn_u32 v110, v30, v127 offset:0
v_lshrrev_b32 v116, 8, v11
v_lshrrev_b32 v117, 2, v11
v_bfi_b32 v116, 15, v11, v116
v_lshl_or_b32 v11, v31, 12, v116
v_and_b32 v31, 0x3fc, v117
ds_add_rtn_u32 v111, v31, v127 offset:0
v_lshlrev_b32 v118, 16, v48
v_and_b32 v119, 0xffff0000, v48
v_mul_f32 v118, v3, v118
v_mul_f32 v119, v3, v119
v_fract_f32 v118, v118
v_fract_f32 v119, v119
v_cos_f32 v118, v118
v_cos_f32 v119, v119
s_nop 0
v_cvt_pk_f16_f32 v48, v118, v119
v_lshlrev_b32 v118, 16, v49
v_and_b32 v119, 0xffff0000, v49
v_mul_f32 v118, v3, v118
v_mul_f32 v119, v3, v119
v_fract_f32 v118, v118
v_fract_f32 v119, v119
v_cos_f32 v118, v118
v_cos_f32 v119, v119
s_nop 0
v_cvt_pk_f16_f32 v49, v118, v119
v_lshrrev_b32 v116, 8, v12
v_lshrrev_b32 v117, 2, v12
v_bfi_b32 v116, 15, v12, v116
v_lshl_or_b32 v12, v32, 12, v116
v_and_b32 v32, 0x3fc, v117
ds_add_rtn_u32 v112, v32, v127 offset:0
v_lshrrev_b32 v116, 8, v13
v_lshrrev_b32 v117, 2, v13
v_bfi_b32 v116, 15, v13, v116
v_lshl_or_b32 v13, v33, 12, v116
v_and_b32 v33, 0x3fc, v117
ds_add_rtn_u32 v113, v33, v127 offset:0
v_lshrrev_b32 v116, 8, v14
v_lshrrev_b32 v117, 2, v14
v_bfi_b32 v116, 15, v14, v116
v_lshl_or_b32 v14, v34, 12, v116
v_and_b32 v34, 0x3fc, v117
ds_add_rtn_u32 v114, v34, v127 offset:0
v_lshrrev_b32 v116, 8, v15
v_lshrrev_b32 v117, 2, v15
v_bfi_b32 v116, 15, v15, v116
v_lshl_or_b32 v15, v35, 12, v116
v_and_b32 v35, 0x3fc, v117
ds_add_rtn_u32 v115, v35, v127 offset:0
v_lshlrev_b32 v118, 16, v50
v_and_b32 v119, 0xffff0000, v50
v_mul_f32 v118, v3, v118
v_mul_f32 v119, v3, v119
v_fract_f32 v118, v118
v_fract_f32 v119, v119
v_cos_f32 v118, v118
v_cos_f32 v119, v119
s_nop 0
v_cvt_pk_f16_f32 v50, v118, v119
v_lshlrev_b32 v118, 16, v51
v_and_b32 v119, 0xffff0000, v51
v_mul_f32 v118, v3, v118
v_mul_f32 v119, v3, v119
v_fract_f32 v118, v118
v_fract_f32 v119, v119
v_cos_f32 v118, v118
v_cos_f32 v119, v119
s_nop 0
v_cvt_pk_f16_f32 v51, v118, v119
s_waitcnt lgkmcnt(4)
v_lshl_or_b32 v28, v108, 10, v28
v_lshl_or_b32 v29, v109, 10, v29
v_lshl_or_b32 v30, v110, 10, v30
v_lshl_or_b32 v31, v111, 10, v31
v_lshrrev_b32 v116, 8, v16
v_lshrrev_b32 v117, 2, v16
v_bfi_b32 v116, 15, v16, v116
v_lshl_or_b32 v16, v36, 12, v116
v_and_b32 v36, 0x3fc, v117
ds_add_rtn_u32 v108, v36, v127 offset:0
v_lshrrev_b32 v116, 8, v17
v_lshrrev_b32 v117, 2, v17
v_bfi_b32 v116, 15, v17, v116
v_lshl_or_b32 v17, v37, 12, v116
v_and_b32 v37, 0x3fc, v117
ds_add_rtn_u32 v109, v37, v127 offset:0
v_lshrrev_b32 v116, 8, v18
v_lshrrev_b32 v117, 2, v18
v_bfi_b32 v116, 15, v18, v116
v_lshl_or_b32 v18, v38, 12, v116
v_and_b32 v38, 0x3fc, v117
ds_add_rtn_u32 v110, v38, v127 offset:0
v_lshrrev_b32 v116, 8, v19
v_lshrrev_b32 v117, 2, v19
v_bfi_b32 v116, 15, v19, v116
v_lshl_or_b32 v19, v39, 12, v116
v_and_b32 v39, 0x3fc, v117
ds_add_rtn_u32 v111, v39, v127 offset:0
v_lshlrev_b32 v118, 16, v52
v_and_b32 v119, 0xffff0000, v52
v_mul_f32 v118, v3, v118
v_mul_f32 v119, v3, v119
v_fract_f32 v118, v118
v_fract_f32 v119, v119
v_cos_f32 v118, v118
v_cos_f32 v119, v119
s_nop 0
v_cvt_pk_f16_f32 v52, v118, v119
v_lshlrev_b32 v118, 16, v53
v_and_b32 v119, 0xffff0000, v53
v_mul_f32 v118, v3, v118
v_mul_f32 v119, v3, v119
v_fract_f32 v118, v118
v_fract_f32 v119, v119
v_cos_f32 v118, v118
v_cos_f32 v119, v119
s_nop 0
v_cvt_pk_f16_f32 v53, v118, v119
s_waitcnt lgkmcnt(4)
v_lshl_or_b32 v32, v112, 10, v32
v_lshl_or_b32 v33, v113, 10, v33
v_lshl_or_b32 v34, v114, 10, v34
v_lshl_or_b32 v35, v115, 10, v35
v_lshrrev_b32 v116, 8, v20
v_lshrrev_b32 v117, 2, v20
v_bfi_b32 v116, 15, v20, v116
v_lshl_or_b32 v20, v40, 12, v116
v_and_b32 v40, 0x3fc, v117
ds_add_rtn_u32 v112, v40, v127 offset:0
v_lshrrev_b32 v116, 8, v21
v_lshrrev_b32 v117, 2, v21
v_bfi_b32 v116, 15, v21, v116
v_lshl_or_b32 v21, v41, 12, v116
v_and_b32 v41, 0x3fc, v117
ds_add_rtn_u32 v113, v41, v127 offset:0
v_lshrrev_b32 v116, 8, v22
v_lshrrev_b32 v117, 2, v22
v_bfi_b32 v116, 15, v22, v116
v_lshl_or_b32 v22, v42, 12, v116
v_and_b32 v42, 0x3fc, v117
ds_add_rtn_u32 v114, v42, v127 offset:0
v_lshrrev_b32 v116, 8, v23
v_lshrrev_b32 v117, 2, v23
v_bfi_b32 v116, 15, v23, v116
v_lshl_or_b32 v23, v43, 12, v116
v_and_b32 v43, 0x3fc, v117
ds_add_rtn_u32 v115, v43, v127 offset:0
v_lshlrev_b32 v118, 16, v54
v_and_b32 v119, 0xffff0000, v54
v_mul_f32 v118, v3, v118
v_mul_f32 v119, v3, v119
v_fract_f32 v118, v118
v_fract_f32 v119, v119
v_cos_f32 v118, v118
v_cos_f32 v119, v119
s_nop 0
v_cvt_pk_f16_f32 v54, v118, v119
v_lshlrev_b32 v118, 16, v55
v_and_b32 v119, 0xffff0000, v55
v_mul_f32 v118, v3, v118
v_mul_f32 v119, v3, v119
v_fract_f32 v118, v118
v_fract_f32 v119, v119
v_cos_f32 v118, v118
v_cos_f32 v119, v119
s_nop 0
v_cvt_pk_f16_f32 v55, v118, v119
s_waitcnt lgkmcnt(4)
v_lshl_or_b32 v36, v108, 10, v36
v_lshl_or_b32 v37, v109, 10, v37
v_lshl_or_b32 v38, v110, 10, v38
v_lshl_or_b32 v39, v111, 10, v39
s_waitcnt lgkmcnt(0)
v_lshl_or_b32 v40, v112, 10, v40
v_lshl_or_b32 v41, v113, 10, v41
v_lshl_or_b32 v42, v114, 10, v42
v_lshl_or_b32 v43, v115, 10, v43
s_mov_b64 exec, s[56:57]
v_lshrrev_b32 v116, 8, v24
v_lshrrev_b32 v117, 2, v24
v_bfi_b32 v116, 15, v24, v116
v_lshl_or_b32 v24, v44, 12, v116
v_and_b32 v44, 0x3fc, v117
ds_add_rtn_u32 v108, v44, v127 offset:0
v_lshrrev_b32 v116, 8, v25
v_lshrrev_b32 v117, 2, v25
v_bfi_b32 v116, 15, v25, v116
v_lshl_or_b32 v25, v45, 12, v116
v_and_b32 v45, 0x3fc, v117
ds_add_rtn_u32 v109, v45, v127 offset:0
v_lshrrev_b32 v116, 8, v26
v_lshrrev_b32 v117, 2, v26
v_bfi_b32 v116, 15, v26, v116
v_lshl_or_b32 v26, v46, 12, v116
v_and_b32 v46, 0x3fc, v117
ds_add_rtn_u32 v110, v46, v127 offset:0
v_lshrrev_b32 v116, 8, v27
v_lshrrev_b32 v117, 2, v27
v_bfi_b32 v116, 15, v27, v116
v_lshl_or_b32 v27, v47, 12, v116
v_and_b32 v47, 0x3fc, v117
ds_add_rtn_u32 v111, v47, v127 offset:0
v_lshlrev_b32 v118, 16, v56
v_and_b32 v119, 0xffff0000, v56
v_mul_f32 v118, v3, v118
v_mul_f32 v119, v3, v119
v_fract_f32 v118, v118
v_fract_f32 v119, v119
v_cos_f32 v118, v118
v_cos_f32 v119, v119
s_nop 0
v_cvt_pk_f16_f32 v56, v118, v119
v_lshlrev_b32 v118, 16, v57
v_and_b32 v119, 0xffff0000, v57
v_mul_f32 v118, v3, v118
v_mul_f32 v119, v3, v119
v_fract_f32 v118, v118
v_fract_f32 v119, v119
v_cos_f32 v118, v118
v_cos_f32 v119, v119
s_nop 0
v_cvt_pk_f16_f32 v57, v118, v119
s_waitcnt lgkmcnt(0)
v_lshl_or_b32 v44, v108, 10, v44
v_lshl_or_b32 v45, v109, 10, v45
v_lshl_or_b32 v46, v110, 10, v46
v_lshl_or_b32 v47, v111, 10, v47
s_mov_b64 exec, -1
s_barrier
ds_read_b128 v[108:111], v126 offset:0
s_waitcnt lgkmcnt(0)
v_add_u32 v112, 3, v108
v_lshrrev_b32 v112, 2, v112
v_add_u32 v113, 3, v109
v_lshrrev_b32 v113, 2, v113
v_add_u32 v114, 3, v110
v_lshrrev_b32 v114, 2, v114
v_add_u32 v115, 3, v111
v_lshrrev_b32 v115, 2, v115
v_add_u32 v118, v112, v113
v_add_u32 v119, v118, v114
v_add_u32 v120, v119, v115
v_mov_b32 v121, v120
s_nop 1
v_add_u32_dpp v121, v121, v121 row_shr:1 row_mask:0xf bank_mask:0xf bound_ctrl:0
s_nop 1
v_add_u32_dpp v121, v121, v121 row_shr:2 row_mask:0xf bank_mask:0xf bound_ctrl:0
s_nop 1
v_add_u32_dpp v121, v121, v121 row_shr:4 row_mask:0xf bank_mask:0xf bound_ctrl:0
s_nop 1
v_add_u32_dpp v121, v121, v121 row_shr:8 row_mask:0xf bank_mask:0xf bound_ctrl:0
s_nop 1
v_add_u32_dpp v121, v121, v121 row_bcast:15 row_mask:0xa bank_mask:0xf
s_nop 1
v_add_u32_dpp v121, v121, v121 row_bcast:31 row_mask:0xc bank_mask:0xf
v_sub_u32 v116, v121, v120
v_add_u32 v117, v116, v112
v_add_u32 v118, v116, v118
v_add_u32 v119, v116, v119
v_readlane_b32 s61, v121, 63
v_lshl_or_b32 v112, v112, 16, v116
v_lshl_or_b32 v113, v113, 16, v117
v_lshl_or_b32 v114, v114, 16, v118
v_lshl_or_b32 v115, v115, 16, v119
v_mul_u32_u24 v116, 24, v116
v_mul_u32_u24 v117, 24, v117
v_mul_u32_u24 v118, 24, v118
v_mul_u32_u24 v119, 24, v119
ds_write_b128 v126, v[116:119] offset:2048
ds_write_b128 v126, v[4:7] offset:1024
s_cmp_lg_u32 s58, 0
s_cbranch_scc1 k1w0_9
s_add_u32 s50, s60, 4
s_lshl_b32 s50, s50, 10
buffer_store_dwordx4 v[112:115], v126, s[28:31], s50 offen
k1w0_9:
s_cmp_lg_u32 s58, 1
s_cbranch_scc1 k1w1_10
v_lshrrev_b32 v120, 2, v108
v_mad_u32_u24 v120, v120, 24, v116
v_and_b32 v121, 3, v108
v_add_u32 v121, -1, v121
v_cmp_gt_u32 vcc, 1, v121
v_mov_b32 v123, 196608
s_nop 0
v_cndmask_b32 v123, v123, v120, vcc
ds_write_b16 v123, v4 offset:3106
v_cmp_gt_u32 vcc, 2, v121
v_mov_b32 v123, 196608
s_nop 0
v_cndmask_b32 v123, v123, v120, vcc
ds_write_b16 v123, v4 offset:3108
v_cmp_gt_u32 vcc, 3, v121
v_mov_b32 v123, 196608
s_nop 0
v_cndmask_b32 v123, v123, v120, vcc
ds_write_b16 v123, v4 offset:3110
v_lshrrev_b32 v120, 2, v109
v_mad_u32_u24 v120, v120, 24, v117
v_and_b32 v121, 3, v109
v_add_u32 v121, -1, v121
v_cmp_gt_u32 vcc, 1, v121
v_mov_b32 v123, 196608
s_nop 0
v_cndmask_b32 v123, v123, v120, vcc
ds_write_b16 v123, v4 offset:3106
v_cmp_gt_u32 vcc, 2, v121
v_mov_b32 v123, 196608
s_nop 0
v_cndmask_b32 v123, v123, v120, vcc
ds_write_b16 v123, v4 offset:3108
v_cmp_gt_u32 vcc, 3, v121
v_mov_b32 v123, 196608
s_nop 0
v_cndmask_b32 v123, v123, v120, vcc
ds_write_b16 v123, v4 offset:3110
v_lshrrev_b32 v120, 2, v110
v_mad_u32_u24 v120, v120, 24, v118
v_and_b32 v121, 3, v110
v_add_u32 v121, -1, v121
v_cmp_gt_u32 vcc, 1, v121
v_mov_b32 v123, 196608
s_nop 0
v_cndmask_b32 v123, v123, v120, vcc
ds_write_b16 v123, v4 offset:3106
v_cmp_gt_u32 vcc, 2, v121
v_mov_b32 v123, 196608
s_nop 0
v_cndmask_b32 v123, v123, v120, vcc
ds_write_b16 v123, v4 offset:3108
v_cmp_gt_u32 vcc, 3, v121
v_mov_b32 v123, 196608
s_nop 0
v_cndmask_b32 v123, v123, v120, vcc
ds_write_b16 v123, v4 offset:3110
v_lshrrev_b32 v120, 2, v111
v_mad_u32_u24 v120, v120, 24, v119
v_and_b32 v121, 3, v111
v_add_u32 v121, -1, v121
v_cmp_gt_u32 vcc, 1, v121
v_mov_b32 v123, 196608
s_nop 0
v_cndmask_b32 v123, v123, v120, vcc
ds_write_b16 v123, v4 offset:3106
v_cmp_gt_u32 vcc, 2, v121
v_mov_b32 v123, 196608
s_nop 0
v_cndmask_b32 v123, v123, v120, vcc
ds_write_b16 v123, v4 offset:3108
v_cmp_gt_u32 vcc, 3, v121
v_mov_b32 v123, 196608
s_nop 0
v_cndmask_b32 v123, v123, v120, vcc
ds_write_b16 v123, v4 offset:3110
k1w1_10:
s_add_u32 s50, s60, 4
s_mul_i32 s51, s50, 124800
s_add_u32 s20, s52, s51
s_addc_u32 s21, s53, 0
s_and_b32 s21, s21, 0xffff
s_mul_i32 s22, s61, 24
s_add_u32 s22, s22, 127
s_and_b32 s22, s22, 0xffffff80
s_waitcnt lgkmcnt(0)
v_and_b32 v108, 0x3ff, v28
ds_read_b32 v108, v108 offset:2048
v_and_b32 v109, 0x3ff, v29
ds_read_b32 v109, v109 offset:2048
v_and_b32 v110, 0x3ff, v30
ds_read_b32 v110, v110 offset:2048
v_and_b32 v111, 0x3ff, v31
ds_read_b32 v111, v111 offset:2048
v_and_b32 v112, 0x3ff, v32
ds_read_b32 v112, v112 offset:2048
v_and_b32 v113, 0x3ff, v33
ds_read_b32 v113, v113 offset:2048
v_and_b32 v114, 0x3ff, v34
ds_read_b32 v114, v114 offset:2048
v_and_b32 v115, 0x3ff, v35
ds_read_b32 v115, v115 offset:2048
s_waitcnt lgkmcnt(0)
v_lshrrev_b32 v28, 10, v28
v_mad_u32_u24 v108, v28, 6, v108
v_and_b32 v116, 3, v28
v_mad_i32_i24 v117, v116, -2, v108
v_mad_i32_i24 v108, v116, -4, v108
ds_write_b32 v117, v8 offset:3088
ds_write_b16 v108, v48 offset:3104
v_lshrrev_b32 v29, 10, v29
v_mad_u32_u24 v109, v29, 6, v109
v_and_b32 v116, 3, v29
v_mad_i32_i24 v117, v116, -2, v109
v_mad_i32_i24 v109, v116, -4, v109
ds_write_b32 v117, v9 offset:3088
ds_write_b16_d16_hi v109, v48 offset:3104
v_lshrrev_b32 v30, 10, v30
v_mad_u32_u24 v110, v30, 6, v110
v_and_b32 v116, 3, v30
v_mad_i32_i24 v117, v116, -2, v110
v_mad_i32_i24 v110, v116, -4, v110
ds_write_b32 v117, v10 offset:3088
ds_write_b16 v110, v49 offset:3104
v_lshrrev_b32 v31, 10, v31
v_mad_u32_u24 v111, v31, 6, v111
v_and_b32 v116, 3, v31
v_mad_i32_i24 v117, v116, -2, v111
v_mad_i32_i24 v111, v116, -4, v111
ds_write_b32 v117, v11 offset:3088
ds_write_b16_d16_hi v111, v49 offset:3104
v_lshrrev_b32 v32, 10, v32
v_mad_u32_u24 v112, v32, 6, v112
v_and_b32 v116, 3, v32
v_mad_i32_i24 v117, v116, -2, v112
v_mad_i32_i24 v112, v116, -4, v112
ds_write_b32 v117, v12 offset:3088
ds_write_b16 v112, v50 offset:3104
v_lshrrev_b32 v33, 10, v33
v_mad_u32_u24 v113, v33, 6, v113
v_and_b32 v116, 3, v33
v_mad_i32_i24 v117, v116, -2, v113
v_mad_i32_i24 v113, v116, -4, v113
ds_write_b32 v117, v13 offset:3088
ds_write_b16_d16_hi v113, v50 offset:3104
v_lshrrev_b32 v34, 10, v34
v_mad_u32_u24 v114, v34, 6, v114
v_and_b32 v116, 3, v34
v_mad_i32_i24 v117, v116, -2, v114
v_mad_i32_i24 v114, v116, -4, v114
ds_write_b32 v117, v14 offset:3088
ds_write_b16 v114, v51 offset:3104
v_lshrrev_b32 v35, 10, v35
v_mad_u32_u24 v115, v35, 6, v115
v_and_b32 v116, 3, v35
v_mad_i32_i24 v117, v116, -2, v115
v_mad_i32_i24 v115, v116, -4, v115
ds_write_b32 v117, v15 offset:3088
ds_write_b16_d16_hi v115, v51 offset:3104
v_and_b32 v108, 0x3ff, v36
ds_read_b32 v108, v108 offset:2048
v_and_b32 v109, 0x3ff, v37
ds_read_b32 v109, v109 offset:2048
v_and_b32 v110, 0x3ff, v38
ds_read_b32 v110, v110 offset:2048
v_and_b32 v111, 0x3ff, v39
ds_read_b32 v111, v111 offset:2048
v_and_b32 v112, 0x3ff, v40
ds_read_b32 v112, v112 offset:2048
v_and_b32 v113, 0x3ff, v41
ds_read_b32 v113, v113 offset:2048
v_and_b32 v114, 0x3ff, v42
ds_read_b32 v114, v114 offset:2048
v_and_b32 v115, 0x3ff, v43
ds_read_b32 v115, v115 offset:2048
s_waitcnt lgkmcnt(0)
v_lshrrev_b32 v36, 10, v36
v_mad_u32_u24 v108, v36, 6, v108
v_and_b32 v116, 3, v36
v_mad_i32_i24 v117, v116, -2, v108
v_mad_i32_i24 v108, v116, -4, v108
ds_write_b32 v117, v16 offset:3088
ds_write_b16 v108, v52 offset:3104
v_lshrrev_b32 v37, 10, v37
v_mad_u32_u24 v109, v37, 6, v109
v_and_b32 v116, 3, v37
v_mad_i32_i24 v117, v116, -2, v109
v_mad_i32_i24 v109, v116, -4, v109
ds_write_b32 v117, v17 offset:3088
ds_write_b16_d16_hi v109, v52 offset:3104
v_lshrrev_b32 v38, 10, v38
v_mad_u32_u24 v110, v38, 6, v110
v_and_b32 v116, 3, v38
v_mad_i32_i24 v117, v116, -2, v110
v_mad_i32_i24 v110, v116, -4, v110
ds_write_b32 v117, v18 offset:3088
ds_write_b16 v110, v53 offset:3104
v_lshrrev_b32 v39, 10, v39
v_mad_u32_u24 v111, v39, 6, v111
v_and_b32 v116, 3, v39
v_mad_i32_i24 v117, v116, -2, v111
v_mad_i32_i24 v111, v116, -4, v111
ds_write_b32 v117, v19 offset:3088
ds_write_b16_d16_hi v111, v53 offset:3104
v_lshrrev_b32 v40, 10, v40
v_mad_u32_u24 v112, v40, 6, v112
v_and_b32 v116, 3, v40
v_mad_i32_i24 v117, v116, -2, v112
v_mad_i32_i24 v112, v116, -4, v112
ds_write_b32 v117, v20 offset:3088
ds_write_b16 v112, v54 offset:3104
v_lshrrev_b32 v41, 10, v41
v_mad_u32_u24 v113, v41, 6, v113
v_and_b32 v116, 3, v41
v_mad_i32_i24 v117, v116, -2, v113
v_mad_i32_i24 v113, v116, -4, v113
ds_write_b32 v117, v21 offset:3088
ds_write_b16_d16_hi v113, v54 offset:3104
v_lshrrev_b32 v42, 10, v42
v_mad_u32_u24 v114, v42, 6, v114
v_and_b32 v116, 3, v42
v_mad_i32_i24 v117, v116, -2, v114
v_mad_i32_i24 v114, v116, -4, v114
ds_write_b32 v117, v22 offset:3088
ds_write_b16 v114, v55 offset:3104
v_lshrrev_b32 v43, 10, v43
v_mad_u32_u24 v115, v43, 6, v115
v_and_b32 v116, 3, v43
v_mad_i32_i24 v117, v116, -2, v115
v_mad_i32_i24 v115, v116, -4, v115
ds_write_b32 v117, v23 offset:3088
ds_write_b16_d16_hi v115, v55 offset:3104
s_mov_b64 exec, s[56:57]
v_and_b32 v108, 0x3ff, v44
ds_read_b32 v108, v108 offset:2048
v_and_b32 v109, 0x3ff, v45
ds_read_b32 v109, v109 offset:2048
v_and_b32 v110, 0x3ff, v46
ds_read_b32 v110, v110 offset:2048
v_and_b32 v111, 0x3ff, v47
ds_read_b32 v111, v111 offset:2048
s_waitcnt lgkmcnt(0)
v_lshrrev_b32 v44, 10, v44
v_mad_u32_u24 v108, v44, 6, v108
v_and_b32 v116, 3, v44
v_mad_i32_i24 v117, v116, -2, v108
v_mad_i32_i24 v108, v116, -4, v108
ds_write_b32 v117, v24 offset:3088
ds_write_b16 v108, v56 offset:3104
v_lshrrev_b32 v45, 10, v45
v_mad_u32_u24 v109, v45, 6, v109
v_and_b32 v116, 3, v45
v_mad_i32_i24 v117, v116, -2, v109
v_mad_i32_i24 v109, v116, -4, v109
ds_write_b32 v117, v25 offset:3088
ds_write_b16_d16_hi v109, v56 offset:3104
v_lshrrev_b32 v46, 10, v46
v_mad_u32_u24 v110, v46, 6, v110
v_and_b32 v116, 3, v46
v_mad_i32_i24 v117, v116, -2, v110
v_mad_i32_i24 v110, v116, -4, v110
ds_write_b32 v117, v26 offset:3088
ds_write_b16 v110, v57 offset:3104
v_lshrrev_b32 v47, 10, v47
v_mad_u32_u24 v111, v47, 6, v111
v_and_b32 v116, 3, v47
v_mad_i32_i24 v117, v116, -2, v111
v_mad_i32_i24 v111, v116, -4, v111
ds_write_b32 v117, v27 offset:3088
ds_write_b16_d16_hi v111, v57 offset:3104
s_mov_b64 exec, -1
s_waitcnt lgkmcnt(0)
s_barrier
v_add_u32 v108, 0, v1
ds_read_b128 v[8:11], v108 offset:3088
v_add_u32 v109, 16384, v1
ds_read_b128 v[12:15], v109 offset:3088
v_add_u32 v110, 32768, v1
ds_read_b128 v[16:19], v110 offset:3088
v_add_u32 v111, 49152, v1
ds_read_b128 v[20:23], v111 offset:3088
v_add_u32 v112, 65536, v1
ds_read_b128 v[24:27], v112 offset:3088
v_add_u32 v113, 81920, v1
ds_read_b128 v[28:31], v113 offset:3088
v_add_u32 v114, 98304, v1
ds_read_b128 v[32:35], v114 offset:3088
v_add_u32 v115, 114688, v1
ds_read_b128 v[36:39], v115 offset:3088
s_waitcnt lgkmcnt(7)
buffer_store_dwordx4 v[8:11], v108, s[20:23], 0 offen sc1
s_waitcnt lgkmcnt(6)
buffer_store_dwordx4 v[12:15], v109, s[20:23], 0 offen sc1
s_waitcnt lgkmcnt(5)
buffer_store_dwordx4 v[16:19], v110, s[20:23], 0 offen sc1
s_waitcnt lgkmcnt(4)
buffer_store_dwordx4 v[20:23], v111, s[20:23], 0 offen sc1
s_waitcnt lgkmcnt(3)
buffer_store_dwordx4 v[24:27], v112, s[20:23], 0 offen sc1
s_waitcnt lgkmcnt(2)
buffer_store_dwordx4 v[28:31], v113, s[20:23], 0 offen sc1
s_waitcnt lgkmcnt(1)
buffer_store_dwordx4 v[32:35], v114, s[20:23], 0 offen sc1
s_waitcnt lgkmcnt(0)
buffer_store_dwordx4 v[36:39], v115, s[20:23], 0 offen sc1
s_waitcnt vmcnt(0) lgkmcnt(0)
k1_end:
s_endpgm
.globl gath_kernel
.p2align 8
.type gath_kernel,@function
gath_kernel:
s_cmp_ge_u32 s2, 256
s_cbranch_scc1 k2_end
s_load_dwordx2 s[44:45], s[0:1], 104
s_load_dwordx2 s[46:47], s[0:1], 0
v_lshlrev_b32 v1, 4, v0
v_and_b32 v3, 63, v0
v_lshlrev_b32 v2, 4, v3
v_mov_b32 v4, 0
v_mov_b32 v5, 0
v_mov_b32 v6, 0
v_mov_b32 v7, 0
v_lshrrev_b32 v96, 6, v0
s_nop 0
v_readfirstlane_b32 s43, v96
v_mov_b32 v12, 196608
v_mov_b32 v13, 2147483648
v_mov_b32 v14, 1
s_and_b32 s42, s2, 7
s_lshl_b32 s42, s42, 5
s_lshr_b32 s3, s2, 3
s_add_u32 s42, s42, s3
s_mul_i32 s50, s43, 80
v_add_u32 v98, s50, v3
v_add_u32 v99, 40, v98
v_lshlrev_b32 v96, 10, v98
v_lshlrev_b32 v97, 10, v99
v_cmp_gt_u32 vcc, 40, v3
s_nop 1
v_cndmask_b32 v96, v13, v96, vcc
v_cndmask_b32 v97, v13, v97, vcc
v_add_u32 v112, 0, v0
v_lshrrev_b32 v116, 4, v112
v_lshlrev_b32 v116, 15, v116
v_and_b32 v112, 15, v112
v_lshl_or_b32 v112, v112, 3, v116
v_add_u32 v113, 1024, v0
v_lshrrev_b32 v116, 4, v113
v_lshlrev_b32 v116, 15, v116
v_and_b32 v113, 15, v113
v_lshl_or_b32 v113, v113, 3, v116
v_add_u32 v114, 2048, v0
v_lshrrev_b32 v116, 4, v114
v_lshlrev_b32 v116, 15, v116
v_and_b32 v114, 15, v114
v_lshl_or_b32 v114, v114, 3, v116
v_add_u32 v115, 3072, v0
v_lshrrev_b32 v116, 4, v115
v_lshlrev_b32 v116, 15, v116
v_and_b32 v115, 15, v115
v_lshl_or_b32 v115, v115, 3, v116
v_cmp_gt_u32 vcc, 64, v0
s_nop 1
v_cndmask_b32 v115, v13, v115, vcc
v_cmp_gt_u32 vcc, 128, v0
s_nop 1
s_and_saveexec_b64 s[62:63], vcc
ds_write_b128 v1, v[4:7]
s_mov_b64 exec, s[62:63]
s_lshl_b32 s51, s42, 2
s_lshl_b32 s54, s42, 7
s_waitcnt lgkmcnt(0)
s_add_u32 s16, s44, 398295040
s_addc_u32 s17, s45, 0
s_and_b32 s17, s17, 0xffff
s_mov_b32 s18, 1310720
s_mov_b32 s19, 0x00020000
buffer_load_dword v100, v96, s[16:19], s51 offen
buffer_load_dword v101, v97, s[16:19], s51 offen
s_add_u32 s24, s44, 401440768
s_addc_u32 s25, s45, 0
s_and_b32 s25, s25, 0xffff
s_mov_b32 s26, 1024
s_mov_b32 s27, 0x00020000
s_mov_b32 s20, s46
s_and_b32 s21, s47, 0xffff
s_mov_b32 s22, 6400000
s_mov_b32 s23, 0x00020000
buffer_load_dwordx4 v[120:123], v2, s[24:27], 0 offen
buffer_load_dwordx2 v[104:105], v112, s[20:23], s54 offen
buffer_load_dwordx2 v[106:107], v113, s[20:23], s54 offen
buffer_load_dwordx2 v[108:109], v114, s[20:23], s54 offen
buffer_load_dwordx2 v[110:111], v115, s[20:23], s54 offen
s_add_u32 s8, s44, 0
s_addc_u32 s9, s45, 0
s_and_b32 s9, s9, 0xffff
s_mov_b32 s10, 159744000
s_mov_b32 s11, 0x00020000
s_add_u32 s32, s44, 399605760
s_addc_u32 s33, s45, 0
s_and_b32 s33, s33, 0xffff
s_mov_b32 s34, 1835008
s_mov_b32 s35, 0x00020000
s_add_u32 s36, s44, 401441792
s_addc_u32 s37, s45, 0
s_and_b32 s37, s37, 0xffff
s_mov_b32 s38, 4
s_mov_b32 s39, 0x00020000
s_add_u32 s52, s44, 159744000
s_addc_u32 s53, s45, 0
s_mov_b32 s28, s52
s_and_b32 s29, s53, 0xffff
s_mov_b32 s30, 0
s_mov_b32 s31, 0x00020000
s_waitcnt vmcnt(5)
v_lshrrev_b32 v8, 16, v100
v_mov_b32 v96, v8
s_nop 0
v_add_u32_dpp v8, v8, v8 row_shr:1 row_mask:0xf bank_mask:0xf bound_ctrl:0
s_nop 1
v_add_u32_dpp v8, v8, v8 row_shr:2 row_mask:0xf bank_mask:0xf bound_ctrl:0
s_nop 1
v_add_u32_dpp v8, v8, v8 row_shr:4 row_mask:0xf bank_mask:0xf bound_ctrl:0
s_nop 1
v_add_u32_dpp v8, v8, v8 row_shr:8 row_mask:0xf bank_mask:0xf bound_ctrl:0
s_nop 1
v_add_u32_dpp v8, v8, v8 row_bcast:15 row_mask:0xa bank_mask:0xf
s_nop 1
v_add_u32_dpp v8, v8, v8 row_bcast:31 row_mask:0xc bank_mask:0xf
s_nop 0
v_readlane_b32 s46, v8, 63
v_sub_u32 v8, v8, v96
v_and_b32 v100, 0xffff, v100
v_sub_u32 v100, v100, v8
v_mov_b32 v96, 5200
v_mad_u32_u24 v9, v98, v96, v100
s_sub_u32 s3, 7000000, s46
v_mov_b32 v96, s3
v_cmp_eq_u32 vcc, 40, v3
s_nop 1
v_cndmask_b32 v9, v9, v96, vcc
v_mov_b32 v96, -1
v_cmp_lt_u32 vcc, 40, v3
s_nop 1
v_cndmask_b32 v8, v8, v96, vcc
v_lshrrev_b32 v10, 16, v101
v_mov_b32 v97, v10
s_nop 0
v_add_u32_dpp v10, v10, v10 row_shr:1 row_mask:0xf bank_mask:0xf bound_ctrl:0
s_nop 1
v_add_u32_dpp v10, v10, v10 row_shr:2 row_mask:0xf bank_mask:0xf bound_ctrl:0
s_nop 1
v_add_u32_dpp v10, v10, v10 row_shr:4 row_mask:0xf bank_mask:0xf bound_ctrl:0
s_nop 1
v_add_u32_dpp v10, v10, v10 row_shr:8 row_mask:0xf bank_mask:0xf bound_ctrl:0
s_nop 1
v_add_u32_dpp v10, v10, v10 row_bcast:15 row_mask:0xa bank_mask:0xf
s_nop 1
v_add_u32_dpp v10, v10, v10 row_bcast:31 row_mask:0xc bank_mask:0xf
s_nop 0
v_readlane_b32 s47, v10, 63
v_sub_u32 v10, v10, v97
v_and_b32 v101, 0xffff, v101
v_sub_u32 v101, v101, v10
v_mov_b32 v97, 5200
v_mad_u32_u24 v11, v99, v97, v101
s_sub_u32 s3, 7000000, s47
v_mov_b32 v97, s3
v_cmp_eq_u32 vcc, 40, v3
s_nop 1
v_cndmask_b32 v11, v11, v97, vcc
v_mov_b32 v97, -1
v_cmp_lt_u32 vcc, 40, v3
s_nop 1
v_cndmask_b32 v10, v10, v97, vcc
s_add_u32 s48, s46, 63
s_lshr_b32 s48, s48, 6
s_add_u32 s49, s47, 63
s_lshr_b32 s49, s49, 6
s_add_u32 s50, s48, s49
s_cmp_le_u32 s50, 28
s_cbranch_scc1 k2ok_11
buffer_store_dword v14, v4, s[36:39], 0 offen sc0 sc1
s_waitcnt vmcnt(0)
k2ok_11:
s_mov_b32 s64, 0
s_mov_b32 s65, 0
s_mov_b32 s66, 0
s_mov_b32 s68, 0
v_readlane_b32 s67, v8, 0
s_cmp_lt_u32 s64, s46
s_cbranch_scc1 k2ns_12
s_cmp_lg_u32 s65, 0
s_cbranch_scc1 k2ns_12
v_mov_b32 v8, v10
v_mov_b32 v9, v11
s_mov_b32 s46, s47
s_mov_b32 s64, 0
s_mov_b32 s65, 1
s_mov_b32 s66, 0
v_readlane_b32 s67, v8, 0
k2ns_12:
v_mov_b32 v96, s68
s_add_u32 s69, s64, 64
s_cmp_lt_u32 s67, s69
s_cbranch_scc0 gwek2_14
gwk2_13:
v_readlane_b32 s68, v9, s66
s_add_u32 s66, s66, 1
s_sub_u32 s70, s67, s64
s_max_i32 s70, s70, 0
v_readlane_b32 s67, v8, s66
s_lshl_b64 exec, -1, s70
v_mov_b32 v96, s68
s_cmp_lt_u32 s67, s69
s_cbranch_scc1 gwk2_13
s_mov_b64 exec, -1
gwek2_14:
v_add3_u32 v96, v96, s64, v3
s_add_u32 s64, s64, 64
v_mul_u32_u24 v96, 24, v96
buffer_load_dwordx4 v[16:19], v96, s[8:11], 0 offen
buffer_load_dwordx2 v[32:33], v96, s[8:11], 0 offen offset:16
s_cmp_lt_u32 s64, s46
s_cbranch_scc1 k2ns_15
s_cmp_lg_u32 s65, 0
s_cbranch_scc1 k2ns_15
v_mov_b32 v8, v10
v_mov_b32 v9, v11
s_mov_b32 s46, s47
s_mov_b32 s64, 0
s_mov_b32 s65, 1
s_mov_b32 s66, 0
v_readlane_b32 s67, v8, 0
k2ns_15:
v_mov_b32 v98, s68
s_add_u32 s69, s64, 64
s_cmp_lt_u32 s67, s69
s_cbranch_scc0 gwek2_17
gwk2_16:
v_readlane_b32 s68, v9, s66
s_add_u32 s66, s66, 1
s_sub_u32 s70, s67, s64
s_max_i32 s70, s70, 0
v_readlane_b32 s67, v8, s66
s_lshl_b64 exec, -1, s70
v_mov_b32 v98, s68
s_cmp_lt_u32 s67, s69
s_cbranch_scc1 gwk2_16
s_mov_b64 exec, -1
gwek2_17:
v_add3_u32 v98, v98, s64, v3
s_add_u32 s64, s64, 64
v_mul_u32_u24 v98, 24, v98
buffer_load_dwordx4 v[20:23], v98, s[8:11], 0 offen
buffer_load_dwordx2 v[34:35], v98, s[8:11], 0 offen offset:16
s_cmp_lt_u32 s64, s46
s_cbranch_scc1 k2ns_18
s_cmp_lg_u32 s65, 0
s_cbranch_scc1 k2ns_18
v_mov_b32 v8, v10
v_mov_b32 v9, v11
s_mov_b32 s46, s47
s_mov_b32 s64, 0
s_mov_b32 s65, 1
s_mov_b32 s66, 0
v_readlane_b32 s67, v8, 0
k2ns_18:
v_mov_b32 v100, s68
s_add_u32 s69, s64, 64
s_cmp_lt_u32 s67, s69
s_cbranch_scc0 gwek2_20
gwk2_19:
v_readlane_b32 s68, v9, s66
s_add_u32 s66, s66, 1
s_sub_u32 s70, s67, s64
s_max_i32 s70, s70, 0
v_readlane_b32 s67, v8, s66
s_lshl_b64 exec, -1, s70
v_mov_b32 v100, s68
s_cmp_lt_u32 s67, s69
s_cbranch_scc1 gwk2_19
s_mov_b64 exec, -1
gwek2_20:
v_add3_u32 v100, v100, s64, v3
s_add_u32 s64, s64, 64
v_mul_u32_u24 v100, 24, v100
buffer_load_dwordx4 v[24:27], v100, s[8:11], 0 offen
buffer_load_dwordx2 v[36:37], v100, s[8:11], 0 offen offset:16
s_cmp_lt_u32 s64, s46
s_cbranch_scc1 k2ns_21
s_cmp_lg_u32 s65, 0
s_cbranch_scc1 k2ns_21
v_mov_b32 v8, v10
v_mov_b32 v9, v11
s_mov_b32 s46, s47
s_mov_b32 s64, 0
s_mov_b32 s65, 1
s_mov_b32 s66, 0
v_readlane_b32 s67, v8, 0
k2ns_21:
v_mov_b32 v102, s68
s_add_u32 s69, s64, 64
s_cmp_lt_u32 s67, s69
s_cbranch_scc0 gwek2_23
gwk2_22:
v_readlane_b32 s68, v9, s66
s_add_u32 s66, s66, 1
s_sub_u32 s70, s67, s64
s_max_i32 s70, s70, 0
v_readlane_b32 s67, v8, s66
s_lshl_b64 exec, -1, s70
v_mov_b32 v102, s68
s_cmp_lt_u32 s67, s69
s_cbranch_scc1 gwk2_22
s_mov_b64 exec, -1
gwek2_23:
v_add3_u32 v102, v102, s64, v3
s_add_u32 s64, s64, 64
v_mul_u32_u24 v102, 24, v102
buffer_load_dwordx4 v[28:31], v102, s[8:11], 0 offen
buffer_load_dwordx2 v[38:39], v102, s[8:11], 0 offen offset:16
s_waitcnt vmcnt(8)
v_max_u32 v120, v120, v121
v_max_u32 v122, v122, v123
v_max_u32 v120, v120, v122
s_nop 1
v_max_u32_dpp v120, v120, v120 row_shr:1 row_mask:0xf bank_mask:0xf bound_ctrl:0
s_nop 1
v_max_u32_dpp v120, v120, v120 row_shr:2 row_mask:0xf bank_mask:0xf bound_ctrl:0
s_nop 1
v_max_u32_dpp v120, v120, v120 row_shr:4 row_mask:0xf bank_mask:0xf bound_ctrl:0
s_nop 1
v_max_u32_dpp v120, v120, v120 row_shr:8 row_mask:0xf bank_mask:0xf bound_ctrl:0
s_nop 1
v_max_u32_dpp v120, v120, v120 row_bcast:15 row_mask:0xa bank_mask:0xf
s_nop 1
v_max_u32_dpp v120, v120, v120 row_bcast:31 row_mask:0xc bank_mask:0xf
s_nop 0
v_readlane_b32 s41, v120, 63
s_nop 1
s_lshr_b32 s41, s41, 7
s_sub_u32 s40, 268, s41
s_min_u32 s40, s40, 254
s_max_u32 s40, s40, 1
s_lshl_b32 s41, s40, 23
v_lshlrev_b32 v120, 16, v104
v_and_b32 v121, 0xffff0000, v104
v_mul_f32 v120, s41, v120
v_mul_f32 v121, s41, v121
v_cvt_pk_f16_f32 v104, v120, v121
v_lshlrev_b32 v120, 16, v105
v_and_b32 v121, 0xffff0000, v105
v_mul_f32 v120, s41, v120
v_mul_f32 v121, s41, v121
v_cvt_pk_f16_f32 v105, v120, v121
v_add_u32 v120, 0, v0
v_lshlrev_b32 v120, 3, v120
ds_write_b64 v120, v[104:105] offset:3072
v_lshlrev_b32 v120, 16, v106
v_and_b32 v121, 0xffff0000, v106
v_mul_f32 v120, s41, v120
v_mul_f32 v121, s41, v121
v_cvt_pk_f16_f32 v106, v120, v121
v_lshlrev_b32 v120, 16, v107
v_and_b32 v121, 0xffff0000, v107
v_mul_f32 v120, s41, v120
v_mul_f32 v121, s41, v121
v_cvt_pk_f16_f32 v107, v120, v121
v_add_u32 v120, 1024, v0
v_lshlrev_b32 v120, 3, v120
ds_write_b64 v120, v[106:107] offset:3072
v_lshlrev_b32 v120, 16, v108
v_and_b32 v121, 0xffff0000, v108
v_mul_f32 v120, s41, v120
v_mul_f32 v121, s41, v121
v_cvt_pk_f16_f32 v108, v120, v121
v_lshlrev_b32 v120, 16, v109
v_and_b32 v121, 0xffff0000, v109
v_mul_f32 v120, s41, v120
v_mul_f32 v121, s41, v121
v_cvt_pk_f16_f32 v109, v120, v121
v_add_u32 v120, 2048, v0
v_lshlrev_b32 v120, 3, v120
ds_write_b64 v120, v[108:109] offset:3072
v_lshlrev_b32 v120, 16, v110
v_and_b32 v121, 0xffff0000, v110
v_mul_f32 v120, s41, v120
v_mul_f32 v121, s41, v121
v_cvt_pk_f16_f32 v110, v120, v121
v_lshlrev_b32 v120, 16, v111
v_and_b32 v121, 0xffff0000, v111
v_mul_f32 v120, s41, v120
v_mul_f32 v121, s41, v121
v_cvt_pk_f16_f32 v111, v120, v121
v_add_u32 v120, 3072, v0
v_lshlrev_b32 v120, 3, v120
v_cmp_gt_u32 vcc, 64, v0
s_nop 1
s_and_saveexec_b64 s[62:63], vcc
ds_write_b64 v120, v[110:111] offset:3072
s_mov_b64 exec, s[62:63]
s_mov_b32 s72, 0x00070007
s_mov_b32 s73, 196608
s_waitcnt lgkmcnt(0)
s_barrier
s_waitcnt vmcnt(0)
v_lshlrev_b32 v112, 3, v16
v_and_b32 v112, 0x7ff8, v112
ds_read_b64 v[64:65], v112 offset:3072
v_lshlrev_b32 v112, 3, v17
v_and_b32 v112, 0x7ff8, v112
ds_read_b64 v[66:67], v112 offset:3072
v_lshlrev_b32 v112, 3, v18
v_and_b32 v112, 0x7ff8, v112
ds_read_b64 v[68:69], v112 offset:3072
v_lshlrev_b32 v112, 3, v19
v_and_b32 v112, 0x7ff8, v112
ds_read_b64 v[70:71], v112 offset:3072
v_cmp_ne_u16 vcc, 0, v32
v_lshrrev_b32 v96, 14, v16
v_and_b32 v96, 0x3fc, v96
v_cndmask_b32 v96, v12, v96, vcc
ds_add_rtn_u32 v100, v96, v14 offset:0
v_cmp_lt_u32 vcc, 0xffff, v32
v_lshrrev_b32 v97, 14, v17
v_and_b32 v97, 0x3fc, v97
v_cndmask_b32 v97, v12, v97, vcc
ds_add_rtn_u32 v101, v97, v14 offset:0
v_cmp_ne_u16 vcc, 0, v33
v_lshrrev_b32 v98, 14, v18
v_and_b32 v98, 0x3fc, v98
v_cndmask_b32 v98, v12, v98, vcc
ds_add_rtn_u32 v102, v98, v14 offset:0
v_cmp_lt_u32 vcc, 0xffff, v33
v_lshrrev_b32 v99, 14, v19
v_and_b32 v99, 0x3fc, v99
v_cndmask_b32 v99, v12, v99, vcc
ds_add_rtn_u32 v103, v99, v14 offset:0
v_lshlrev_b32 v112, 3, v20
v_and_b32 v112, 0x7ff8, v112
ds_read_b64 v[72:73], v112 offset:3072
v_lshlrev_b32 v112, 3, v21
v_and_b32 v112, 0x7ff8, v112
ds_read_b64 v[74:75], v112 offset:3072
v_lshlrev_b32 v112, 3, v22
v_and_b32 v112, 0x7ff8, v112
ds_read_b64 v[76:77], v112 offset:3072
v_lshlrev_b32 v112, 3, v23
v_and_b32 v112, 0x7ff8, v112
ds_read_b64 v[78:79], v112 offset:3072
v_cmp_ne_u16 vcc, 0, v34
v_lshrrev_b32 v104, 14, v20
v_and_b32 v104, 0x3fc, v104
v_cndmask_b32 v104, v12, v104, vcc
ds_add_rtn_u32 v108, v104, v14 offset:0
v_cmp_lt_u32 vcc, 0xffff, v34
v_lshrrev_b32 v105, 14, v21
v_and_b32 v105, 0x3fc, v105
v_cndmask_b32 v105, v12, v105, vcc
ds_add_rtn_u32 v109, v105, v14 offset:0
v_cmp_ne_u16 vcc, 0, v35
v_lshrrev_b32 v106, 14, v22
v_and_b32 v106, 0x3fc, v106
v_cndmask_b32 v106, v12, v106, vcc
ds_add_rtn_u32 v110, v106, v14 offset:0
v_cmp_lt_u32 vcc, 0xffff, v35
v_lshrrev_b32 v107, 14, v23
v_and_b32 v107, 0x3fc, v107
v_cndmask_b32 v107, v12, v107, vcc
ds_add_rtn_u32 v111, v107, v14 offset:0
s_waitcnt lgkmcnt(12)
v_pk_mul_f16 v64, v64, v32 op_sel:[0,0] op_sel_hi:[1,0]
v_pk_mul_f16 v65, v65, v32 op_sel:[0,0] op_sel_hi:[1,0]
v_lshrrev_b32 v113, 20, v16
v_lshrrev_b32 v114, 12, v16
v_bfi_b32 v113, 15, v114, v113
v_add_u32 v64, 0x00040004, v64
v_add_u32 v65, 0x00040004, v65
v_lshl_or_b32 v114, v113, 13, v113
v_lshrrev_b32 v115, 6, v113
v_bfi_b32 v64, s72, v114, v64
v_lshl_or_b32 v115, v115, 13, v115
v_bfi_b32 v65, s72, v115, v65
v_pk_mul_f16 v66, v66, v32 op_sel:[0,1] op_sel_hi:[1,1]
v_pk_mul_f16 v67, v67, v32 op_sel:[0,1] op_sel_hi:[1,1]
v_lshrrev_b32 v113, 20, v17
v_lshrrev_b32 v114, 12, v17
v_bfi_b32 v113, 15, v114, v113
v_add_u32 v66, 0x00040004, v66
v_add_u32 v67, 0x00040004, v67
v_lshl_or_b32 v114, v113, 13, v113
v_lshrrev_b32 v115, 6, v113
v_bfi_b32 v66, s72, v114, v66
v_lshl_or_b32 v115, v115, 13, v115
v_bfi_b32 v67, s72, v115, v67
v_pk_mul_f16 v68, v68, v33 op_sel:[0,0] op_sel_hi:[1,0]
v_pk_mul_f16 v69, v69, v33 op_sel:[0,0] op_sel_hi:[1,0]
v_lshrrev_b32 v113, 20, v18
v_lshrrev_b32 v114, 12, v18
v_bfi_b32 v113, 15, v114, v113
v_add_u32 v68, 0x00040004, v68
v_add_u32 v69, 0x00040004, v69
v_lshl_or_b32 v114, v113, 13, v113
v_lshrrev_b32 v115, 6, v113
v_bfi_b32 v68, s72, v114, v68
v_lshl_or_b32 v115, v115, 13, v115
v_bfi_b32 v69, s72, v115, v69
v_pk_mul_f16 v70, v70, v33 op_sel:[0,1] op_sel_hi:[1,1]
v_pk_mul_f16 v71, v71, v33 op_sel:[0,1] op_sel_hi:[1,1]
v_lshrrev_b32 v113, 20, v19
v_lshrrev_b32 v114, 12, v19
v_bfi_b32 v113, 15, v114, v113
v_add_u32 v70, 0x00040004, v70
v_add_u32 v71, 0x00040004, v71
v_lshl_or_b32 v114, v113, 13, v113
v_lshrrev_b32 v115, 6, v113
v_bfi_b32 v70, s72, v114, v70
v_lshl_or_b32 v115, v115, 13, v115
v_bfi_b32 v71, s72, v115, v71
s_waitcnt lgkmcnt(8)
v_lshl_or_b32 v16, v100, 18, v96
v_lshl_or_b32 v17, v101, 18, v97
v_lshl_or_b32 v18, v102, 18, v98
v_lshl_or_b32 v19, v103, 18, v99
v_lshlrev_b32 v112, 3, v24
v_and_b32 v112, 0x7ff8, v112
ds_read_b64 v[80:81], v112 offset:3072
v_lshlrev_b32 v112, 3, v25
v_and_b32 v112, 0x7ff8, v112
ds_read_b64 v[82:83], v112 offset:3072
v_lshlrev_b32 v112, 3, v26
v_and_b32 v112, 0x7ff8, v112
ds_read_b64 v[84:85], v112 offset:3072
v_lshlrev_b32 v112, 3, v27
v_and_b32 v112, 0x7ff8, v112
ds_read_b64 v[86:87], v112 offset:3072
v_cmp_ne_u16 vcc, 0, v36
v_lshrrev_b32 v96, 14, v24
v_and_b32 v96, 0x3fc, v96
v_cndmask_b32 v96, v12, v96, vcc
ds_add_rtn_u32 v100, v96, v14 offset:0
v_cmp_lt_u32 vcc, 0xffff, v36
v_lshrrev_b32 v97, 14, v25
v_and_b32 v97, 0x3fc, v97
v_cndmask_b32 v97, v12, v97, vcc
ds_add_rtn_u32 v101, v97, v14 offset:0
v_cmp_ne_u16 vcc, 0, v37
v_lshrrev_b32 v98, 14, v26
v_and_b32 v98, 0x3fc, v98
v_cndmask_b32 v98, v12, v98, vcc
ds_add_rtn_u32 v102, v98, v14 offset:0
v_cmp_lt_u32 vcc, 0xffff, v37
v_lshrrev_b32 v99, 14, v27
v_and_b32 v99, 0x3fc, v99
v_cndmask_b32 v99, v12, v99, vcc
ds_add_rtn_u32 v103, v99, v14 offset:0
s_waitcnt lgkmcnt(12)
v_pk_mul_f16 v72, v72, v34 op_sel:[0,0] op_sel_hi:[1,0]
v_pk_mul_f16 v73, v73, v34 op_sel:[0,0] op_sel_hi:[1,0]
v_lshrrev_b32 v113, 20, v20
v_lshrrev_b32 v114, 12, v20
v_bfi_b32 v113, 15, v114, v113
v_add_u32 v72, 0x00040004, v72
v_add_u32 v73, 0x00040004, v73
v_lshl_or_b32 v114, v113, 13, v113
v_lshrrev_b32 v115, 6, v113
v_bfi_b32 v72, s72, v114, v72
v_lshl_or_b32 v115, v115, 13, v115
v_bfi_b32 v73, s72, v115, v73
v_pk_mul_f16 v74, v74, v34 op_sel:[0,1] op_sel_hi:[1,1]
v_pk_mul_f16 v75, v75, v34 op_sel:[0,1] op_sel_hi:[1,1]
v_lshrrev_b32 v113, 20, v21
v_lshrrev_b32 v114, 12, v21
v_bfi_b32 v113, 15, v114, v113
v_add_u32 v74, 0x00040004, v74
v_add_u32 v75, 0x00040004, v75
v_lshl_or_b32 v114, v113, 13, v113
v_lshrrev_b32 v115, 6, v113
v_bfi_b32 v74, s72, v114, v74
v_lshl_or_b32 v115, v115, 13, v115
v_bfi_b32 v75, s72, v115, v75
v_pk_mul_f16 v76, v76, v35 op_sel:[0,0] op_sel_hi:[1,0]
v_pk_mul_f16 v77, v77, v35 op_sel:[0,0] op_sel_hi:[1,0]
v_lshrrev_b32 v113, 20, v22
v_lshrrev_b32 v114, 12, v22
v_bfi_b32 v113, 15, v114, v113
v_add_u32 v76, 0x00040004, v76
v_add_u32 v77, 0x00040004, v77
v_lshl_or_b32 v114, v113, 13, v113
v_lshrrev_b32 v115, 6, v113
v_bfi_b32 v76, s72, v114, v76
v_lshl_or_b32 v115, v115, 13, v115
v_bfi_b32 v77, s72, v115, v77
v_pk_mul_f16 v78, v78, v35 op_sel:[0,1] op_sel_hi:[1,1]
v_pk_mul_f16 v79, v79, v35 op_sel:[0,1] op_sel_hi:[1,1]
v_lshrrev_b32 v113, 20, v23
v_lshrrev_b32 v114, 12, v23
v_bfi_b32 v113, 15, v114, v113
v_add_u32 v78, 0x00040004, v78
v_add_u32 v79, 0x00040004, v79
v_lshl_or_b32 v114, v113, 13, v113
v_lshrrev_b32 v115, 6, v113
v_bfi_b32 v78, s72, v114, v78
v_lshl_or_b32 v115, v115, 13, v115
v_bfi_b32 v79, s72, v115, v79
s_waitcnt lgkmcnt(8)
v_lshl_or_b32 v20, v108, 18, v104
v_lshl_or_b32 v21, v109, 18, v105
v_lshl_or_b32 v22, v110, 18, v106
v_lshl_or_b32 v23, v111, 18, v107
v_lshlrev_b32 v112, 3, v28
v_and_b32 v112, 0x7ff8, v112
ds_read_b64 v[88:89], v112 offset:3072
v_lshlrev_b32 v112, 3, v29
v_and_b32 v112, 0x7ff8, v112
ds_read_b64 v[90:91], v112 offset:3072
v_lshlrev_b32 v112, 3, v30
v_and_b32 v112, 0x7ff8, v112
ds_read_b64 v[92:93], v112 offset:3072
v_lshlrev_b32 v112, 3, v31
v_and_b32 v112, 0x7ff8, v112
ds_read_b64 v[94:95], v112 offset:3072
v_cmp_ne_u16 vcc, 0, v38
v_lshrrev_b32 v104, 14, v28
v_and_b32 v104, 0x3fc, v104
v_cndmask_b32 v104, v12, v104, vcc
ds_add_rtn_u32 v108, v104, v14 offset:0
v_cmp_lt_u32 vcc, 0xffff, v38
v_lshrrev_b32 v105, 14, v29
v_and_b32 v105, 0x3fc, v105
v_cndmask_b32 v105, v12, v105, vcc
ds_add_rtn_u32 v109, v105, v14 offset:0
v_cmp_ne_u16 vcc, 0, v39
v_lshrrev_b32 v106, 14, v30
v_and_b32 v106, 0x3fc, v106
v_cndmask_b32 v106, v12, v106, vcc
ds_add_rtn_u32 v110, v106, v14 offset:0
v_cmp_lt_u32 vcc, 0xffff, v39
v_lshrrev_b32 v107, 14, v31
v_and_b32 v107, 0x3fc, v107
v_cndmask_b32 v107, v12, v107, vcc
ds_add_rtn_u32 v111, v107, v14 offset:0
s_waitcnt lgkmcnt(12)
v_pk_mul_f16 v80, v80, v36 op_sel:[0,0] op_sel_hi:[1,0]
v_pk_mul_f16 v81, v81, v36 op_sel:[0,0] op_sel_hi:[1,0]
v_lshrrev_b32 v113, 20, v24
v_lshrrev_b32 v114, 12, v24
v_bfi_b32 v113, 15, v114, v113
v_add_u32 v80, 0x00040004, v80
v_add_u32 v81, 0x00040004, v81
v_lshl_or_b32 v114, v113, 13, v113
v_lshrrev_b32 v115, 6, v113
v_bfi_b32 v80, s72, v114, v80
v_lshl_or_b32 v115, v115, 13, v115
v_bfi_b32 v81, s72, v115, v81
v_pk_mul_f16 v82, v82, v36 op_sel:[0,1] op_sel_hi:[1,1]
v_pk_mul_f16 v83, v83, v36 op_sel:[0,1] op_sel_hi:[1,1]
v_lshrrev_b32 v113, 20, v25
v_lshrrev_b32 v114, 12, v25
v_bfi_b32 v113, 15, v114, v113
v_add_u32 v82, 0x00040004, v82
v_add_u32 v83, 0x00040004, v83
v_lshl_or_b32 v114, v113, 13, v113
v_lshrrev_b32 v115, 6, v113
v_bfi_b32 v82, s72, v114, v82
v_lshl_or_b32 v115, v115, 13, v115
v_bfi_b32 v83, s72, v115, v83
v_pk_mul_f16 v84, v84, v37 op_sel:[0,0] op_sel_hi:[1,0]
v_pk_mul_f16 v85, v85, v37 op_sel:[0,0] op_sel_hi:[1,0]
v_lshrrev_b32 v113, 20, v26
v_lshrrev_b32 v114, 12, v26
v_bfi_b32 v113, 15, v114, v113
v_add_u32 v84, 0x00040004, v84
v_add_u32 v85, 0x00040004, v85
v_lshl_or_b32 v114, v113, 13, v113
v_lshrrev_b32 v115, 6, v113
v_bfi_b32 v84, s72, v114, v84
v_lshl_or_b32 v115, v115, 13, v115
v_bfi_b32 v85, s72, v115, v85
v_pk_mul_f16 v86, v86, v37 op_sel:[0,1] op_sel_hi:[1,1]
v_pk_mul_f16 v87, v87, v37 op_sel:[0,1] op_sel_hi:[1,1]
v_lshrrev_b32 v113, 20, v27
v_lshrrev_b32 v114, 12, v27
v_bfi_b32 v113, 15, v114, v113
v_add_u32 v86, 0x00040004, v86
v_add_u32 v87, 0x00040004, v87
v_lshl_or_b32 v114, v113, 13, v113
v_lshrrev_b32 v115, 6, v113
v_bfi_b32 v86, s72, v114, v86
v_lshl_or_b32 v115, v115, 13, v115
v_bfi_b32 v87, s72, v115, v87
s_waitcnt lgkmcnt(8)
v_lshl_or_b32 v24, v100, 18, v96
v_lshl_or_b32 v25, v101, 18, v97
v_lshl_or_b32 v26, v102, 18, v98
v_lshl_or_b32 v27, v103, 18, v99
s_waitcnt lgkmcnt(4)
v_pk_mul_f16 v88, v88, v38 op_sel:[0,0] op_sel_hi:[1,0]
v_pk_mul_f16 v89, v89, v38 op_sel:[0,0] op_sel_hi:[1,0]
v_lshrrev_b32 v113, 20, v28
v_lshrrev_b32 v114, 12, v28
v_bfi_b32 v113, 15, v114, v113
v_add_u32 v88, 0x00040004, v88
v_add_u32 v89, 0x00040004, v89
v_lshl_or_b32 v114, v113, 13, v113
v_lshrrev_b32 v115, 6, v113
v_bfi_b32 v88, s72, v114, v88
v_lshl_or_b32 v115, v115, 13, v115
v_bfi_b32 v89, s72, v115, v89
v_pk_mul_f16 v90, v90, v38 op_sel:[0,1] op_sel_hi:[1,1]
v_pk_mul_f16 v91, v91, v38 op_sel:[0,1] op_sel_hi:[1,1]
v_lshrrev_b32 v113, 20, v29
v_lshrrev_b32 v114, 12, v29
v_bfi_b32 v113, 15, v114, v113
v_add_u32 v90, 0x00040004, v90
v_add_u32 v91, 0x00040004, v91
v_lshl_or_b32 v114, v113, 13, v113
v_lshrrev_b32 v115, 6, v113
v_bfi_b32 v90, s72, v114, v90
v_lshl_or_b32 v115, v115, 13, v115
v_bfi_b32 v91, s72, v115, v91
v_pk_mul_f16 v92, v92, v39 op_sel:[0,0] op_sel_hi:[1,0]
v_pk_mul_f16 v93, v93, v39 op_sel:[0,0] op_sel_hi:[1,0]
v_lshrrev_b32 v113, 20, v30
v_lshrrev_b32 v114, 12, v30
v_bfi_b32 v113, 15, v114, v113
v_add_u32 v92, 0x00040004, v92
v_add_u32 v93, 0x00040004, v93
v_lshl_or_b32 v114, v113, 13, v113
v_lshrrev_b32 v115, 6, v113
v_bfi_b32 v92, s72, v114, v92
v_lshl_or_b32 v115, v115, 13, v115
v_bfi_b32 v93, s72, v115, v93
v_pk_mul_f16 v94, v94, v39 op_sel:[0,1] op_sel_hi:[1,1]
v_pk_mul_f16 v95, v95, v39 op_sel:[0,1] op_sel_hi:[1,1]
v_lshrrev_b32 v113, 20, v31
v_lshrrev_b32 v114, 12, v31
v_bfi_b32 v113, 15, v114, v113
v_add_u32 v94, 0x00040004, v94
v_add_u32 v95, 0x00040004, v95
v_lshl_or_b32 v114, v113, 13, v113
v_lshrrev_b32 v115, 6, v113
v_bfi_b32 v94, s72, v114, v94
v_lshl_or_b32 v115, v115, 13, v115
v_bfi_b32 v95, s72, v115, v95
s_waitcnt lgkmcnt(0)
v_lshl_or_b32 v28, v108, 18, v104
v_lshl_or_b32 v29, v109, 18, v105
v_lshl_or_b32 v30, v110, 18, v106
v_lshl_or_b32 v31, v111, 18, v107
s_barrier
ds_read_b128 v[96:99], v2 offset:0
s_waitcnt lgkmcnt(0)
v_add_u32 v100, 1, v96
v_lshrrev_b32 v100, 1, v100
v_add_u32 v101, 1, v97
v_lshrrev_b32 v101, 1, v101
v_add_u32 v102, 1, v98
v_lshrrev_b32 v102, 1, v102
v_add_u32 v103, 1, v99
v_lshrrev_b32 v103, 1, v103
v_add_u32 v106, v100, v101
v_add_u32 v107, v106, v102
v_add_u32 v108, v107, v103
v_mov_b32 v109, v108
s_nop 1
v_add_u32_dpp v109, v109, v109 row_shr:1 row_mask:0xf bank_mask:0xf bound_ctrl:0
s_nop 1
v_add_u32_dpp v109, v109, v109 row_shr:2 row_mask:0xf bank_mask:0xf bound_ctrl:0
s_nop 1
v_add_u32_dpp v109, v109, v109 row_shr:4 row_mask:0xf bank_mask:0xf bound_ctrl:0
s_nop 1
v_add_u32_dpp v109, v109, v109 row_shr:8 row_mask:0xf bank_mask:0xf bound_ctrl:0
s_nop 1
v_add_u32_dpp v109, v109, v109 row_bcast:15 row_mask:0xa bank_mask:0xf
s_nop 1
v_add_u32_dpp v109, v109, v109 row_bcast:31 row_mask:0xc bank_mask:0xf
v_sub_u32 v104, v109, v108
v_add_u32 v105, v104, v100
v_add_u32 v106, v104, v106
v_add_u32 v107, v104, v107
v_readlane_b32 s61, v109, 63
v_lshl_or_b32 v100, v100, 16, v104
v_lshl_or_b32 v101, v101, 16, v105
v_lshl_or_b32 v102, v102, 16, v106
v_lshl_or_b32 v103, v103, 16, v107
v_lshlrev_b32 v104, 4, v104
v_lshlrev_b32 v105, 4, v105
v_lshlrev_b32 v106, 4, v106
v_lshlrev_b32 v107, 4, v107
ds_write_b128 v2, v[104:107] offset:2048
ds_write_b128 v2, v[4:7] offset:1024
s_cmp_lg_u32 s43, 0
s_cbranch_scc1 k2w0_24
s_mul_i32 s50, s42, 7
s_add_u32 s50, s50, 0
s_lshl_b32 s50, s50, 10
buffer_store_dwordx4 v[100:103], v2, s[32:35], s50 offen
v_and_b32 v111, 1, v96
v_cmp_eq_u32 vcc, 1, v111
v_lshl_add_u32 v110, v96, 3, v104
s_nop 0
v_cndmask_b32 v110, v12, v110, vcc
ds_write_b64 v110, v[4:5] offset:28160
v_and_b32 v111, 1, v97
v_cmp_eq_u32 vcc, 1, v111
v_lshl_add_u32 v110, v97, 3, v105
s_nop 0
v_cndmask_b32 v110, v12, v110, vcc
ds_write_b64 v110, v[4:5] offset:28160
v_and_b32 v111, 1, v98
v_cmp_eq_u32 vcc, 1, v111
v_lshl_add_u32 v110, v98, 3, v106
s_nop 0
v_cndmask_b32 v110, v12, v110, vcc
ds_write_b64 v110, v[4:5] offset:28160
v_and_b32 v111, 1, v99
v_cmp_eq_u32 vcc, 1, v111
v_lshl_add_u32 v110, v99, 3, v107
s_nop 0
v_cndmask_b32 v110, v12, v110, vcc
ds_write_b64 v110, v[4:5] offset:28160
k2w0_24:
s_mul_i32 s50, s42, 7
s_add_u32 s50, s50, 0
s_mul_i32 s51, s50, 133120
s_add_u32 s28, s52, s51
s_addc_u32 s29, s53, 0
s_and_b32 s29, s29, 0xffff
s_lshl_b32 s30, s61, 4
s_add_u32 s30, s30, 127
s_and_b32 s30, s30, 0xffffff80
s_waitcnt lgkmcnt(0)
s_cmp_lt_u32 s64, s46
s_cbranch_scc1 k2ns_25
s_cmp_lg_u32 s65, 0
s_cbranch_scc1 k2ns_25
v_mov_b32 v8, v10
v_mov_b32 v9, v11
s_mov_b32 s46, s47
s_mov_b32 s64, 0
s_mov_b32 s65, 1
s_mov_b32 s66, 0
v_readlane_b32 s67, v8, 0
k2ns_25:
v_mov_b32 v96, s68
s_add_u32 s69, s64, 64
s_cmp_lt_u32 s67, s69
s_cbranch_scc0 gwek2_27
gwk2_26:
v_readlane_b32 s68, v9, s66
s_add_u32 s66, s66, 1
s_sub_u32 s70, s67, s64
s_max_i32 s70, s70, 0
v_readlane_b32 s67, v8, s66
s_lshl_b64 exec, -1, s70
v_mov_b32 v96, s68
s_cmp_lt_u32 s67, s69
s_cbranch_scc1 gwk2_26
s_mov_b64 exec, -1
gwek2_27:
v_add3_u32 v96, v96, s64, v3
s_add_u32 s64, s64, 64
v_mul_u32_u24 v96, 24, v96
buffer_load_dwordx4 v[40:43], v96, s[8:11], 0 offen
buffer_load_dwordx2 v[56:57], v96, s[8:11], 0 offen offset:16
s_cmp_lt_u32 s64, s46
s_cbranch_scc1 k2ns_28
s_cmp_lg_u32 s65, 0
s_cbranch_scc1 k2ns_28
v_mov_b32 v8, v10
v_mov_b32 v9, v11
s_mov_b32 s46, s47
s_mov_b32 s64, 0
s_mov_b32 s65, 1
s_mov_b32 s66, 0
v_readlane_b32 s67, v8, 0
k2ns_28:
v_mov_b32 v98, s68
s_add_u32 s69, s64, 64
s_cmp_lt_u32 s67, s69
s_cbranch_scc0 gwek2_30
gwk2_29:
v_readlane_b32 s68, v9, s66
s_add_u32 s66, s66, 1
s_sub_u32 s70, s67, s64
s_max_i32 s70, s70, 0
v_readlane_b32 s67, v8, s66
s_lshl_b64 exec, -1, s70
v_mov_b32 v98, s68
s_cmp_lt_u32 s67, s69
s_cbranch_scc1 gwk2_29
s_mov_b64 exec, -1
gwek2_30:
v_add3_u32 v98, v98, s64, v3
s_add_u32 s64, s64, 64
v_mul_u32_u24 v98, 24, v98
buffer_load_dwordx4 v[44:47], v98, s[8:11], 0 offen
buffer_load_dwordx2 v[58:59], v98, s[8:11], 0 offen offset:16
s_cmp_lt_u32 s64, s46
s_cbranch_scc1 k2ns_31
s_cmp_lg_u32 s65, 0
s_cbranch_scc1 k2ns_31
v_mov_b32 v8, v10
v_mov_b32 v9, v11
s_mov_b32 s46, s47
s_mov_b32 s64, 0
s_mov_b32 s65, 1
s_mov_b32 s66, 0
v_readlane_b32 s67, v8, 0
k2ns_31:
v_mov_b32 v100, s68
s_add_u32 s69, s64, 64
s_cmp_lt_u32 s67, s69
s_cbranch_scc0 gwek2_33
gwk2_32:
v_readlane_b32 s68, v9, s66
s_add_u32 s66, s66, 1
s_sub_u32 s70, s67, s64
s_max_i32 s70, s70, 0
v_readlane_b32 s67, v8, s66
s_lshl_b64 exec, -1, s70
v_mov_b32 v100, s68
s_cmp_lt_u32 s67, s69
s_cbranch_scc1 gwk2_32
s_mov_b64 exec, -1
gwek2_33:
v_add3_u32 v100, v100, s64, v3
s_add_u32 s64, s64, 64
v_mul_u32_u24 v100, 24, v100
buffer_load_dwordx4 v[48:51], v100, s[8:11], 0 offen
buffer_load_dwordx2 v[60:61], v100, s[8:11], 0 offen offset:16
s_cmp_lt_u32 s64, s46
s_cbranch_scc1 k2ns_34
s_cmp_lg_u32 s65, 0
s_cbranch_scc1 k2ns_34
v_mov_b32 v8, v10
v_mov_b32 v9, v11
s_mov_b32 s46, s47
s_mov_b32 s64, 0
s_mov_b32 s65, 1
s_mov_b32 s66, 0
v_readlane_b32 s67, v8, 0
k2ns_34:
v_mov_b32 v102, s68
s_add_u32 s69, s64, 64
s_cmp_lt_u32 s67, s69
s_cbranch_scc0 gwek2_36
gwk2_35:
v_readlane_b32 s68, v9, s66
s_add_u32 s66, s66, 1
s_sub_u32 s70, s67, s64
s_max_i32 s70, s70, 0
v_readlane_b32 s67, v8, s66
s_lshl_b64 exec, -1, s70
v_mov_b32 v102, s68
s_cmp_lt_u32 s67, s69
s_cbranch_scc1 gwk2_35
s_mov_b64 exec, -1
gwek2_36:
v_add3_u32 v102, v102, s64, v3
s_add_u32 s64, s64, 64
v_mul_u32_u24 v102, 24, v102
buffer_load_dwordx4 v[52:55], v102, s[8:11], 0 offen
buffer_load_dwordx2 v[62:63], v102, s[8:11], 0 offen offset:16
v_and_b32 v96, 0x3ffff, v16
ds_read_b32 v96, v96 offset:2048
v_and_b32 v97, 0x3ffff, v17
ds_read_b32 v97, v97 offset:2048
v_and_b32 v98, 0x3ffff, v18
ds_read_b32 v98, v98 offset:2048
v_and_b32 v99, 0x3ffff, v19
ds_read_b32 v99, v99 offset:2048
v_and_b32 v100, 0x3ffff, v20
ds_read_b32 v100, v100 offset:2048
v_and_b32 v101, 0x3ffff, v21
ds_read_b32 v101, v101 offset:2048
v_and_b32 v102, 0x3ffff, v22
ds_read_b32 v102, v102 offset:2048
v_and_b32 v103, 0x3ffff, v23
ds_read_b32 v103, v103 offset:2048
s_waitcnt lgkmcnt(0)
v_lshrrev_b32 v104, 18, v16
v_lshl_add_u32 v96, v104, 3, v96
v_and_or_b32 v96, v16, s73, v96
ds_write_b64 v96, v[64:65] offset:28160
v_lshrrev_b32 v104, 18, v17
v_lshl_add_u32 v97, v104, 3, v97
v_and_or_b32 v97, v17, s73, v97
ds_write_b64 v97, v[66:67] offset:28160
v_lshrrev_b32 v104, 18, v18
v_lshl_add_u32 v98, v104, 3, v98
v_and_or_b32 v98, v18, s73, v98
ds_write_b64 v98, v[68:69] offset:28160
v_lshrrev_b32 v104, 18, v19
v_lshl_add_u32 v99, v104, 3, v99
v_and_or_b32 v99, v19, s73, v99
ds_write_b64 v99, v[70:71] offset:28160
v_lshrrev_b32 v104, 18, v20
v_lshl_add_u32 v100, v104, 3, v100
v_and_or_b32 v100, v20, s73, v100
ds_write_b64 v100, v[72:73] offset:28160
v_lshrrev_b32 v104, 18, v21
v_lshl_add_u32 v101, v104, 3, v101
v_and_or_b32 v101, v21, s73, v101
ds_write_b64 v101, v[74:75] offset:28160
v_lshrrev_b32 v104, 18, v22
v_lshl_add_u32 v102, v104, 3, v102
v_and_or_b32 v102, v22, s73, v102
ds_write_b64 v102, v[76:77] offset:28160
v_lshrrev_b32 v104, 18, v23
v_lshl_add_u32 v103, v104, 3, v103
v_and_or_b32 v103, v23, s73, v103
ds_write_b64 v103, v[78:79] offset:28160
v_and_b32 v96, 0x3ffff, v24
ds_read_b32 v96, v96 offset:2048
v_and_b32 v97, 0x3ffff, v25
ds_read_b32 v97, v97 offset:2048
v_and_b32 v98, 0x3ffff, v26
ds_read_b32 v98, v98 offset:2048
v_and_b32 v99, 0x3ffff, v27
ds_read_b32 v99, v99 offset:2048
v_and_b32 v100, 0x3ffff, v28
ds_read_b32 v100, v100 offset:2048
v_and_b32 v101, 0x3ffff, v29
ds_read_b32 v101, v101 offset:2048
v_and_b32 v102, 0x3ffff, v30
ds_read_b32 v102, v102 offset:2048
v_and_b32 v103, 0x3ffff, v31
ds_read_b32 v103, v103 offset:2048
s_waitcnt lgkmcnt(0)
v_lshrrev_b32 v104, 18, v24
v_lshl_add_u32 v96, v104, 3, v96
v_and_or_b32 v96, v24, s73, v96
ds_write_b64 v96, v[80:81] offset:28160
v_lshrrev_b32 v104, 18, v25
v_lshl_add_u32 v97, v104, 3, v97
v_and_or_b32 v97, v25, s73, v97
ds_write_b64 v97, v[82:83] offset:28160
v_lshrrev_b32 v104, 18, v26
v_lshl_add_u32 v98, v104, 3, v98
v_and_or_b32 v98, v26, s73, v98
ds_write_b64 v98, v[84:85] offset:28160
v_lshrrev_b32 v104, 18, v27
v_lshl_add_u32 v99, v104, 3, v99
v_and_or_b32 v99, v27, s73, v99
ds_write_b64 v99, v[86:87] offset:28160
v_lshrrev_b32 v104, 18, v28
v_lshl_add_u32 v100, v104, 3, v100
v_and_or_b32 v100, v28, s73, v100
ds_write_b64 v100, v[88:89] offset:28160
v_lshrrev_b32 v104, 18, v29
v_lshl_add_u32 v101, v104, 3, v101
v_and_or_b32 v101, v29, s73, v101
ds_write_b64 v101, v[90:91] offset:28160
v_lshrrev_b32 v104, 18, v30
v_lshl_add_u32 v102, v104, 3, v102
v_and_or_b32 v102, v30, s73, v102
ds_write_b64 v102, v[92:93] offset:28160
v_lshrrev_b32 v104, 18, v31
v_lshl_add_u32 v103, v104, 3, v103
v_and_or_b32 v103, v31, s73, v103
ds_write_b64 v103, v[94:95] offset:28160
s_waitcnt lgkmcnt(0)
s_barrier
v_add_u32 v96, 0, v1
ds_read_b128 v[64:67], v96 offset:28160
v_add_u32 v97, 16384, v1
ds_read_b128 v[68:71], v97 offset:28160
v_add_u32 v98, 32768, v1
ds_read_b128 v[72:75], v98 offset:28160
v_add_u32 v99, 49152, v1
ds_read_b128 v[76:79], v99 offset:28160
v_add_u32 v100, 65536, v1
ds_read_b128 v[80:83], v100 offset:28160
v_add_u32 v101, 81920, v1
ds_read_b128 v[84:87], v101 offset:28160
v_add_u32 v102, 98304, v1
ds_read_b128 v[88:91], v102 offset:28160
v_add_u32 v103, 114688, v1
ds_read_b128 v[92:95], v103 offset:28160
v_add_u32 v104, 131072, v1
ds_read_b128 v[112:115], v104 offset:28160
s_waitcnt lgkmcnt(8)
buffer_store_dwordx4 v[64:67], v96, s[28:31], 0 offen nt
s_waitcnt lgkmcnt(7)
buffer_store_dwordx4 v[68:71], v97, s[28:31], 0 offen nt
s_waitcnt lgkmcnt(6)
buffer_store_dwordx4 v[72:75], v98, s[28:31], 0 offen nt
s_waitcnt lgkmcnt(5)
buffer_store_dwordx4 v[76:79], v99, s[28:31], 0 offen nt
s_waitcnt lgkmcnt(4)
buffer_store_dwordx4 v[80:83], v100, s[28:31], 0 offen nt
s_waitcnt lgkmcnt(3)
buffer_store_dwordx4 v[84:87], v101, s[28:31], 0 offen nt
s_waitcnt lgkmcnt(2)
buffer_store_dwordx4 v[88:91], v102, s[28:31], 0 offen nt
s_waitcnt lgkmcnt(1)
buffer_store_dwordx4 v[92:95], v103, s[28:31], 0 offen nt
s_waitcnt lgkmcnt(0)
buffer_store_dwordx4 v[112:115], v104, s[28:31], 0 offen nt
s_waitcnt vmcnt(9)
s_nop 0
v_lshlrev_b32 v112, 3, v40
v_and_b32 v112, 0x7ff8, v112
ds_read_b64 v[64:65], v112 offset:3072
v_lshlrev_b32 v112, 3, v41
v_and_b32 v112, 0x7ff8, v112
ds_read_b64 v[66:67], v112 offset:3072
v_lshlrev_b32 v112, 3, v42
v_and_b32 v112, 0x7ff8, v112
ds_read_b64 v[68:69], v112 offset:3072
v_lshlrev_b32 v112, 3, v43
v_and_b32 v112, 0x7ff8, v112
ds_read_b64 v[70:71], v112 offset:3072
v_cmp_ne_u16 vcc, 0, v56
v_lshrrev_b32 v96, 14, v40
v_and_b32 v96, 0x3fc, v96
v_cndmask_b32 v96, v12, v96, vcc
ds_add_rtn_u32 v100, v96, v14 offset:1024
v_cmp_lt_u32 vcc, 0xffff, v56
v_lshrrev_b32 v97, 14, v41
v_and_b32 v97, 0x3fc, v97
v_cndmask_b32 v97, v12, v97, vcc
ds_add_rtn_u32 v101, v97, v14 offset:1024
v_cmp_ne_u16 vcc, 0, v57
v_lshrrev_b32 v98, 14, v42
v_and_b32 v98, 0x3fc, v98
v_cndmask_b32 v98, v12, v98, vcc
ds_add_rtn_u32 v102, v98, v14 offset:1024
v_cmp_lt_u32 vcc, 0xffff, v57
v_lshrrev_b32 v99, 14, v43
v_and_b32 v99, 0x3fc, v99
v_cndmask_b32 v99, v12, v99, vcc
ds_add_rtn_u32 v103, v99, v14 offset:1024
v_lshlrev_b32 v112, 3, v44
v_and_b32 v112, 0x7ff8, v112
ds_read_b64 v[72:73], v112 offset:3072
v_lshlrev_b32 v112, 3, v45
v_and_b32 v112, 0x7ff8, v112
ds_read_b64 v[74:75], v112 offset:3072
v_lshlrev_b32 v112, 3, v46
v_and_b32 v112, 0x7ff8, v112
ds_read_b64 v[76:77], v112 offset:3072
v_lshlrev_b32 v112, 3, v47
v_and_b32 v112, 0x7ff8, v112
ds_read_b64 v[78:79], v112 offset:3072
v_cmp_ne_u16 vcc, 0, v58
v_lshrrev_b32 v104, 14, v44
v_and_b32 v104, 0x3fc, v104
v_cndmask_b32 v104, v12, v104, vcc
ds_add_rtn_u32 v108, v104, v14 offset:1024
v_cmp_lt_u32 vcc, 0xffff, v58
v_lshrrev_b32 v105, 14, v45
v_and_b32 v105, 0x3fc, v105
v_cndmask_b32 v105, v12, v105, vcc
ds_add_rtn_u32 v109, v105, v14 offset:1024
v_cmp_ne_u16 vcc, 0, v59
v_lshrrev_b32 v106, 14, v46
v_and_b32 v106, 0x3fc, v106
v_cndmask_b32 v106, v12, v106, vcc
ds_add_rtn_u32 v110, v106, v14 offset:1024
v_cmp_lt_u32 vcc, 0xffff, v59
v_lshrrev_b32 v107, 14, v47
v_and_b32 v107, 0x3fc, v107
v_cndmask_b32 v107, v12, v107, vcc
ds_add_rtn_u32 v111, v107, v14 offset:1024
s_waitcnt lgkmcnt(12)
v_pk_mul_f16 v64, v64, v56 op_sel:[0,0] op_sel_hi:[1,0]
v_pk_mul_f16 v65, v65, v56 op_sel:[0,0] op_sel_hi:[1,0]
v_lshrrev_b32 v113, 20, v40
v_lshrrev_b32 v114, 12, v40
v_bfi_b32 v113, 15, v114, v113
v_add_u32 v64, 0x00040004, v64
v_add_u32 v65, 0x00040004, v65
v_lshl_or_b32 v114, v113, 13, v113
v_lshrrev_b32 v115, 6, v113
v_bfi_b32 v64, s72, v114, v64
v_lshl_or_b32 v115, v115, 13, v115
v_bfi_b32 v65, s72, v115, v65
v_pk_mul_f16 v66, v66, v56 op_sel:[0,1] op_sel_hi:[1,1]
v_pk_mul_f16 v67, v67, v56 op_sel:[0,1] op_sel_hi:[1,1]
v_lshrrev_b32 v113, 20, v41
v_lshrrev_b32 v114, 12, v41
v_bfi_b32 v113, 15, v114, v113
v_add_u32 v66, 0x00040004, v66
v_add_u32 v67, 0x00040004, v67
v_lshl_or_b32 v114, v113, 13, v113
v_lshrrev_b32 v115, 6, v113
v_bfi_b32 v66, s72, v114, v66
v_lshl_or_b32 v115, v115, 13, v115
v_bfi_b32 v67, s72, v115, v67
v_pk_mul_f16 v68, v68, v57 op_sel:[0,0] op_sel_hi:[1,0]
v_pk_mul_f16 v69, v69, v57 op_sel:[0,0] op_sel_hi:[1,0]
v_lshrrev_b32 v113, 20, v42
v_lshrrev_b32 v114, 12, v42
v_bfi_b32 v113, 15, v114, v113
v_add_u32 v68, 0x00040004, v68
v_add_u32 v69, 0x00040004, v69
v_lshl_or_b32 v114, v113, 13, v113
v_lshrrev_b32 v115, 6, v113
v_bfi_b32 v68, s72, v114, v68
v_lshl_or_b32 v115, v115, 13, v115
v_bfi_b32 v69, s72, v115, v69
v_pk_mul_f16 v70, v70, v57 op_sel:[0,1] op_sel_hi:[1,1]
v_pk_mul_f16 v71, v71, v57 op_sel:[0,1] op_sel_hi:[1,1]
v_lshrrev_b32 v113, 20, v43
v_lshrrev_b32 v114, 12, v43
v_bfi_b32 v113, 15, v114, v113
v_add_u32 v70, 0x00040004, v70
v_add_u32 v71, 0x00040004, v71
v_lshl_or_b32 v114, v113, 13, v113
v_lshrrev_b32 v115, 6, v113
v_bfi_b32 v70, s72, v114, v70
v_lshl_or_b32 v115, v115, 13, v115
v_bfi_b32 v71, s72, v115, v71
s_waitcnt lgkmcnt(8)
v_lshl_or_b32 v40, v100, 18, v96
v_lshl_or_b32 v41, v101, 18, v97
v_lshl_or_b32 v42, v102, 18, v98
v_lshl_or_b32 v43, v103, 18, v99
v_lshlrev_b32 v112, 3, v48
v_and_b32 v112, 0x7ff8, v112
ds_read_b64 v[80:81], v112 offset:3072
v_lshlrev_b32 v112, 3, v49
v_and_b32 v112, 0x7ff8, v112
ds_read_b64 v[82:83], v112 offset:3072
v_lshlrev_b32 v112, 3, v50
v_and_b32 v112, 0x7ff8, v112
ds_read_b64 v[84:85], v112 offset:3072
v_lshlrev_b32 v112, 3, v51
v_and_b32 v112, 0x7ff8, v112
ds_read_b64 v[86:87], v112 offset:3072
v_cmp_ne_u16 vcc, 0, v60
v_lshrrev_b32 v96, 14, v48
v_and_b32 v96, 0x3fc, v96
v_cndmask_b32 v96, v12, v96, vcc
ds_add_rtn_u32 v100, v96, v14 offset:1024
v_cmp_lt_u32 vcc, 0xffff, v60
v_lshrrev_b32 v97, 14, v49
v_and_b32 v97, 0x3fc, v97
v_cndmask_b32 v97, v12, v97, vcc
ds_add_rtn_u32 v101, v97, v14 offset:1024
v_cmp_ne_u16 vcc, 0, v61
v_lshrrev_b32 v98, 14, v50
v_and_b32 v98, 0x3fc, v98
v_cndmask_b32 v98, v12, v98, vcc
ds_add_rtn_u32 v102, v98, v14 offset:1024
v_cmp_lt_u32 vcc, 0xffff, v61
v_lshrrev_b32 v99, 14, v51
v_and_b32 v99, 0x3fc, v99
v_cndmask_b32 v99, v12, v99, vcc
ds_add_rtn_u32 v103, v99, v14 offset:1024
s_waitcnt lgkmcnt(12)
v_pk_mul_f16 v72, v72, v58 op_sel:[0,0] op_sel_hi:[1,0]
v_pk_mul_f16 v73, v73, v58 op_sel:[0,0] op_sel_hi:[1,0]
v_lshrrev_b32 v113, 20, v44
v_lshrrev_b32 v114, 12, v44
v_bfi_b32 v113, 15, v114, v113
v_add_u32 v72, 0x00040004, v72
v_add_u32 v73, 0x00040004, v73
v_lshl_or_b32 v114, v113, 13, v113
v_lshrrev_b32 v115, 6, v113
v_bfi_b32 v72, s72, v114, v72
v_lshl_or_b32 v115, v115, 13, v115
v_bfi_b32 v73, s72, v115, v73
v_pk_mul_f16 v74, v74, v58 op_sel:[0,1] op_sel_hi:[1,1]
v_pk_mul_f16 v75, v75, v58 op_sel:[0,1] op_sel_hi:[1,1]
v_lshrrev_b32 v113, 20, v45
v_lshrrev_b32 v114, 12, v45
v_bfi_b32 v113, 15, v114, v113
v_add_u32 v74, 0x00040004, v74
v_add_u32 v75, 0x00040004, v75
v_lshl_or_b32 v114, v113, 13, v113
v_lshrrev_b32 v115, 6, v113
v_bfi_b32 v74, s72, v114, v74
v_lshl_or_b32 v115, v115, 13, v115
v_bfi_b32 v75, s72, v115, v75
v_pk_mul_f16 v76, v76, v59 op_sel:[0,0] op_sel_hi:[1,0]
v_pk_mul_f16 v77, v77, v59 op_sel:[0,0] op_sel_hi:[1,0]
v_lshrrev_b32 v113, 20, v46
v_lshrrev_b32 v114, 12, v46
v_bfi_b32 v113, 15, v114, v113
v_add_u32 v76, 0x00040004, v76
v_add_u32 v77, 0x00040004, v77
v_lshl_or_b32 v114, v113, 13, v113
v_lshrrev_b32 v115, 6, v113
v_bfi_b32 v76, s72, v114, v76
v_lshl_or_b32 v115, v115, 13, v115
v_bfi_b32 v77, s72, v115, v77
v_pk_mul_f16 v78, v78, v59 op_sel:[0,1] op_sel_hi:[1,1]
v_pk_mul_f16 v79, v79, v59 op_sel:[0,1] op_sel_hi:[1,1]
v_lshrrev_b32 v113, 20, v47
v_lshrrev_b32 v114, 12, v47
v_bfi_b32 v113, 15, v114, v113
v_add_u32 v78, 0x00040004, v78
v_add_u32 v79, 0x00040004, v79
v_lshl_or_b32 v114, v113, 13, v113
v_lshrrev_b32 v115, 6, v113
v_bfi_b32 v78, s72, v114, v78
v_lshl_or_b32 v115, v115, 13, v115
v_bfi_b32 v79, s72, v115, v79
s_waitcnt lgkmcnt(8)
v_lshl_or_b32 v44, v108, 18, v104
v_lshl_or_b32 v45, v109, 18, v105
v_lshl_or_b32 v46, v110, 18, v106
v_lshl_or_b32 v47, v111, 18, v107
v_lshlrev_b32 v112, 3, v52
v_and_b32 v112, 0x7ff8, v112
ds_read_b64 v[88:89], v112 offset:3072
v_lshlrev_b32 v112, 3, v53
v_and_b32 v112, 0x7ff8, v112
ds_read_b64 v[90:91], v112 offset:3072
v_lshlrev_b32 v112, 3, v54
v_and_b32 v112, 0x7ff8, v112
ds_read_b64 v[92:93], v112 offset:3072
v_lshlrev_b32 v112, 3, v55
v_and_b32 v112, 0x7ff8, v112
ds_read_b64 v[94:95], v112 offset:3072
v_cmp_ne_u16 vcc, 0, v62
v_lshrrev_b32 v104, 14, v52
v_and_b32 v104, 0x3fc, v104
v_cndmask_b32 v104, v12, v104, vcc
ds_add_rtn_u32 v108, v104, v14 offset:1024
v_cmp_lt_u32 vcc, 0xffff, v62
v_lshrrev_b32 v105, 14, v53
v_and_b32 v105, 0x3fc, v105
v_cndmask_b32 v105, v12, v105, vcc
ds_add_rtn_u32 v109, v105, v14 offset:1024
v_cmp_ne_u16 vcc, 0, v63
v_lshrrev_b32 v106, 14, v54
v_and_b32 v106, 0x3fc, v106
v_cndmask_b32 v106, v12, v106, vcc
ds_add_rtn_u32 v110, v106, v14 offset:1024
v_cmp_lt_u32 vcc, 0xffff, v63
v_lshrrev_b32 v107, 14, v55
v_and_b32 v107, 0x3fc, v107
v_cndmask_b32 v107, v12, v107, vcc
ds_add_rtn_u32 v111, v107, v14 offset:1024
s_waitcnt lgkmcnt(12)
v_pk_mul_f16 v80, v80, v60 op_sel:[0,0] op_sel_hi:[1,0]
v_pk_mul_f16 v81, v81, v60 op_sel:[0,0] op_sel_hi:[1,0]
v_lshrrev_b32 v113, 20, v48
v_lshrrev_b32 v114, 12, v48
v_bfi_b32 v113, 15, v114, v113
v_add_u32 v80, 0x00040004, v80
v_add_u32 v81, 0x00040004, v81
v_lshl_or_b32 v114, v113, 13, v113
v_lshrrev_b32 v115, 6, v113
v_bfi_b32 v80, s72, v114, v80
v_lshl_or_b32 v115, v115, 13, v115
v_bfi_b32 v81, s72, v115, v81
v_pk_mul_f16 v82, v82, v60 op_sel:[0,1] op_sel_hi:[1,1]
v_pk_mul_f16 v83, v83, v60 op_sel:[0,1] op_sel_hi:[1,1]
v_lshrrev_b32 v113, 20, v49
v_lshrrev_b32 v114, 12, v49
v_bfi_b32 v113, 15, v114, v113
v_add_u32 v82, 0x00040004, v82
v_add_u32 v83, 0x00040004, v83
v_lshl_or_b32 v114, v113, 13, v113
v_lshrrev_b32 v115, 6, v113
v_bfi_b32 v82, s72, v114, v82
v_lshl_or_b32 v115, v115, 13, v115
v_bfi_b32 v83, s72, v115, v83
v_pk_mul_f16 v84, v84, v61 op_sel:[0,0] op_sel_hi:[1,0]
v_pk_mul_f16 v85, v85, v61 op_sel:[0,0] op_sel_hi:[1,0]
v_lshrrev_b32 v113, 20, v50
v_lshrrev_b32 v114, 12, v50
v_bfi_b32 v113, 15, v114, v113
v_add_u32 v84, 0x00040004, v84
v_add_u32 v85, 0x00040004, v85
v_lshl_or_b32 v114, v113, 13, v113
v_lshrrev_b32 v115, 6, v113
v_bfi_b32 v84, s72, v114, v84
v_lshl_or_b32 v115, v115, 13, v115
v_bfi_b32 v85, s72, v115, v85
v_pk_mul_f16 v86, v86, v61 op_sel:[0,1] op_sel_hi:[1,1]
v_pk_mul_f16 v87, v87, v61 op_sel:[0,1] op_sel_hi:[1,1]
v_lshrrev_b32 v113, 20, v51
v_lshrrev_b32 v114, 12, v51
v_bfi_b32 v113, 15, v114, v113
v_add_u32 v86, 0x00040004, v86
v_add_u32 v87, 0x00040004, v87
v_lshl_or_b32 v114, v113, 13, v113
v_lshrrev_b32 v115, 6, v113
v_bfi_b32 v86, s72, v114, v86
v_lshl_or_b32 v115, v115, 13, v115
v_bfi_b32 v87, s72, v115, v87
s_waitcnt lgkmcnt(8)
v_lshl_or_b32 v48, v100, 18, v96
v_lshl_or_b32 v49, v101, 18, v97
v_lshl_or_b32 v50, v102, 18, v98
v_lshl_or_b32 v51, v103, 18, v99
s_waitcnt lgkmcnt(4)
v_pk_mul_f16 v88, v88, v62 op_sel:[0,0] op_sel_hi:[1,0]
v_pk_mul_f16 v89, v89, v62 op_sel:[0,0] op_sel_hi:[1,0]
v_lshrrev_b32 v113, 20, v52
v_lshrrev_b32 v114, 12, v52
v_bfi_b32 v113, 15, v114, v113
v_add_u32 v88, 0x00040004, v88
v_add_u32 v89, 0x00040004, v89
v_lshl_or_b32 v114, v113, 13, v113
v_lshrrev_b32 v115, 6, v113
v_bfi_b32 v88, s72, v114, v88
v_lshl_or_b32 v115, v115, 13, v115
v_bfi_b32 v89, s72, v115, v89
v_pk_mul_f16 v90, v90, v62 op_sel:[0,1] op_sel_hi:[1,1]
v_pk_mul_f16 v91, v91, v62 op_sel:[0,1] op_sel_hi:[1,1]
v_lshrrev_b32 v113, 20, v53
v_lshrrev_b32 v114, 12, v53
v_bfi_b32 v113, 15, v114, v113
v_add_u32 v90, 0x00040004, v90
v_add_u32 v91, 0x00040004, v91
v_lshl_or_b32 v114, v113, 13, v113
v_lshrrev_b32 v115, 6, v113
v_bfi_b32 v90, s72, v114, v90
v_lshl_or_b32 v115, v115, 13, v115
v_bfi_b32 v91, s72, v115, v91
v_pk_mul_f16 v92, v92, v63 op_sel:[0,0] op_sel_hi:[1,0]
v_pk_mul_f16 v93, v93, v63 op_sel:[0,0] op_sel_hi:[1,0]
v_lshrrev_b32 v113, 20, v54
v_lshrrev_b32 v114, 12, v54
v_bfi_b32 v113, 15, v114, v113
v_add_u32 v92, 0x00040004, v92
v_add_u32 v93, 0x00040004, v93
v_lshl_or_b32 v114, v113, 13, v113
v_lshrrev_b32 v115, 6, v113
v_bfi_b32 v92, s72, v114, v92
v_lshl_or_b32 v115, v115, 13, v115
v_bfi_b32 v93, s72, v115, v93
v_pk_mul_f16 v94, v94, v63 op_sel:[0,1] op_sel_hi:[1,1]
v_pk_mul_f16 v95, v95, v63 op_sel:[0,1] op_sel_hi:[1,1]
v_lshrrev_b32 v113, 20, v55
v_lshrrev_b32 v114, 12, v55
v_bfi_b32 v113, 15, v114, v113
v_add_u32 v94, 0x00040004, v94
v_add_u32 v95, 0x00040004, v95
v_lshl_or_b32 v114, v113, 13, v113
v_lshrrev_b32 v115, 6, v113
v_bfi_b32 v94, s72, v114, v94
v_lshl_or_b32 v115, v115, 13, v115
v_bfi_b32 v95, s72, v115, v95
s_waitcnt lgkmcnt(0)
v_lshl_or_b32 v52, v108, 18, v104
v_lshl_or_b32 v53, v109, 18, v105
v_lshl_or_b32 v54, v110, 18, v106
v_lshl_or_b32 v55, v111, 18, v107
s_barrier
ds_read_b128 v[96:99], v2 offset:1024
s_waitcnt lgkmcnt(0)
v_add_u32 v100, 1, v96
v_lshrrev_b32 v100, 1, v100
v_add_u32 v101, 1, v97
v_lshrrev_b32 v101, 1, v101
v_add_u32 v102, 1, v98
v_lshrrev_b32 v102, 1, v102
v_add_u32 v103, 1, v99
v_lshrrev_b32 v103, 1, v103
v_add_u32 v106, v100, v101
v_add_u32 v107, v106, v102
v_add_u32 v108, v107, v103
v_mov_b32 v109, v108
s_nop 1
v_add_u32_dpp v109, v109, v109 row_shr:1 row_mask:0xf bank_mask:0xf bound_ctrl:0
s_nop 1
v_add_u32_dpp v109, v109, v109 row_shr:2 row_mask:0xf bank_mask:0xf bound_ctrl:0
s_nop 1
v_add_u32_dpp v109, v109, v109 row_shr:4 row_mask:0xf bank_mask:0xf bound_ctrl:0
s_nop 1
v_add_u32_dpp v109, v109, v109 row_shr:8 row_mask:0xf bank_mask:0xf bound_ctrl:0
s_nop 1
v_add_u32_dpp v109, v109, v109 row_bcast:15 row_mask:0xa bank_mask:0xf
s_nop 1
v_add_u32_dpp v109, v109, v109 row_bcast:31 row_mask:0xc bank_mask:0xf
v_sub_u32 v104, v109, v108
v_add_u32 v105, v104, v100
v_add_u32 v106, v104, v106
v_add_u32 v107, v104, v107
v_readlane_b32 s61, v109, 63
v_lshl_or_b32 v100, v100, 16, v104
v_lshl_or_b32 v101, v101, 16, v105
v_lshl_or_b32 v102, v102, 16, v106
v_lshl_or_b32 v103, v103, 16, v107
v_lshlrev_b32 v104, 4, v104
v_lshlrev_b32 v105, 4, v105
v_lshlrev_b32 v106, 4, v106
v_lshlrev_b32 v107, 4, v107
ds_write_b128 v2, v[104:107] offset:2048
ds_write_b128 v2, v[4:7] offset:0
s_cmp_lg_u32 s43, 0
s_cbranch_scc1 k2w0_37
s_mul_i32 s50, s42, 7
s_add_u32 s50, s50, 1
s_lshl_b32 s50, s50, 10
buffer_store_dwordx4 v[100:103], v2, s[32:35], s50 offen
v_and_b32 v111, 1, v96
v_cmp_eq_u32 vcc, 1, v111
v_lshl_add_u32 v110, v96, 3, v104
s_nop 0
v_cndmask_b32 v110, v12, v110, vcc
ds_write_b64 v110, v[4:5] offset:28160
v_and_b32 v111, 1, v97
v_cmp_eq_u32 vcc, 1, v111
v_lshl_add_u32 v110, v97, 3, v105
s_nop 0
v_cndmask_b32 v110, v12, v110, vcc
ds_write_b64 v110, v[4:5] offset:28160
v_and_b32 v111, 1, v98
v_cmp_eq_u32 vcc, 1, v111
v_lshl_add_u32 v110, v98, 3, v106
s_nop 0
v_cndmask_b32 v110, v12, v110, vcc
ds_write_b64 v110, v[4:5] offset:28160
v_and_b32 v111, 1, v99
v_cmp_eq_u32 vcc, 1, v111
v_lshl_add_u32 v110, v99, 3, v107
s_nop 0
v_cndmask_b32 v110, v12, v110, vcc
ds_write_b64 v110, v[4:5] offset:28160
k2w0_37:
s_mul_i32 s50, s42, 7
s_add_u32 s50, s50, 1
s_mul_i32 s51, s50, 133120
s_add_u32 s28, s52, s51
s_addc_u32 s29, s53, 0
s_and_b32 s29, s29, 0xffff
s_lshl_b32 s30, s61, 4
s_add_u32 s30, s30, 127
s_and_b32 s30, s30, 0xffffff80
s_waitcnt lgkmcnt(0)
s_cmp_lt_u32 s64, s46
s_cbranch_scc1 k2ns_38
s_cmp_lg_u32 s65, 0
s_cbranch_scc1 k2ns_38
v_mov_b32 v8, v10
v_mov_b32 v9, v11
s_mov_b32 s46, s47
s_mov_b32 s64, 0
s_mov_b32 s65, 1
s_mov_b32 s66, 0
v_readlane_b32 s67, v8, 0
k2ns_38:
v_mov_b32 v96, s68
s_add_u32 s69, s64, 64
s_cmp_lt_u32 s67, s69
s_cbranch_scc0 gwek2_40
gwk2_39:
v_readlane_b32 s68, v9, s66
s_add_u32 s66, s66, 1
s_sub_u32 s70, s67, s64
s_max_i32 s70, s70, 0
v_readlane_b32 s67, v8, s66
s_lshl_b64 exec, -1, s70
v_mov_b32 v96, s68
s_cmp_lt_u32 s67, s69
s_cbranch_scc1 gwk2_39
s_mov_b64 exec, -1
gwek2_40:
v_add3_u32 v96, v96, s64, v3
s_add_u32 s64, s64, 64
v_mul_u32_u24 v96, 24, v96
buffer_load_dwordx4 v[16:19], v96, s[8:11], 0 offen
buffer_load_dwordx2 v[32:33], v96, s[8:11], 0 offen offset:16
s_cmp_lt_u32 s64, s46
s_cbranch_scc1 k2ns_41
s_cmp_lg_u32 s65, 0
s_cbranch_scc1 k2ns_41
v_mov_b32 v8, v10
v_mov_b32 v9, v11
s_mov_b32 s46, s47
s_mov_b32 s64, 0
s_mov_b32 s65, 1
s_mov_b32 s66, 0
v_readlane_b32 s67, v8, 0
k2ns_41:
v_mov_b32 v98, s68
s_add_u32 s69, s64, 64
s_cmp_lt_u32 s67, s69
s_cbranch_scc0 gwek2_43
gwk2_42:
v_readlane_b32 s68, v9, s66
s_add_u32 s66, s66, 1
s_sub_u32 s70, s67, s64
s_max_i32 s70, s70, 0
v_readlane_b32 s67, v8, s66
s_lshl_b64 exec, -1, s70
v_mov_b32 v98, s68
s_cmp_lt_u32 s67, s69
s_cbranch_scc1 gwk2_42
s_mov_b64 exec, -1
gwek2_43:
v_add3_u32 v98, v98, s64, v3
s_add_u32 s64, s64, 64
v_mul_u32_u24 v98, 24, v98
buffer_load_dwordx4 v[20:23], v98, s[8:11], 0 offen
buffer_load_dwordx2 v[34:35], v98, s[8:11], 0 offen offset:16
s_cmp_lt_u32 s64, s46
s_cbranch_scc1 k2ns_44
s_cmp_lg_u32 s65, 0
s_cbranch_scc1 k2ns_44
v_mov_b32 v8, v10
v_mov_b32 v9, v11
s_mov_b32 s46, s47
s_mov_b32 s64, 0
s_mov_b32 s65, 1
s_mov_b32 s66, 0
v_readlane_b32 s67, v8, 0
k2ns_44:
v_mov_b32 v100, s68
s_add_u32 s69, s64, 64
s_cmp_lt_u32 s67, s69
s_cbranch_scc0 gwek2_46
gwk2_45:
v_readlane_b32 s68, v9, s66
s_add_u32 s66, s66, 1
s_sub_u32 s70, s67, s64
s_max_i32 s70, s70, 0
v_readlane_b32 s67, v8, s66
s_lshl_b64 exec, -1, s70
v_mov_b32 v100, s68
s_cmp_lt_u32 s67, s69
s_cbranch_scc1 gwk2_45
s_mov_b64 exec, -1
gwek2_46:
v_add3_u32 v100, v100, s64, v3
s_add_u32 s64, s64, 64
v_mul_u32_u24 v100, 24, v100
buffer_load_dwordx4 v[24:27], v100, s[8:11], 0 offen
buffer_load_dwordx2 v[36:37], v100, s[8:11], 0 offen offset:16
s_cmp_lt_u32 s64, s46
s_cbranch_scc1 k2ns_47
s_cmp_lg_u32 s65, 0
s_cbranch_scc1 k2ns_47
v_mov_b32 v8, v10
v_mov_b32 v9, v11
s_mov_b32 s46, s47
s_mov_b32 s64, 0
s_mov_b32 s65, 1
s_mov_b32 s66, 0
v_readlane_b32 s67, v8, 0
k2ns_47:
v_mov_b32 v102, s68
s_add_u32 s69, s64, 64
s_cmp_lt_u32 s67, s69
s_cbranch_scc0 gwek2_49
gwk2_48:
v_readlane_b32 s68, v9, s66
s_add_u32 s66, s66, 1
s_sub_u32 s70, s67, s64
s_max_i32 s70, s70, 0
v_readlane_b32 s67, v8, s66
s_lshl_b64 exec, -1, s70
v_mov_b32 v102, s68
s_cmp_lt_u32 s67, s69
s_cbranch_scc1 gwk2_48
s_mov_b64 exec, -1
gwek2_49:
v_add3_u32 v102, v102, s64, v3
s_add_u32 s64, s64, 64
v_mul_u32_u24 v102, 24, v102
buffer_load_dwordx4 v[28:31], v102, s[8:11], 0 offen
buffer_load_dwordx2 v[38:39], v102, s[8:11], 0 offen offset:16
v_and_b32 v96, 0x3ffff, v40
ds_read_b32 v96, v96 offset:2048
v_and_b32 v97, 0x3ffff, v41
ds_read_b32 v97, v97 offset:2048
v_and_b32 v98, 0x3ffff, v42
ds_read_b32 v98, v98 offset:2048
v_and_b32 v99, 0x3ffff, v43
ds_read_b32 v99, v99 offset:2048
v_and_b32 v100, 0x3ffff, v44
ds_read_b32 v100, v100 offset:2048
v_and_b32 v101, 0x3ffff, v45
ds_read_b32 v101, v101 offset:2048
v_and_b32 v102, 0x3ffff, v46
ds_read_b32 v102, v102 offset:2048
v_and_b32 v103, 0x3ffff, v47
ds_read_b32 v103, v103 offset:2048
s_waitcnt lgkmcnt(0)
v_lshrrev_b32 v104, 18, v40
v_lshl_add_u32 v96, v104, 3, v96
v_and_or_b32 v96, v40, s73, v96
ds_write_b64 v96, v[64:65] offset:28160
v_lshrrev_b32 v104, 18, v41
v_lshl_add_u32 v97, v104, 3, v97
v_and_or_b32 v97, v41, s73, v97
ds_write_b64 v97, v[66:67] offset:28160
v_lshrrev_b32 v104, 18, v42
v_lshl_add_u32 v98, v104, 3, v98
v_and_or_b32 v98, v42, s73, v98
ds_write_b64 v98, v[68:69] offset:28160
v_lshrrev_b32 v104, 18, v43
v_lshl_add_u32 v99, v104, 3, v99
v_and_or_b32 v99, v43, s73, v99
ds_write_b64 v99, v[70:71] offset:28160
v_lshrrev_b32 v104, 18, v44
v_lshl_add_u32 v100, v104, 3, v100
v_and_or_b32 v100, v44, s73, v100
ds_write_b64 v100, v[72:73] offset:28160
v_lshrrev_b32 v104, 18, v45
v_lshl_add_u32 v101, v104, 3, v101
v_and_or_b32 v101, v45, s73, v101
ds_write_b64 v101, v[74:75] offset:28160
v_lshrrev_b32 v104, 18, v46
v_lshl_add_u32 v102, v104, 3, v102
v_and_or_b32 v102, v46, s73, v102
ds_write_b64 v102, v[76:77] offset:28160
v_lshrrev_b32 v104, 18, v47
v_lshl_add_u32 v103, v104, 3, v103
v_and_or_b32 v103, v47, s73, v103
ds_write_b64 v103, v[78:79] offset:28160
v_and_b32 v96, 0x3ffff, v48
ds_read_b32 v96, v96 offset:2048
v_and_b32 v97, 0x3ffff, v49
ds_read_b32 v97, v97 offset:2048
v_and_b32 v98, 0x3ffff, v50
ds_read_b32 v98, v98 offset:2048
v_and_b32 v99, 0x3ffff, v51
ds_read_b32 v99, v99 offset:2048
v_and_b32 v100, 0x3ffff, v52
ds_read_b32 v100, v100 offset:2048
v_and_b32 v101, 0x3ffff, v53
ds_read_b32 v101, v101 offset:2048
v_and_b32 v102, 0x3ffff, v54
ds_read_b32 v102, v102 offset:2048
v_and_b32 v103, 0x3ffff, v55
ds_read_b32 v103, v103 offset:2048
s_waitcnt lgkmcnt(0)
v_lshrrev_b32 v104, 18, v48
v_lshl_add_u32 v96, v104, 3, v96
v_and_or_b32 v96, v48, s73, v96
ds_write_b64 v96, v[80:81] offset:28160
v_lshrrev_b32 v104, 18, v49
v_lshl_add_u32 v97, v104, 3, v97
v_and_or_b32 v97, v49, s73, v97
ds_write_b64 v97, v[82:83] offset:28160
v_lshrrev_b32 v104, 18, v50
v_lshl_add_u32 v98, v104, 3, v98
v_and_or_b32 v98, v50, s73, v98
ds_write_b64 v98, v[84:85] offset:28160
v_lshrrev_b32 v104, 18, v51
v_lshl_add_u32 v99, v104, 3, v99
v_and_or_b32 v99, v51, s73, v99
ds_write_b64 v99, v[86:87] offset:28160
v_lshrrev_b32 v104, 18, v52
v_lshl_add_u32 v100, v104, 3, v100
v_and_or_b32 v100, v52, s73, v100
ds_write_b64 v100, v[88:89] offset:28160
v_lshrrev_b32 v104, 18, v53
v_lshl_add_u32 v101, v104, 3, v101
v_and_or_b32 v101, v53, s73, v101
ds_write_b64 v101, v[90:91] offset:28160
v_lshrrev_b32 v104, 18, v54
v_lshl_add_u32 v102, v104, 3, v102
v_and_or_b32 v102, v54, s73, v102
ds_write_b64 v102, v[92:93] offset:28160
v_lshrrev_b32 v104, 18, v55
v_lshl_add_u32 v103, v104, 3, v103
v_and_or_b32 v103, v55, s73, v103
ds_write_b64 v103, v[94:95] offset:28160
s_waitcnt lgkmcnt(0)
s_barrier
v_add_u32 v96, 0, v1
ds_read_b128 v[64:67], v96 offset:28160
v_add_u32 v97, 16384, v1
ds_read_b128 v[68:71], v97 offset:28160
v_add_u32 v98, 32768, v1
ds_read_b128 v[72:75], v98 offset:28160
v_add_u32 v99, 49152, v1
ds_read_b128 v[76:79], v99 offset:28160
v_add_u32 v100, 65536, v1
ds_read_b128 v[80:83], v100 offset:28160
v_add_u32 v101, 81920, v1
ds_read_b128 v[84:87], v101 offset:28160
v_add_u32 v102, 98304, v1
ds_read_b128 v[88:91], v102 offset:28160
v_add_u32 v103, 114688, v1
ds_read_b128 v[92:95], v103 offset:28160
v_add_u32 v104, 131072, v1
ds_read_b128 v[112:115], v104 offset:28160
s_waitcnt lgkmcnt(8)
buffer_store_dwordx4 v[64:67], v96, s[28:31], 0 offen nt
s_waitcnt lgkmcnt(7)
buffer_store_dwordx4 v[68:71], v97, s[28:31], 0 offen nt
s_waitcnt lgkmcnt(6)
buffer_store_dwordx4 v[72:75], v98, s[28:31], 0 offen nt
s_waitcnt lgkmcnt(5)
buffer_store_dwordx4 v[76:79], v99, s[28:31], 0 offen nt
s_waitcnt lgkmcnt(4)
buffer_store_dwordx4 v[80:83], v100, s[28:31], 0 offen nt
s_waitcnt lgkmcnt(3)
buffer_store_dwordx4 v[84:87], v101, s[28:31], 0 offen nt
s_waitcnt lgkmcnt(2)
buffer_store_dwordx4 v[88:91], v102, s[28:31], 0 offen nt
s_waitcnt lgkmcnt(1)
buffer_store_dwordx4 v[92:95], v103, s[28:31], 0 offen nt
s_waitcnt lgkmcnt(0)
buffer_store_dwordx4 v[112:115], v104, s[28:31], 0 offen nt
s_waitcnt vmcnt(9)
s_nop 0
v_lshlrev_b32 v112, 3, v16
v_and_b32 v112, 0x7ff8, v112
ds_read_b64 v[64:65], v112 offset:3072
v_lshlrev_b32 v112, 3, v17
v_and_b32 v112, 0x7ff8, v112
ds_read_b64 v[66:67], v112 offset:3072
v_lshlrev_b32 v112, 3, v18
v_and_b32 v112, 0x7ff8, v112
ds_read_b64 v[68:69], v112 offset:3072
v_lshlrev_b32 v112, 3, v19
v_and_b32 v112, 0x7ff8, v112
ds_read_b64 v[70:71], v112 offset:3072
v_cmp_ne_u16 vcc, 0, v32
v_lshrrev_b32 v96, 14, v16
v_and_b32 v96, 0x3fc, v96
v_cndmask_b32 v96, v12, v96, vcc
ds_add_rtn_u32 v100, v96, v14 offset:0
v_cmp_lt_u32 vcc, 0xffff, v32
v_lshrrev_b32 v97, 14, v17
v_and_b32 v97, 0x3fc, v97
v_cndmask_b32 v97, v12, v97, vcc
ds_add_rtn_u32 v101, v97, v14 offset:0
v_cmp_ne_u16 vcc, 0, v33
v_lshrrev_b32 v98, 14, v18
v_and_b32 v98, 0x3fc, v98
v_cndmask_b32 v98, v12, v98, vcc
ds_add_rtn_u32 v102, v98, v14 offset:0
v_cmp_lt_u32 vcc, 0xffff, v33
v_lshrrev_b32 v99, 14, v19
v_and_b32 v99, 0x3fc, v99
v_cndmask_b32 v99, v12, v99, vcc
ds_add_rtn_u32 v103, v99, v14 offset:0
v_lshlrev_b32 v112, 3, v20
v_and_b32 v112, 0x7ff8, v112
ds_read_b64 v[72:73], v112 offset:3072
v_lshlrev_b32 v112, 3, v21
v_and_b32 v112, 0x7ff8, v112
ds_read_b64 v[74:75], v112 offset:3072
v_lshlrev_b32 v112, 3, v22
v_and_b32 v112, 0x7ff8, v112
ds_read_b64 v[76:77], v112 offset:3072
v_lshlrev_b32 v112, 3, v23
v_and_b32 v112, 0x7ff8, v112
ds_read_b64 v[78:79], v112 offset:3072
v_cmp_ne_u16 vcc, 0, v34
v_lshrrev_b32 v104, 14, v20
v_and_b32 v104, 0x3fc, v104
v_cndmask_b32 v104, v12, v104, vcc
ds_add_rtn_u32 v108, v104, v14 offset:0
v_cmp_lt_u32 vcc, 0xffff, v34
v_lshrrev_b32 v105, 14, v21
v_and_b32 v105, 0x3fc, v105
v_cndmask_b32 v105, v12, v105, vcc
ds_add_rtn_u32 v109, v105, v14 offset:0
v_cmp_ne_u16 vcc, 0, v35
v_lshrrev_b32 v106, 14, v22
v_and_b32 v106, 0x3fc, v106
v_cndmask_b32 v106, v12, v106, vcc
ds_add_rtn_u32 v110, v106, v14 offset:0
v_cmp_lt_u32 vcc, 0xffff, v35
v_lshrrev_b32 v107, 14, v23
v_and_b32 v107, 0x3fc, v107
v_cndmask_b32 v107, v12, v107, vcc
ds_add_rtn_u32 v111, v107, v14 offset:0
s_waitcnt lgkmcnt(12)
v_pk_mul_f16 v64, v64, v32 op_sel:[0,0] op_sel_hi:[1,0]
v_pk_mul_f16 v65, v65, v32 op_sel:[0,0] op_sel_hi:[1,0]
v_lshrrev_b32 v113, 20, v16
v_lshrrev_b32 v114, 12, v16
v_bfi_b32 v113, 15, v114, v113
v_add_u32 v64, 0x00040004, v64
v_add_u32 v65, 0x00040004, v65
v_lshl_or_b32 v114, v113, 13, v113
v_lshrrev_b32 v115, 6, v113
v_bfi_b32 v64, s72, v114, v64
v_lshl_or_b32 v115, v115, 13, v115
v_bfi_b32 v65, s72, v115, v65
v_pk_mul_f16 v66, v66, v32 op_sel:[0,1] op_sel_hi:[1,1]
v_pk_mul_f16 v67, v67, v32 op_sel:[0,1] op_sel_hi:[1,1]
v_lshrrev_b32 v113, 20, v17
v_lshrrev_b32 v114, 12, v17
v_bfi_b32 v113, 15, v114, v113
v_add_u32 v66, 0x00040004, v66
v_add_u32 v67, 0x00040004, v67
v_lshl_or_b32 v114, v113, 13, v113
v_lshrrev_b32 v115, 6, v113
v_bfi_b32 v66, s72, v114, v66
v_lshl_or_b32 v115, v115, 13, v115
v_bfi_b32 v67, s72, v115, v67
v_pk_mul_f16 v68, v68, v33 op_sel:[0,0] op_sel_hi:[1,0]
v_pk_mul_f16 v69, v69, v33 op_sel:[0,0] op_sel_hi:[1,0]
v_lshrrev_b32 v113, 20, v18
v_lshrrev_b32 v114, 12, v18
v_bfi_b32 v113, 15, v114, v113
v_add_u32 v68, 0x00040004, v68
v_add_u32 v69, 0x00040004, v69
v_lshl_or_b32 v114, v113, 13, v113
v_lshrrev_b32 v115, 6, v113
v_bfi_b32 v68, s72, v114, v68
v_lshl_or_b32 v115, v115, 13, v115
v_bfi_b32 v69, s72, v115, v69
v_pk_mul_f16 v70, v70, v33 op_sel:[0,1] op_sel_hi:[1,1]
v_pk_mul_f16 v71, v71, v33 op_sel:[0,1] op_sel_hi:[1,1]
v_lshrrev_b32 v113, 20, v19
v_lshrrev_b32 v114, 12, v19
v_bfi_b32 v113, 15, v114, v113
v_add_u32 v70, 0x00040004, v70
v_add_u32 v71, 0x00040004, v71
v_lshl_or_b32 v114, v113, 13, v113
v_lshrrev_b32 v115, 6, v113
v_bfi_b32 v70, s72, v114, v70
v_lshl_or_b32 v115, v115, 13, v115
v_bfi_b32 v71, s72, v115, v71
s_waitcnt lgkmcnt(8)
v_lshl_or_b32 v16, v100, 18, v96
v_lshl_or_b32 v17, v101, 18, v97
v_lshl_or_b32 v18, v102, 18, v98
v_lshl_or_b32 v19, v103, 18, v99
v_lshlrev_b32 v112, 3, v24
v_and_b32 v112, 0x7ff8, v112
ds_read_b64 v[80:81], v112 offset:3072
v_lshlrev_b32 v112, 3, v25
v_and_b32 v112, 0x7ff8, v112
ds_read_b64 v[82:83], v112 offset:3072
v_lshlrev_b32 v112, 3, v26
v_and_b32 v112, 0x7ff8, v112
ds_read_b64 v[84:85], v112 offset:3072
v_lshlrev_b32 v112, 3, v27
v_and_b32 v112, 0x7ff8, v112
ds_read_b64 v[86:87], v112 offset:3072
v_cmp_ne_u16 vcc, 0, v36
v_lshrrev_b32 v96, 14, v24
v_and_b32 v96, 0x3fc, v96
v_cndmask_b32 v96, v12, v96, vcc
ds_add_rtn_u32 v100, v96, v14 offset:0
v_cmp_lt_u32 vcc, 0xffff, v36
v_lshrrev_b32 v97, 14, v25
v_and_b32 v97, 0x3fc, v97
v_cndmask_b32 v97, v12, v97, vcc
ds_add_rtn_u32 v101, v97, v14 offset:0
v_cmp_ne_u16 vcc, 0, v37
v_lshrrev_b32 v98, 14, v26
v_and_b32 v98, 0x3fc, v98
v_cndmask_b32 v98, v12, v98, vcc
ds_add_rtn_u32 v102, v98, v14 offset:0
v_cmp_lt_u32 vcc, 0xffff, v37
v_lshrrev_b32 v99, 14, v27
v_and_b32 v99, 0x3fc, v99
v_cndmask_b32 v99, v12, v99, vcc
ds_add_rtn_u32 v103, v99, v14 offset:0
s_waitcnt lgkmcnt(12)
v_pk_mul_f16 v72, v72, v34 op_sel:[0,0] op_sel_hi:[1,0]
v_pk_mul_f16 v73, v73, v34 op_sel:[0,0] op_sel_hi:[1,0]
v_lshrrev_b32 v113, 20, v20
v_lshrrev_b32 v114, 12, v20
v_bfi_b32 v113, 15, v114, v113
v_add_u32 v72, 0x00040004, v72
v_add_u32 v73, 0x00040004, v73
v_lshl_or_b32 v114, v113, 13, v113
v_lshrrev_b32 v115, 6, v113
v_bfi_b32 v72, s72, v114, v72
v_lshl_or_b32 v115, v115, 13, v115
v_bfi_b32 v73, s72, v115, v73
v_pk_mul_f16 v74, v74, v34 op_sel:[0,1] op_sel_hi:[1,1]
v_pk_mul_f16 v75, v75, v34 op_sel:[0,1] op_sel_hi:[1,1]
v_lshrrev_b32 v113, 20, v21
v_lshrrev_b32 v114, 12, v21
v_bfi_b32 v113, 15, v114, v113
v_add_u32 v74, 0x00040004, v74
v_add_u32 v75, 0x00040004, v75
v_lshl_or_b32 v114, v113, 13, v113
v_lshrrev_b32 v115, 6, v113
v_bfi_b32 v74, s72, v114, v74
v_lshl_or_b32 v115, v115, 13, v115
v_bfi_b32 v75, s72, v115, v75
v_pk_mul_f16 v76, v76, v35 op_sel:[0,0] op_sel_hi:[1,0]
v_pk_mul_f16 v77, v77, v35 op_sel:[0,0] op_sel_hi:[1,0]
v_lshrrev_b32 v113, 20, v22
v_lshrrev_b32 v114, 12, v22
v_bfi_b32 v113, 15, v114, v113
v_add_u32 v76, 0x00040004, v76
v_add_u32 v77, 0x00040004, v77
v_lshl_or_b32 v114, v113, 13, v113
v_lshrrev_b32 v115, 6, v113
v_bfi_b32 v76, s72, v114, v76
v_lshl_or_b32 v115, v115, 13, v115
v_bfi_b32 v77, s72, v115, v77
v_pk_mul_f16 v78, v78, v35 op_sel:[0,1] op_sel_hi:[1,1]
v_pk_mul_f16 v79, v79, v35 op_sel:[0,1] op_sel_hi:[1,1]
v_lshrrev_b32 v113, 20, v23
v_lshrrev_b32 v114, 12, v23
v_bfi_b32 v113, 15, v114, v113
v_add_u32 v78, 0x00040004, v78
v_add_u32 v79, 0x00040004, v79
v_lshl_or_b32 v114, v113, 13, v113
v_lshrrev_b32 v115, 6, v113
v_bfi_b32 v78, s72, v114, v78
v_lshl_or_b32 v115, v115, 13, v115
v_bfi_b32 v79, s72, v115, v79
s_waitcnt lgkmcnt(8)
v_lshl_or_b32 v20, v108, 18, v104
v_lshl_or_b32 v21, v109, 18, v105
v_lshl_or_b32 v22, v110, 18, v106
v_lshl_or_b32 v23, v111, 18, v107
v_lshlrev_b32 v112, 3, v28
v_and_b32 v112, 0x7ff8, v112
ds_read_b64 v[88:89], v112 offset:3072
v_lshlrev_b32 v112, 3, v29
v_and_b32 v112, 0x7ff8, v112
ds_read_b64 v[90:91], v112 offset:3072
v_lshlrev_b32 v112, 3, v30
v_and_b32 v112, 0x7ff8, v112
ds_read_b64 v[92:93], v112 offset:3072
v_lshlrev_b32 v112, 3, v31
v_and_b32 v112, 0x7ff8, v112
ds_read_b64 v[94:95], v112 offset:3072
v_cmp_ne_u16 vcc, 0, v38
v_lshrrev_b32 v104, 14, v28
v_and_b32 v104, 0x3fc, v104
v_cndmask_b32 v104, v12, v104, vcc
ds_add_rtn_u32 v108, v104, v14 offset:0
v_cmp_lt_u32 vcc, 0xffff, v38
v_lshrrev_b32 v105, 14, v29
v_and_b32 v105, 0x3fc, v105
v_cndmask_b32 v105, v12, v105, vcc
ds_add_rtn_u32 v109, v105, v14 offset:0
v_cmp_ne_u16 vcc, 0, v39
v_lshrrev_b32 v106, 14, v30
v_and_b32 v106, 0x3fc, v106
v_cndmask_b32 v106, v12, v106, vcc
ds_add_rtn_u32 v110, v106, v14 offset:0
v_cmp_lt_u32 vcc, 0xffff, v39
v_lshrrev_b32 v107, 14, v31
v_and_b32 v107, 0x3fc, v107
v_cndmask_b32 v107, v12, v107, vcc
ds_add_rtn_u32 v111, v107, v14 offset:0
s_waitcnt lgkmcnt(12)
v_pk_mul_f16 v80, v80, v36 op_sel:[0,0] op_sel_hi:[1,0]
v_pk_mul_f16 v81, v81, v36 op_sel:[0,0] op_sel_hi:[1,0]
v_lshrrev_b32 v113, 20, v24
v_lshrrev_b32 v114, 12, v24
v_bfi_b32 v113, 15, v114, v113
v_add_u32 v80, 0x00040004, v80
v_add_u32 v81, 0x00040004, v81
v_lshl_or_b32 v114, v113, 13, v113
v_lshrrev_b32 v115, 6, v113
v_bfi_b32 v80, s72, v114, v80
v_lshl_or_b32 v115, v115, 13, v115
v_bfi_b32 v81, s72, v115, v81
v_pk_mul_f16 v82, v82, v36 op_sel:[0,1] op_sel_hi:[1,1]
v_pk_mul_f16 v83, v83, v36 op_sel:[0,1] op_sel_hi:[1,1]
v_lshrrev_b32 v113, 20, v25
v_lshrrev_b32 v114, 12, v25
v_bfi_b32 v113, 15, v114, v113
v_add_u32 v82, 0x00040004, v82
v_add_u32 v83, 0x00040004, v83
v_lshl_or_b32 v114, v113, 13, v113
v_lshrrev_b32 v115, 6, v113
v_bfi_b32 v82, s72, v114, v82
v_lshl_or_b32 v115, v115, 13, v115
v_bfi_b32 v83, s72, v115, v83
v_pk_mul_f16 v84, v84, v37 op_sel:[0,0] op_sel_hi:[1,0]
v_pk_mul_f16 v85, v85, v37 op_sel:[0,0] op_sel_hi:[1,0]
v_lshrrev_b32 v113, 20, v26
v_lshrrev_b32 v114, 12, v26
v_bfi_b32 v113, 15, v114, v113
v_add_u32 v84, 0x00040004, v84
v_add_u32 v85, 0x00040004, v85
v_lshl_or_b32 v114, v113, 13, v113
v_lshrrev_b32 v115, 6, v113
v_bfi_b32 v84, s72, v114, v84
v_lshl_or_b32 v115, v115, 13, v115
v_bfi_b32 v85, s72, v115, v85
v_pk_mul_f16 v86, v86, v37 op_sel:[0,1] op_sel_hi:[1,1]
v_pk_mul_f16 v87, v87, v37 op_sel:[0,1] op_sel_hi:[1,1]
v_lshrrev_b32 v113, 20, v27
v_lshrrev_b32 v114, 12, v27
v_bfi_b32 v113, 15, v114, v113
v_add_u32 v86, 0x00040004, v86
v_add_u32 v87, 0x00040004, v87
v_lshl_or_b32 v114, v113, 13, v113
v_lshrrev_b32 v115, 6, v113
v_bfi_b32 v86, s72, v114, v86
v_lshl_or_b32 v115, v115, 13, v115
v_bfi_b32 v87, s72, v115, v87
s_waitcnt lgkmcnt(8)
v_lshl_or_b32 v24, v100, 18, v96
v_lshl_or_b32 v25, v101, 18, v97
v_lshl_or_b32 v26, v102, 18, v98
v_lshl_or_b32 v27, v103, 18, v99
s_waitcnt lgkmcnt(4)
v_pk_mul_f16 v88, v88, v38 op_sel:[0,0] op_sel_hi:[1,0]
v_pk_mul_f16 v89, v89, v38 op_sel:[0,0] op_sel_hi:[1,0]
v_lshrrev_b32 v113, 20, v28
v_lshrrev_b32 v114, 12, v28
v_bfi_b32 v113, 15, v114, v113
v_add_u32 v88, 0x00040004, v88
v_add_u32 v89, 0x00040004, v89
v_lshl_or_b32 v114, v113, 13, v113
v_lshrrev_b32 v115, 6, v113
v_bfi_b32 v88, s72, v114, v88
v_lshl_or_b32 v115, v115, 13, v115
v_bfi_b32 v89, s72, v115, v89
v_pk_mul_f16 v90, v90, v38 op_sel:[0,1] op_sel_hi:[1,1]
v_pk_mul_f16 v91, v91, v38 op_sel:[0,1] op_sel_hi:[1,1]
v_lshrrev_b32 v113, 20, v29
v_lshrrev_b32 v114, 12, v29
v_bfi_b32 v113, 15, v114, v113
v_add_u32 v90, 0x00040004, v90
v_add_u32 v91, 0x00040004, v91
v_lshl_or_b32 v114, v113, 13, v113
v_lshrrev_b32 v115, 6, v113
v_bfi_b32 v90, s72, v114, v90
v_lshl_or_b32 v115, v115, 13, v115
v_bfi_b32 v91, s72, v115, v91
v_pk_mul_f16 v92, v92, v39 op_sel:[0,0] op_sel_hi:[1,0]
v_pk_mul_f16 v93, v93, v39 op_sel:[0,0] op_sel_hi:[1,0]
v_lshrrev_b32 v113, 20, v30
v_lshrrev_b32 v114, 12, v30
v_bfi_b32 v113, 15, v114, v113
v_add_u32 v92, 0x00040004, v92
v_add_u32 v93, 0x00040004, v93
v_lshl_or_b32 v114, v113, 13, v113
v_lshrrev_b32 v115, 6, v113
v_bfi_b32 v92, s72, v114, v92
v_lshl_or_b32 v115, v115, 13, v115
v_bfi_b32 v93, s72, v115, v93
v_pk_mul_f16 v94, v94, v39 op_sel:[0,1] op_sel_hi:[1,1]
v_pk_mul_f16 v95, v95, v39 op_sel:[0,1] op_sel_hi:[1,1]
v_lshrrev_b32 v113, 20, v31
v_lshrrev_b32 v114, 12, v31
v_bfi_b32 v113, 15, v114, v113
v_add_u32 v94, 0x00040004, v94
v_add_u32 v95, 0x00040004, v95
v_lshl_or_b32 v114, v113, 13, v113
v_lshrrev_b32 v115, 6, v113
v_bfi_b32 v94, s72, v114, v94
v_lshl_or_b32 v115, v115, 13, v115
v_bfi_b32 v95, s72, v115, v95
s_waitcnt lgkmcnt(0)
v_lshl_or_b32 v28, v108, 18, v104
v_lshl_or_b32 v29, v109, 18, v105
v_lshl_or_b32 v30, v110, 18, v106
v_lshl_or_b32 v31, v111, 18, v107
s_barrier
ds_read_b128 v[96:99], v2 offset:0
s_waitcnt lgkmcnt(0)
v_add_u32 v100, 1, v96
v_lshrrev_b32 v100, 1, v100
v_add_u32 v101, 1, v97
v_lshrrev_b32 v101, 1, v101
v_add_u32 v102, 1, v98
v_lshrrev_b32 v102, 1, v102
v_add_u32 v103, 1, v99
v_lshrrev_b32 v103, 1, v103
v_add_u32 v106, v100, v101
v_add_u32 v107, v106, v102
v_add_u32 v108, v107, v103
v_mov_b32 v109, v108
s_nop 1
v_add_u32_dpp v109, v109, v109 row_shr:1 row_mask:0xf bank_mask:0xf bound_ctrl:0
s_nop 1
v_add_u32_dpp v109, v109, v109 row_shr:2 row_mask:0xf bank_mask:0xf bound_ctrl:0
s_nop 1
v_add_u32_dpp v109, v109, v109 row_shr:4 row_mask:0xf bank_mask:0xf bound_ctrl:0
s_nop 1
v_add_u32_dpp v109, v109, v109 row_shr:8 row_mask:0xf bank_mask:0xf bound_ctrl:0
s_nop 1
v_add_u32_dpp v109, v109, v109 row_bcast:15 row_mask:0xa bank_mask:0xf
s_nop 1
v_add_u32_dpp v109, v109, v109 row_bcast:31 row_mask:0xc bank_mask:0xf
v_sub_u32 v104, v109, v108
v_add_u32 v105, v104, v100
v_add_u32 v106, v104, v106
v_add_u32 v107, v104, v107
v_readlane_b32 s61, v109, 63
v_lshl_or_b32 v100, v100, 16, v104
v_lshl_or_b32 v101, v101, 16, v105
v_lshl_or_b32 v102, v102, 16, v106
v_lshl_or_b32 v103, v103, 16, v107
v_lshlrev_b32 v104, 4, v104
v_lshlrev_b32 v105, 4, v105
v_lshlrev_b32 v106, 4, v106
v_lshlrev_b32 v107, 4, v107
ds_write_b128 v2, v[104:107] offset:2048
ds_write_b128 v2, v[4:7] offset:1024
s_cmp_lg_u32 s43, 0
s_cbranch_scc1 k2w0_50
s_mul_i32 s50, s42, 7
s_add_u32 s50, s50, 2
s_lshl_b32 s50, s50, 10
buffer_store_dwordx4 v[100:103], v2, s[32:35], s50 offen
v_and_b32 v111, 1, v96
v_cmp_eq_u32 vcc, 1, v111
v_lshl_add_u32 v110, v96, 3, v104
s_nop 0
v_cndmask_b32 v110, v12, v110, vcc
ds_write_b64 v110, v[4:5] offset:28160
v_and_b32 v111, 1, v97
v_cmp_eq_u32 vcc, 1, v111
v_lshl_add_u32 v110, v97, 3, v105
s_nop 0
v_cndmask_b32 v110, v12, v110, vcc
ds_write_b64 v110, v[4:5] offset:28160
v_and_b32 v111, 1, v98
v_cmp_eq_u32 vcc, 1, v111
v_lshl_add_u32 v110, v98, 3, v106
s_nop 0
v_cndmask_b32 v110, v12, v110, vcc
ds_write_b64 v110, v[4:5] offset:28160
v_and_b32 v111, 1, v99
v_cmp_eq_u32 vcc, 1, v111
v_lshl_add_u32 v110, v99, 3, v107
s_nop 0
v_cndmask_b32 v110, v12, v110, vcc
ds_write_b64 v110, v[4:5] offset:28160
k2w0_50:
s_mul_i32 s50, s42, 7
s_add_u32 s50, s50, 2
s_mul_i32 s51, s50, 133120
s_add_u32 s28, s52, s51
s_addc_u32 s29, s53, 0
s_and_b32 s29, s29, 0xffff
s_lshl_b32 s30, s61, 4
s_add_u32 s30, s30, 127
s_and_b32 s30, s30, 0xffffff80
s_waitcnt lgkmcnt(0)
s_cmp_lt_u32 s64, s46
s_cbranch_scc1 k2ns_51
s_cmp_lg_u32 s65, 0
s_cbranch_scc1 k2ns_51
v_mov_b32 v8, v10
v_mov_b32 v9, v11
s_mov_b32 s46, s47
s_mov_b32 s64, 0
s_mov_b32 s65, 1
s_mov_b32 s66, 0
v_readlane_b32 s67, v8, 0
k2ns_51:
v_mov_b32 v96, s68
s_add_u32 s69, s64, 64
s_cmp_lt_u32 s67, s69
s_cbranch_scc0 gwek2_53
gwk2_52:
v_readlane_b32 s68, v9, s66
s_add_u32 s66, s66, 1
s_sub_u32 s70, s67, s64
s_max_i32 s70, s70, 0
v_readlane_b32 s67, v8, s66
s_lshl_b64 exec, -1, s70
v_mov_b32 v96, s68
s_cmp_lt_u32 s67, s69
s_cbranch_scc1 gwk2_52
s_mov_b64 exec, -1
gwek2_53:
v_add3_u32 v96, v96, s64, v3
s_add_u32 s64, s64, 64
v_mul_u32_u24 v96, 24, v96
buffer_load_dwordx4 v[40:43], v96, s[8:11], 0 offen
buffer_load_dwordx2 v[56:57], v96, s[8:11], 0 offen offset:16
s_cmp_lt_u32 s64, s46
s_cbranch_scc1 k2ns_54
s_cmp_lg_u32 s65, 0
s_cbranch_scc1 k2ns_54
v_mov_b32 v8, v10
v_mov_b32 v9, v11
s_mov_b32 s46, s47
s_mov_b32 s64, 0
s_mov_b32 s65, 1
s_mov_b32 s66, 0
v_readlane_b32 s67, v8, 0
k2ns_54:
v_mov_b32 v98, s68
s_add_u32 s69, s64, 64
s_cmp_lt_u32 s67, s69
s_cbranch_scc0 gwek2_56
gwk2_55:
v_readlane_b32 s68, v9, s66
s_add_u32 s66, s66, 1
s_sub_u32 s70, s67, s64
s_max_i32 s70, s70, 0
v_readlane_b32 s67, v8, s66
s_lshl_b64 exec, -1, s70
v_mov_b32 v98, s68
s_cmp_lt_u32 s67, s69
s_cbranch_scc1 gwk2_55
s_mov_b64 exec, -1
gwek2_56:
v_add3_u32 v98, v98, s64, v3
s_add_u32 s64, s64, 64
v_mul_u32_u24 v98, 24, v98
buffer_load_dwordx4 v[44:47], v98, s[8:11], 0 offen
buffer_load_dwordx2 v[58:59], v98, s[8:11], 0 offen offset:16
s_cmp_lt_u32 s64, s46
s_cbranch_scc1 k2ns_57
s_cmp_lg_u32 s65, 0
s_cbranch_scc1 k2ns_57
v_mov_b32 v8, v10
v_mov_b32 v9, v11
s_mov_b32 s46, s47
s_mov_b32 s64, 0
s_mov_b32 s65, 1
s_mov_b32 s66, 0
v_readlane_b32 s67, v8, 0
k2ns_57:
v_mov_b32 v100, s68
s_add_u32 s69, s64, 64
s_cmp_lt_u32 s67, s69
s_cbranch_scc0 gwek2_59
gwk2_58:
v_readlane_b32 s68, v9, s66
s_add_u32 s66, s66, 1
s_sub_u32 s70, s67, s64
s_max_i32 s70, s70, 0
v_readlane_b32 s67, v8, s66
s_lshl_b64 exec, -1, s70
v_mov_b32 v100, s68
s_cmp_lt_u32 s67, s69
s_cbranch_scc1 gwk2_58
s_mov_b64 exec, -1
gwek2_59:
v_add3_u32 v100, v100, s64, v3
s_add_u32 s64, s64, 64
v_mul_u32_u24 v100, 24, v100
buffer_load_dwordx4 v[48:51], v100, s[8:11], 0 offen
buffer_load_dwordx2 v[60:61], v100, s[8:11], 0 offen offset:16
s_cmp_lt_u32 s64, s46
s_cbranch_scc1 k2ns_60
s_cmp_lg_u32 s65, 0
s_cbranch_scc1 k2ns_60
v_mov_b32 v8, v10
v_mov_b32 v9, v11
s_mov_b32 s46, s47
s_mov_b32 s64, 0
s_mov_b32 s65, 1
s_mov_b32 s66, 0
v_readlane_b32 s67, v8, 0
k2ns_60:
v_mov_b32 v102, s68
s_add_u32 s69, s64, 64
s_cmp_lt_u32 s67, s69
s_cbranch_scc0 gwek2_62
gwk2_61:
v_readlane_b32 s68, v9, s66
s_add_u32 s66, s66, 1
s_sub_u32 s70, s67, s64
s_max_i32 s70, s70, 0
v_readlane_b32 s67, v8, s66
s_lshl_b64 exec, -1, s70
v_mov_b32 v102, s68
s_cmp_lt_u32 s67, s69
s_cbranch_scc1 gwk2_61
s_mov_b64 exec, -1
gwek2_62:
v_add3_u32 v102, v102, s64, v3
s_add_u32 s64, s64, 64
v_mul_u32_u24 v102, 24, v102
buffer_load_dwordx4 v[52:55], v102, s[8:11], 0 offen
buffer_load_dwordx2 v[62:63], v102, s[8:11], 0 offen offset:16
v_and_b32 v96, 0x3ffff, v16
ds_read_b32 v96, v96 offset:2048
v_and_b32 v97, 0x3ffff, v17
ds_read_b32 v97, v97 offset:2048
v_and_b32 v98, 0x3ffff, v18
ds_read_b32 v98, v98 offset:2048
v_and_b32 v99, 0x3ffff, v19
ds_read_b32 v99, v99 offset:2048
v_and_b32 v100, 0x3ffff, v20
ds_read_b32 v100, v100 offset:2048
v_and_b32 v101, 0x3ffff, v21
ds_read_b32 v101, v101 offset:2048
v_and_b32 v102, 0x3ffff, v22
ds_read_b32 v102, v102 offset:2048
v_and_b32 v103, 0x3ffff, v23
ds_read_b32 v103, v103 offset:2048
s_waitcnt lgkmcnt(0)
v_lshrrev_b32 v104, 18, v16
v_lshl_add_u32 v96, v104, 3, v96
v_and_or_b32 v96, v16, s73, v96
ds_write_b64 v96, v[64:65] offset:28160
v_lshrrev_b32 v104, 18, v17
v_lshl_add_u32 v97, v104, 3, v97
v_and_or_b32 v97, v17, s73, v97
ds_write_b64 v97, v[66:67] offset:28160
v_lshrrev_b32 v104, 18, v18
v_lshl_add_u32 v98, v104, 3, v98
v_and_or_b32 v98, v18, s73, v98
ds_write_b64 v98, v[68:69] offset:28160
v_lshrrev_b32 v104, 18, v19
v_lshl_add_u32 v99, v104, 3, v99
v_and_or_b32 v99, v19, s73, v99
ds_write_b64 v99, v[70:71] offset:28160
v_lshrrev_b32 v104, 18, v20
v_lshl_add_u32 v100, v104, 3, v100
v_and_or_b32 v100, v20, s73, v100
ds_write_b64 v100, v[72:73] offset:28160
v_lshrrev_b32 v104, 18, v21
v_lshl_add_u32 v101, v104, 3, v101
v_and_or_b32 v101, v21, s73, v101
ds_write_b64 v101, v[74:75] offset:28160
v_lshrrev_b32 v104, 18, v22
v_lshl_add_u32 v102, v104, 3, v102
v_and_or_b32 v102, v22, s73, v102
ds_write_b64 v102, v[76:77] offset:28160
v_lshrrev_b32 v104, 18, v23
v_lshl_add_u32 v103, v104, 3, v103
v_and_or_b32 v103, v23, s73, v103
ds_write_b64 v103, v[78:79] offset:28160
v_and_b32 v96, 0x3ffff, v24
ds_read_b32 v96, v96 offset:2048
v_and_b32 v97, 0x3ffff, v25
ds_read_b32 v97, v97 offset:2048
v_and_b32 v98, 0x3ffff, v26
ds_read_b32 v98, v98 offset:2048
v_and_b32 v99, 0x3ffff, v27
ds_read_b32 v99, v99 offset:2048
v_and_b32 v100, 0x3ffff, v28
ds_read_b32 v100, v100 offset:2048
v_and_b32 v101, 0x3ffff, v29
ds_read_b32 v101, v101 offset:2048
v_and_b32 v102, 0x3ffff, v30
ds_read_b32 v102, v102 offset:2048
v_and_b32 v103, 0x3ffff, v31
ds_read_b32 v103, v103 offset:2048
s_waitcnt lgkmcnt(0)
v_lshrrev_b32 v104, 18, v24
v_lshl_add_u32 v96, v104, 3, v96
v_and_or_b32 v96, v24, s73, v96
ds_write_b64 v96, v[80:81] offset:28160
v_lshrrev_b32 v104, 18, v25
v_lshl_add_u32 v97, v104, 3, v97
v_and_or_b32 v97, v25, s73, v97
ds_write_b64 v97, v[82:83] offset:28160
v_lshrrev_b32 v104, 18, v26
v_lshl_add_u32 v98, v104, 3, v98
v_and_or_b32 v98, v26, s73, v98
ds_write_b64 v98, v[84:85] offset:28160
v_lshrrev_b32 v104, 18, v27
v_lshl_add_u32 v99, v104, 3, v99
v_and_or_b32 v99, v27, s73, v99
ds_write_b64 v99, v[86:87] offset:28160
v_lshrrev_b32 v104, 18, v28
v_lshl_add_u32 v100, v104, 3, v100
v_and_or_b32 v100, v28, s73, v100
ds_write_b64 v100, v[88:89] offset:28160
v_lshrrev_b32 v104, 18, v29
v_lshl_add_u32 v101, v104, 3, v101
v_and_or_b32 v101, v29, s73, v101
ds_write_b64 v101, v[90:91] offset:28160
v_lshrrev_b32 v104, 18, v30
v_lshl_add_u32 v102, v104, 3, v102
v_and_or_b32 v102, v30, s73, v102
ds_write_b64 v102, v[92:93] offset:28160
v_lshrrev_b32 v104, 18, v31
v_lshl_add_u32 v103, v104, 3, v103
v_and_or_b32 v103, v31, s73, v103
ds_write_b64 v103, v[94:95] offset:28160
s_waitcnt lgkmcnt(0)
s_barrier
v_add_u32 v96, 0, v1
ds_read_b128 v[64:67], v96 offset:28160
v_add_u32 v97, 16384, v1
ds_read_b128 v[68:71], v97 offset:28160
v_add_u32 v98, 32768, v1
ds_read_b128 v[72:75], v98 offset:28160
v_add_u32 v99, 49152, v1
ds_read_b128 v[76:79], v99 offset:28160
v_add_u32 v100, 65536, v1
ds_read_b128 v[80:83], v100 offset:28160
v_add_u32 v101, 81920, v1
ds_read_b128 v[84:87], v101 offset:28160
v_add_u32 v102, 98304, v1
ds_read_b128 v[88:91], v102 offset:28160
v_add_u32 v103, 114688, v1
ds_read_b128 v[92:95], v103 offset:28160
v_add_u32 v104, 131072, v1
ds_read_b128 v[112:115], v104 offset:28160
s_waitcnt lgkmcnt(8)
buffer_store_dwordx4 v[64:67], v96, s[28:31], 0 offen nt
s_waitcnt lgkmcnt(7)
buffer_store_dwordx4 v[68:71], v97, s[28:31], 0 offen nt
s_waitcnt lgkmcnt(6)
buffer_store_dwordx4 v[72:75], v98, s[28:31], 0 offen nt
s_waitcnt lgkmcnt(5)
buffer_store_dwordx4 v[76:79], v99, s[28:31], 0 offen nt
s_waitcnt lgkmcnt(4)
buffer_store_dwordx4 v[80:83], v100, s[28:31], 0 offen nt
s_waitcnt lgkmcnt(3)
buffer_store_dwordx4 v[84:87], v101, s[28:31], 0 offen nt
s_waitcnt lgkmcnt(2)
buffer_store_dwordx4 v[88:91], v102, s[28:31], 0 offen nt
s_waitcnt lgkmcnt(1)
buffer_store_dwordx4 v[92:95], v103, s[28:31], 0 offen nt
s_waitcnt lgkmcnt(0)
buffer_store_dwordx4 v[112:115], v104, s[28:31], 0 offen nt
s_waitcnt vmcnt(9)
s_nop 0
v_lshlrev_b32 v112, 3, v40
v_and_b32 v112, 0x7ff8, v112
ds_read_b64 v[64:65], v112 offset:3072
v_lshlrev_b32 v112, 3, v41
v_and_b32 v112, 0x7ff8, v112
ds_read_b64 v[66:67], v112 offset:3072
v_lshlrev_b32 v112, 3, v42
v_and_b32 v112, 0x7ff8, v112
ds_read_b64 v[68:69], v112 offset:3072
v_lshlrev_b32 v112, 3, v43
v_and_b32 v112, 0x7ff8, v112
ds_read_b64 v[70:71], v112 offset:3072
v_cmp_ne_u16 vcc, 0, v56
v_lshrrev_b32 v96, 14, v40
v_and_b32 v96, 0x3fc, v96
v_cndmask_b32 v96, v12, v96, vcc
ds_add_rtn_u32 v100, v96, v14 offset:1024
v_cmp_lt_u32 vcc, 0xffff, v56
v_lshrrev_b32 v97, 14, v41
v_and_b32 v97, 0x3fc, v97
v_cndmask_b32 v97, v12, v97, vcc
ds_add_rtn_u32 v101, v97, v14 offset:1024
v_cmp_ne_u16 vcc, 0, v57
v_lshrrev_b32 v98, 14, v42
v_and_b32 v98, 0x3fc, v98
v_cndmask_b32 v98, v12, v98, vcc
ds_add_rtn_u32 v102, v98, v14 offset:1024
v_cmp_lt_u32 vcc, 0xffff, v57
v_lshrrev_b32 v99, 14, v43
v_and_b32 v99, 0x3fc, v99
v_cndmask_b32 v99, v12, v99, vcc
ds_add_rtn_u32 v103, v99, v14 offset:1024
v_lshlrev_b32 v112, 3, v44
v_and_b32 v112, 0x7ff8, v112
ds_read_b64 v[72:73], v112 offset:3072
v_lshlrev_b32 v112, 3, v45
v_and_b32 v112, 0x7ff8, v112
ds_read_b64 v[74:75], v112 offset:3072
v_lshlrev_b32 v112, 3, v46
v_and_b32 v112, 0x7ff8, v112
ds_read_b64 v[76:77], v112 offset:3072
v_lshlrev_b32 v112, 3, v47
v_and_b32 v112, 0x7ff8, v112
ds_read_b64 v[78:79], v112 offset:3072
v_cmp_ne_u16 vcc, 0, v58
v_lshrrev_b32 v104, 14, v44
v_and_b32 v104, 0x3fc, v104
v_cndmask_b32 v104, v12, v104, vcc
ds_add_rtn_u32 v108, v104, v14 offset:1024
v_cmp_lt_u32 vcc, 0xffff, v58
v_lshrrev_b32 v105, 14, v45
v_and_b32 v105, 0x3fc, v105
v_cndmask_b32 v105, v12, v105, vcc
ds_add_rtn_u32 v109, v105, v14 offset:1024
v_cmp_ne_u16 vcc, 0, v59
v_lshrrev_b32 v106, 14, v46
v_and_b32 v106, 0x3fc, v106
v_cndmask_b32 v106, v12, v106, vcc
ds_add_rtn_u32 v110, v106, v14 offset:1024
v_cmp_lt_u32 vcc, 0xffff, v59
v_lshrrev_b32 v107, 14, v47
v_and_b32 v107, 0x3fc, v107
v_cndmask_b32 v107, v12, v107, vcc
ds_add_rtn_u32 v111, v107, v14 offset:1024
s_waitcnt lgkmcnt(12)
v_pk_mul_f16 v64, v64, v56 op_sel:[0,0] op_sel_hi:[1,0]
v_pk_mul_f16 v65, v65, v56 op_sel:[0,0] op_sel_hi:[1,0]
v_lshrrev_b32 v113, 20, v40
v_lshrrev_b32 v114, 12, v40
v_bfi_b32 v113, 15, v114, v113
v_add_u32 v64, 0x00040004, v64
v_add_u32 v65, 0x00040004, v65
v_lshl_or_b32 v114, v113, 13, v113
v_lshrrev_b32 v115, 6, v113
v_bfi_b32 v64, s72, v114, v64
v_lshl_or_b32 v115, v115, 13, v115
v_bfi_b32 v65, s72, v115, v65
v_pk_mul_f16 v66, v66, v56 op_sel:[0,1] op_sel_hi:[1,1]
v_pk_mul_f16 v67, v67, v56 op_sel:[0,1] op_sel_hi:[1,1]
v_lshrrev_b32 v113, 20, v41
v_lshrrev_b32 v114, 12, v41
v_bfi_b32 v113, 15, v114, v113
v_add_u32 v66, 0x00040004, v66
v_add_u32 v67, 0x00040004, v67
v_lshl_or_b32 v114, v113, 13, v113
v_lshrrev_b32 v115, 6, v113
v_bfi_b32 v66, s72, v114, v66
v_lshl_or_b32 v115, v115, 13, v115
v_bfi_b32 v67, s72, v115, v67
v_pk_mul_f16 v68, v68, v57 op_sel:[0,0] op_sel_hi:[1,0]
v_pk_mul_f16 v69, v69, v57 op_sel:[0,0] op_sel_hi:[1,0]
v_lshrrev_b32 v113, 20, v42
v_lshrrev_b32 v114, 12, v42
v_bfi_b32 v113, 15, v114, v113
v_add_u32 v68, 0x00040004, v68
v_add_u32 v69, 0x00040004, v69
v_lshl_or_b32 v114, v113, 13, v113
v_lshrrev_b32 v115, 6, v113
v_bfi_b32 v68, s72, v114, v68
v_lshl_or_b32 v115, v115, 13, v115
v_bfi_b32 v69, s72, v115, v69
v_pk_mul_f16 v70, v70, v57 op_sel:[0,1] op_sel_hi:[1,1]
v_pk_mul_f16 v71, v71, v57 op_sel:[0,1] op_sel_hi:[1,1]
v_lshrrev_b32 v113, 20, v43
v_lshrrev_b32 v114, 12, v43
v_bfi_b32 v113, 15, v114, v113
v_add_u32 v70, 0x00040004, v70
v_add_u32 v71, 0x00040004, v71
v_lshl_or_b32 v114, v113, 13, v113
v_lshrrev_b32 v115, 6, v113
v_bfi_b32 v70, s72, v114, v70
v_lshl_or_b32 v115, v115, 13, v115
v_bfi_b32 v71, s72, v115, v71
s_waitcnt lgkmcnt(8)
v_lshl_or_b32 v40, v100, 18, v96
v_lshl_or_b32 v41, v101, 18, v97
v_lshl_or_b32 v42, v102, 18, v98
v_lshl_or_b32 v43, v103, 18, v99
v_lshlrev_b32 v112, 3, v48
v_and_b32 v112, 0x7ff8, v112
ds_read_b64 v[80:81], v112 offset:3072
v_lshlrev_b32 v112, 3, v49
v_and_b32 v112, 0x7ff8, v112
ds_read_b64 v[82:83], v112 offset:3072
v_lshlrev_b32 v112, 3, v50
v_and_b32 v112, 0x7ff8, v112
ds_read_b64 v[84:85], v112 offset:3072
v_lshlrev_b32 v112, 3, v51
v_and_b32 v112, 0x7ff8, v112
ds_read_b64 v[86:87], v112 offset:3072
v_cmp_ne_u16 vcc, 0, v60
v_lshrrev_b32 v96, 14, v48
v_and_b32 v96, 0x3fc, v96
v_cndmask_b32 v96, v12, v96, vcc
ds_add_rtn_u32 v100, v96, v14 offset:1024
v_cmp_lt_u32 vcc, 0xffff, v60
v_lshrrev_b32 v97, 14, v49
v_and_b32 v97, 0x3fc, v97
v_cndmask_b32 v97, v12, v97, vcc
ds_add_rtn_u32 v101, v97, v14 offset:1024
v_cmp_ne_u16 vcc, 0, v61
v_lshrrev_b32 v98, 14, v50
v_and_b32 v98, 0x3fc, v98
v_cndmask_b32 v98, v12, v98, vcc
ds_add_rtn_u32 v102, v98, v14 offset:1024
v_cmp_lt_u32 vcc, 0xffff, v61
v_lshrrev_b32 v99, 14, v51
v_and_b32 v99, 0x3fc, v99
v_cndmask_b32 v99, v12, v99, vcc
ds_add_rtn_u32 v103, v99, v14 offset:1024
s_waitcnt lgkmcnt(12)
v_pk_mul_f16 v72, v72, v58 op_sel:[0,0] op_sel_hi:[1,0]
v_pk_mul_f16 v73, v73, v58 op_sel:[0,0] op_sel_hi:[1,0]
v_lshrrev_b32 v113, 20, v44
v_lshrrev_b32 v114, 12, v44
v_bfi_b32 v113, 15, v114, v113
v_add_u32 v72, 0x00040004, v72
v_add_u32 v73, 0x00040004, v73
v_lshl_or_b32 v114, v113, 13, v113
v_lshrrev_b32 v115, 6, v113
v_bfi_b32 v72, s72, v114, v72
v_lshl_or_b32 v115, v115, 13, v115
v_bfi_b32 v73, s72, v115, v73
v_pk_mul_f16 v74, v74, v58 op_sel:[0,1] op_sel_hi:[1,1]
v_pk_mul_f16 v75, v75, v58 op_sel:[0,1] op_sel_hi:[1,1]
v_lshrrev_b32 v113, 20, v45
v_lshrrev_b32 v114, 12, v45
v_bfi_b32 v113, 15, v114, v113
v_add_u32 v74, 0x00040004, v74
v_add_u32 v75, 0x00040004, v75
v_lshl_or_b32 v114, v113, 13, v113
v_lshrrev_b32 v115, 6, v113
v_bfi_b32 v74, s72, v114, v74
v_lshl_or_b32 v115, v115, 13, v115
v_bfi_b32 v75, s72, v115, v75
v_pk_mul_f16 v76, v76, v59 op_sel:[0,0] op_sel_hi:[1,0]
v_pk_mul_f16 v77, v77, v59 op_sel:[0,0] op_sel_hi:[1,0]
v_lshrrev_b32 v113, 20, v46
v_lshrrev_b32 v114, 12, v46
v_bfi_b32 v113, 15, v114, v113
v_add_u32 v76, 0x00040004, v76
v_add_u32 v77, 0x00040004, v77
v_lshl_or_b32 v114, v113, 13, v113
v_lshrrev_b32 v115, 6, v113
v_bfi_b32 v76, s72, v114, v76
v_lshl_or_b32 v115, v115, 13, v115
v_bfi_b32 v77, s72, v115, v77
v_pk_mul_f16 v78, v78, v59 op_sel:[0,1] op_sel_hi:[1,1]
v_pk_mul_f16 v79, v79, v59 op_sel:[0,1] op_sel_hi:[1,1]
v_lshrrev_b32 v113, 20, v47
v_lshrrev_b32 v114, 12, v47
v_bfi_b32 v113, 15, v114, v113
v_add_u32 v78, 0x00040004, v78
v_add_u32 v79, 0x00040004, v79
v_lshl_or_b32 v114, v113, 13, v113
v_lshrrev_b32 v115, 6, v113
v_bfi_b32 v78, s72, v114, v78
v_lshl_or_b32 v115, v115, 13, v115
v_bfi_b32 v79, s72, v115, v79
s_waitcnt lgkmcnt(8)
v_lshl_or_b32 v44, v108, 18, v104
v_lshl_or_b32 v45, v109, 18, v105
v_lshl_or_b32 v46, v110, 18, v106
v_lshl_or_b32 v47, v111, 18, v107
v_lshlrev_b32 v112, 3, v52
v_and_b32 v112, 0x7ff8, v112
ds_read_b64 v[88:89], v112 offset:3072
v_lshlrev_b32 v112, 3, v53
v_and_b32 v112, 0x7ff8, v112
ds_read_b64 v[90:91], v112 offset:3072
v_lshlrev_b32 v112, 3, v54
v_and_b32 v112, 0x7ff8, v112
ds_read_b64 v[92:93], v112 offset:3072
v_lshlrev_b32 v112, 3, v55
v_and_b32 v112, 0x7ff8, v112
ds_read_b64 v[94:95], v112 offset:3072
v_cmp_ne_u16 vcc, 0, v62
v_lshrrev_b32 v104, 14, v52
v_and_b32 v104, 0x3fc, v104
v_cndmask_b32 v104, v12, v104, vcc
ds_add_rtn_u32 v108, v104, v14 offset:1024
v_cmp_lt_u32 vcc, 0xffff, v62
v_lshrrev_b32 v105, 14, v53
v_and_b32 v105, 0x3fc, v105
v_cndmask_b32 v105, v12, v105, vcc
ds_add_rtn_u32 v109, v105, v14 offset:1024
v_cmp_ne_u16 vcc, 0, v63
v_lshrrev_b32 v106, 14, v54
v_and_b32 v106, 0x3fc, v106
v_cndmask_b32 v106, v12, v106, vcc
ds_add_rtn_u32 v110, v106, v14 offset:1024
v_cmp_lt_u32 vcc, 0xffff, v63
v_lshrrev_b32 v107, 14, v55
v_and_b32 v107, 0x3fc, v107
v_cndmask_b32 v107, v12, v107, vcc
ds_add_rtn_u32 v111, v107, v14 offset:1024
s_waitcnt lgkmcnt(12)
v_pk_mul_f16 v80, v80, v60 op_sel:[0,0] op_sel_hi:[1,0]
v_pk_mul_f16 v81, v81, v60 op_sel:[0,0] op_sel_hi:[1,0]
v_lshrrev_b32 v113, 20, v48
v_lshrrev_b32 v114, 12, v48
v_bfi_b32 v113, 15, v114, v113
v_add_u32 v80, 0x00040004, v80
v_add_u32 v81, 0x00040004, v81
v_lshl_or_b32 v114, v113, 13, v113
v_lshrrev_b32 v115, 6, v113
v_bfi_b32 v80, s72, v114, v80
v_lshl_or_b32 v115, v115, 13, v115
v_bfi_b32 v81, s72, v115, v81
v_pk_mul_f16 v82, v82, v60 op_sel:[0,1] op_sel_hi:[1,1]
v_pk_mul_f16 v83, v83, v60 op_sel:[0,1] op_sel_hi:[1,1]
v_lshrrev_b32 v113, 20, v49
v_lshrrev_b32 v114, 12, v49
v_bfi_b32 v113, 15, v114, v113
v_add_u32 v82, 0x00040004, v82
v_add_u32 v83, 0x00040004, v83
v_lshl_or_b32 v114, v113, 13, v113
v_lshrrev_b32 v115, 6, v113
v_bfi_b32 v82, s72, v114, v82
v_lshl_or_b32 v115, v115, 13, v115
v_bfi_b32 v83, s72, v115, v83
v_pk_mul_f16 v84, v84, v61 op_sel:[0,0] op_sel_hi:[1,0]
v_pk_mul_f16 v85, v85, v61 op_sel:[0,0] op_sel_hi:[1,0]
v_lshrrev_b32 v113, 20, v50
v_lshrrev_b32 v114, 12, v50
v_bfi_b32 v113, 15, v114, v113
v_add_u32 v84, 0x00040004, v84
v_add_u32 v85, 0x00040004, v85
v_lshl_or_b32 v114, v113, 13, v113
v_lshrrev_b32 v115, 6, v113
v_bfi_b32 v84, s72, v114, v84
v_lshl_or_b32 v115, v115, 13, v115
v_bfi_b32 v85, s72, v115, v85
v_pk_mul_f16 v86, v86, v61 op_sel:[0,1] op_sel_hi:[1,1]
v_pk_mul_f16 v87, v87, v61 op_sel:[0,1] op_sel_hi:[1,1]
v_lshrrev_b32 v113, 20, v51
v_lshrrev_b32 v114, 12, v51
v_bfi_b32 v113, 15, v114, v113
v_add_u32 v86, 0x00040004, v86
v_add_u32 v87, 0x00040004, v87
v_lshl_or_b32 v114, v113, 13, v113
v_lshrrev_b32 v115, 6, v113
v_bfi_b32 v86, s72, v114, v86
v_lshl_or_b32 v115, v115, 13, v115
v_bfi_b32 v87, s72, v115, v87
s_waitcnt lgkmcnt(8)
v_lshl_or_b32 v48, v100, 18, v96
v_lshl_or_b32 v49, v101, 18, v97
v_lshl_or_b32 v50, v102, 18, v98
v_lshl_or_b32 v51, v103, 18, v99
s_waitcnt lgkmcnt(4)
v_pk_mul_f16 v88, v88, v62 op_sel:[0,0] op_sel_hi:[1,0]
v_pk_mul_f16 v89, v89, v62 op_sel:[0,0] op_sel_hi:[1,0]
v_lshrrev_b32 v113, 20, v52
v_lshrrev_b32 v114, 12, v52
v_bfi_b32 v113, 15, v114, v113
v_add_u32 v88, 0x00040004, v88
v_add_u32 v89, 0x00040004, v89
v_lshl_or_b32 v114, v113, 13, v113
v_lshrrev_b32 v115, 6, v113
v_bfi_b32 v88, s72, v114, v88
v_lshl_or_b32 v115, v115, 13, v115
v_bfi_b32 v89, s72, v115, v89
v_pk_mul_f16 v90, v90, v62 op_sel:[0,1] op_sel_hi:[1,1]
v_pk_mul_f16 v91, v91, v62 op_sel:[0,1] op_sel_hi:[1,1]
v_lshrrev_b32 v113, 20, v53
v_lshrrev_b32 v114, 12, v53
v_bfi_b32 v113, 15, v114, v113
v_add_u32 v90, 0x00040004, v90
v_add_u32 v91, 0x00040004, v91
v_lshl_or_b32 v114, v113, 13, v113
v_lshrrev_b32 v115, 6, v113
v_bfi_b32 v90, s72, v114, v90
v_lshl_or_b32 v115, v115, 13, v115
v_bfi_b32 v91, s72, v115, v91
v_pk_mul_f16 v92, v92, v63 op_sel:[0,0] op_sel_hi:[1,0]
v_pk_mul_f16 v93, v93, v63 op_sel:[0,0] op_sel_hi:[1,0]
v_lshrrev_b32 v113, 20, v54
v_lshrrev_b32 v114, 12, v54
v_bfi_b32 v113, 15, v114, v113
v_add_u32 v92, 0x00040004, v92
v_add_u32 v93, 0x00040004, v93
v_lshl_or_b32 v114, v113, 13, v113
v_lshrrev_b32 v115, 6, v113
v_bfi_b32 v92, s72, v114, v92
v_lshl_or_b32 v115, v115, 13, v115
v_bfi_b32 v93, s72, v115, v93
v_pk_mul_f16 v94, v94, v63 op_sel:[0,1] op_sel_hi:[1,1]
v_pk_mul_f16 v95, v95, v63 op_sel:[0,1] op_sel_hi:[1,1]
v_lshrrev_b32 v113, 20, v55
v_lshrrev_b32 v114, 12, v55
v_bfi_b32 v113, 15, v114, v113
v_add_u32 v94, 0x00040004, v94
v_add_u32 v95, 0x00040004, v95
v_lshl_or_b32 v114, v113, 13, v113
v_lshrrev_b32 v115, 6, v113
v_bfi_b32 v94, s72, v114, v94
v_lshl_or_b32 v115, v115, 13, v115
v_bfi_b32 v95, s72, v115, v95
s_waitcnt lgkmcnt(0)
v_lshl_or_b32 v52, v108, 18, v104
v_lshl_or_b32 v53, v109, 18, v105
v_lshl_or_b32 v54, v110, 18, v106
v_lshl_or_b32 v55, v111, 18, v107
s_barrier
ds_read_b128 v[96:99], v2 offset:1024
s_waitcnt lgkmcnt(0)
v_add_u32 v100, 1, v96
v_lshrrev_b32 v100, 1, v100
v_add_u32 v101, 1, v97
v_lshrrev_b32 v101, 1, v101
v_add_u32 v102, 1, v98
v_lshrrev_b32 v102, 1, v102
v_add_u32 v103, 1, v99
v_lshrrev_b32 v103, 1, v103
v_add_u32 v106, v100, v101
v_add_u32 v107, v106, v102
v_add_u32 v108, v107, v103
v_mov_b32 v109, v108
s_nop 1
v_add_u32_dpp v109, v109, v109 row_shr:1 row_mask:0xf bank_mask:0xf bound_ctrl:0
s_nop 1
v_add_u32_dpp v109, v109, v109 row_shr:2 row_mask:0xf bank_mask:0xf bound_ctrl:0
s_nop 1
v_add_u32_dpp v109, v109, v109 row_shr:4 row_mask:0xf bank_mask:0xf bound_ctrl:0
s_nop 1
v_add_u32_dpp v109, v109, v109 row_shr:8 row_mask:0xf bank_mask:0xf bound_ctrl:0
s_nop 1
v_add_u32_dpp v109, v109, v109 row_bcast:15 row_mask:0xa bank_mask:0xf
s_nop 1
v_add_u32_dpp v109, v109, v109 row_bcast:31 row_mask:0xc bank_mask:0xf
v_sub_u32 v104, v109, v108
v_add_u32 v105, v104, v100
v_add_u32 v106, v104, v106
v_add_u32 v107, v104, v107
v_readlane_b32 s61, v109, 63
v_lshl_or_b32 v100, v100, 16, v104
v_lshl_or_b32 v101, v101, 16, v105
v_lshl_or_b32 v102, v102, 16, v106
v_lshl_or_b32 v103, v103, 16, v107
v_lshlrev_b32 v104, 4, v104
v_lshlrev_b32 v105, 4, v105
v_lshlrev_b32 v106, 4, v106
v_lshlrev_b32 v107, 4, v107
ds_write_b128 v2, v[104:107] offset:2048
ds_write_b128 v2, v[4:7] offset:0
s_cmp_lg_u32 s43, 0
s_cbranch_scc1 k2w0_63
s_mul_i32 s50, s42, 7
s_add_u32 s50, s50, 3
s_lshl_b32 s50, s50, 10
buffer_store_dwordx4 v[100:103], v2, s[32:35], s50 offen
v_and_b32 v111, 1, v96
v_cmp_eq_u32 vcc, 1, v111
v_lshl_add_u32 v110, v96, 3, v104
s_nop 0
v_cndmask_b32 v110, v12, v110, vcc
ds_write_b64 v110, v[4:5] offset:28160
v_and_b32 v111, 1, v97
v_cmp_eq_u32 vcc, 1, v111
v_lshl_add_u32 v110, v97, 3, v105
s_nop 0
v_cndmask_b32 v110, v12, v110, vcc
ds_write_b64 v110, v[4:5] offset:28160
v_and_b32 v111, 1, v98
v_cmp_eq_u32 vcc, 1, v111
v_lshl_add_u32 v110, v98, 3, v106
s_nop 0
v_cndmask_b32 v110, v12, v110, vcc
ds_write_b64 v110, v[4:5] offset:28160
v_and_b32 v111, 1, v99
v_cmp_eq_u32 vcc, 1, v111
v_lshl_add_u32 v110, v99, 3, v107
s_nop 0
v_cndmask_b32 v110, v12, v110, vcc
ds_write_b64 v110, v[4:5] offset:28160
k2w0_63:
s_mul_i32 s50, s42, 7
s_add_u32 s50, s50, 3
s_mul_i32 s51, s50, 133120
s_add_u32 s28, s52, s51
s_addc_u32 s29, s53, 0
s_and_b32 s29, s29, 0xffff
s_lshl_b32 s30, s61, 4
s_add_u32 s30, s30, 127
s_and_b32 s30, s30, 0xffffff80
s_waitcnt lgkmcnt(0)
s_cmp_lt_u32 s64, s46
s_cbranch_scc1 k2ns_64
s_cmp_lg_u32 s65, 0
s_cbranch_scc1 k2ns_64
v_mov_b32 v8, v10
v_mov_b32 v9, v11
s_mov_b32 s46, s47
s_mov_b32 s64, 0
s_mov_b32 s65, 1
s_mov_b32 s66, 0
v_readlane_b32 s67, v8, 0
k2ns_64:
v_mov_b32 v96, s68
s_add_u32 s69, s64, 64
s_cmp_lt_u32 s67, s69
s_cbranch_scc0 gwek2_66
gwk2_65:
v_readlane_b32 s68, v9, s66
s_add_u32 s66, s66, 1
s_sub_u32 s70, s67, s64
s_max_i32 s70, s70, 0
v_readlane_b32 s67, v8, s66
s_lshl_b64 exec, -1, s70
v_mov_b32 v96, s68
s_cmp_lt_u32 s67, s69
s_cbranch_scc1 gwk2_65
s_mov_b64 exec, -1
gwek2_66:
v_add3_u32 v96, v96, s64, v3
s_add_u32 s64, s64, 64
v_mul_u32_u24 v96, 24, v96
buffer_load_dwordx4 v[16:19], v96, s[8:11], 0 offen
buffer_load_dwordx2 v[32:33], v96, s[8:11], 0 offen offset:16
s_cmp_lt_u32 s64, s46
s_cbranch_scc1 k2ns_67
s_cmp_lg_u32 s65, 0
s_cbranch_scc1 k2ns_67
v_mov_b32 v8, v10
v_mov_b32 v9, v11
s_mov_b32 s46, s47
s_mov_b32 s64, 0
s_mov_b32 s65, 1
s_mov_b32 s66, 0
v_readlane_b32 s67, v8, 0
k2ns_67:
v_mov_b32 v98, s68
s_add_u32 s69, s64, 64
s_cmp_lt_u32 s67, s69
s_cbranch_scc0 gwek2_69
gwk2_68:
v_readlane_b32 s68, v9, s66
s_add_u32 s66, s66, 1
s_sub_u32 s70, s67, s64
s_max_i32 s70, s70, 0
v_readlane_b32 s67, v8, s66
s_lshl_b64 exec, -1, s70
v_mov_b32 v98, s68
s_cmp_lt_u32 s67, s69
s_cbranch_scc1 gwk2_68
s_mov_b64 exec, -1
gwek2_69:
v_add3_u32 v98, v98, s64, v3
s_add_u32 s64, s64, 64
v_mul_u32_u24 v98, 24, v98
buffer_load_dwordx4 v[20:23], v98, s[8:11], 0 offen
buffer_load_dwordx2 v[34:35], v98, s[8:11], 0 offen offset:16
s_cmp_lt_u32 s64, s46
s_cbranch_scc1 k2ns_70
s_cmp_lg_u32 s65, 0
s_cbranch_scc1 k2ns_70
v_mov_b32 v8, v10
v_mov_b32 v9, v11
s_mov_b32 s46, s47
s_mov_b32 s64, 0
s_mov_b32 s65, 1
s_mov_b32 s66, 0
v_readlane_b32 s67, v8, 0
k2ns_70:
v_mov_b32 v100, s68
s_add_u32 s69, s64, 64
s_cmp_lt_u32 s67, s69
s_cbranch_scc0 gwek2_72
gwk2_71:
v_readlane_b32 s68, v9, s66
s_add_u32 s66, s66, 1
s_sub_u32 s70, s67, s64
s_max_i32 s70, s70, 0
v_readlane_b32 s67, v8, s66
s_lshl_b64 exec, -1, s70
v_mov_b32 v100, s68
s_cmp_lt_u32 s67, s69
s_cbranch_scc1 gwk2_71
s_mov_b64 exec, -1
gwek2_72:
v_add3_u32 v100, v100, s64, v3
s_add_u32 s64, s64, 64
v_mul_u32_u24 v100, 24, v100
buffer_load_dwordx4 v[24:27], v100, s[8:11], 0 offen
buffer_load_dwordx2 v[36:37], v100, s[8:11], 0 offen offset:16
s_cmp_lt_u32 s64, s46
s_cbranch_scc1 k2ns_73
s_cmp_lg_u32 s65, 0
s_cbranch_scc1 k2ns_73
v_mov_b32 v8, v10
v_mov_b32 v9, v11
s_mov_b32 s46, s47
s_mov_b32 s64, 0
s_mov_b32 s65, 1
s_mov_b32 s66, 0
v_readlane_b32 s67, v8, 0
k2ns_73:
v_mov_b32 v102, s68
s_add_u32 s69, s64, 64
s_cmp_lt_u32 s67, s69
s_cbranch_scc0 gwek2_75
gwk2_74:
v_readlane_b32 s68, v9, s66
s_add_u32 s66, s66, 1
s_sub_u32 s70, s67, s64
s_max_i32 s70, s70, 0
v_readlane_b32 s67, v8, s66
s_lshl_b64 exec, -1, s70
v_mov_b32 v102, s68
s_cmp_lt_u32 s67, s69
s_cbranch_scc1 gwk2_74
s_mov_b64 exec, -1
gwek2_75:
v_add3_u32 v102, v102, s64, v3
s_add_u32 s64, s64, 64
v_mul_u32_u24 v102, 24, v102
buffer_load_dwordx4 v[28:31], v102, s[8:11], 0 offen
buffer_load_dwordx2 v[38:39], v102, s[8:11], 0 offen offset:16
v_and_b32 v96, 0x3ffff, v40
ds_read_b32 v96, v96 offset:2048
v_and_b32 v97, 0x3ffff, v41
ds_read_b32 v97, v97 offset:2048
v_and_b32 v98, 0x3ffff, v42
ds_read_b32 v98, v98 offset:2048
v_and_b32 v99, 0x3ffff, v43
ds_read_b32 v99, v99 offset:2048
v_and_b32 v100, 0x3ffff, v44
ds_read_b32 v100, v100 offset:2048
v_and_b32 v101, 0x3ffff, v45
ds_read_b32 v101, v101 offset:2048
v_and_b32 v102, 0x3ffff, v46
ds_read_b32 v102, v102 offset:2048
v_and_b32 v103, 0x3ffff, v47
ds_read_b32 v103, v103 offset:2048
s_waitcnt lgkmcnt(0)
v_lshrrev_b32 v104, 18, v40
v_lshl_add_u32 v96, v104, 3, v96
v_and_or_b32 v96, v40, s73, v96
ds_write_b64 v96, v[64:65] offset:28160
v_lshrrev_b32 v104, 18, v41
v_lshl_add_u32 v97, v104, 3, v97
v_and_or_b32 v97, v41, s73, v97
ds_write_b64 v97, v[66:67] offset:28160
v_lshrrev_b32 v104, 18, v42
v_lshl_add_u32 v98, v104, 3, v98
v_and_or_b32 v98, v42, s73, v98
ds_write_b64 v98, v[68:69] offset:28160
v_lshrrev_b32 v104, 18, v43
v_lshl_add_u32 v99, v104, 3, v99
v_and_or_b32 v99, v43, s73, v99
ds_write_b64 v99, v[70:71] offset:28160
v_lshrrev_b32 v104, 18, v44
v_lshl_add_u32 v100, v104, 3, v100
v_and_or_b32 v100, v44, s73, v100
ds_write_b64 v100, v[72:73] offset:28160
v_lshrrev_b32 v104, 18, v45
v_lshl_add_u32 v101, v104, 3, v101
v_and_or_b32 v101, v45, s73, v101
ds_write_b64 v101, v[74:75] offset:28160
v_lshrrev_b32 v104, 18, v46
v_lshl_add_u32 v102, v104, 3, v102
v_and_or_b32 v102, v46, s73, v102
ds_write_b64 v102, v[76:77] offset:28160
v_lshrrev_b32 v104, 18, v47
v_lshl_add_u32 v103, v104, 3, v103
v_and_or_b32 v103, v47, s73, v103
ds_write_b64 v103, v[78:79] offset:28160
v_and_b32 v96, 0x3ffff, v48
ds_read_b32 v96, v96 offset:2048
v_and_b32 v97, 0x3ffff, v49
ds_read_b32 v97, v97 offset:2048
v_and_b32 v98, 0x3ffff, v50
ds_read_b32 v98, v98 offset:2048
v_and_b32 v99, 0x3ffff, v51
ds_read_b32 v99, v99 offset:2048
v_and_b32 v100, 0x3ffff, v52
ds_read_b32 v100, v100 offset:2048
v_and_b32 v101, 0x3ffff, v53
ds_read_b32 v101, v101 offset:2048
v_and_b32 v102, 0x3ffff, v54
ds_read_b32 v102, v102 offset:2048
v_and_b32 v103, 0x3ffff, v55
ds_read_b32 v103, v103 offset:2048
s_waitcnt lgkmcnt(0)
v_lshrrev_b32 v104, 18, v48
v_lshl_add_u32 v96, v104, 3, v96
v_and_or_b32 v96, v48, s73, v96
ds_write_b64 v96, v[80:81] offset:28160
v_lshrrev_b32 v104, 18, v49
v_lshl_add_u32 v97, v104, 3, v97
v_and_or_b32 v97, v49, s73, v97
ds_write_b64 v97, v[82:83] offset:28160
v_lshrrev_b32 v104, 18, v50
v_lshl_add_u32 v98, v104, 3, v98
v_and_or_b32 v98, v50, s73, v98
ds_write_b64 v98, v[84:85] offset:28160
v_lshrrev_b32 v104, 18, v51
v_lshl_add_u32 v99, v104, 3, v99
v_and_or_b32 v99, v51, s73, v99
ds_write_b64 v99, v[86:87] offset:28160
v_lshrrev_b32 v104, 18, v52
v_lshl_add_u32 v100, v104, 3, v100
v_and_or_b32 v100, v52, s73, v100
ds_write_b64 v100, v[88:89] offset:28160
v_lshrrev_b32 v104, 18, v53
v_lshl_add_u32 v101, v104, 3, v101
v_and_or_b32 v101, v53, s73, v101
ds_write_b64 v101, v[90:91] offset:28160
v_lshrrev_b32 v104, 18, v54
v_lshl_add_u32 v102, v104, 3, v102
v_and_or_b32 v102, v54, s73, v102
ds_write_b64 v102, v[92:93] offset:28160
v_lshrrev_b32 v104, 18, v55
v_lshl_add_u32 v103, v104, 3, v103
v_and_or_b32 v103, v55, s73, v103
ds_write_b64 v103, v[94:95] offset:28160
s_waitcnt lgkmcnt(0)
s_barrier
v_add_u32 v96, 0, v1
ds_read_b128 v[64:67], v96 offset:28160
v_add_u32 v97, 16384, v1
ds_read_b128 v[68:71], v97 offset:28160
v_add_u32 v98, 32768, v1
ds_read_b128 v[72:75], v98 offset:28160
v_add_u32 v99, 49152, v1
ds_read_b128 v[76:79], v99 offset:28160
v_add_u32 v100, 65536, v1
ds_read_b128 v[80:83], v100 offset:28160
v_add_u32 v101, 81920, v1
ds_read_b128 v[84:87], v101 offset:28160
v_add_u32 v102, 98304, v1
ds_read_b128 v[88:91], v102 offset:28160
v_add_u32 v103, 114688, v1
ds_read_b128 v[92:95], v103 offset:28160
v_add_u32 v104, 131072, v1
ds_read_b128 v[112:115], v104 offset:28160
s_waitcnt lgkmcnt(8)
buffer_store_dwordx4 v[64:67], v96, s[28:31], 0 offen nt
s_waitcnt lgkmcnt(7)
buffer_store_dwordx4 v[68:71], v97, s[28:31], 0 offen nt
s_waitcnt lgkmcnt(6)
buffer_store_dwordx4 v[72:75], v98, s[28:31], 0 offen nt
s_waitcnt lgkmcnt(5)
buffer_store_dwordx4 v[76:79], v99, s[28:31], 0 offen nt
s_waitcnt lgkmcnt(4)
buffer_store_dwordx4 v[80:83], v100, s[28:31], 0 offen nt
s_waitcnt lgkmcnt(3)
buffer_store_dwordx4 v[84:87], v101, s[28:31], 0 offen nt
s_waitcnt lgkmcnt(2)
buffer_store_dwordx4 v[88:91], v102, s[28:31], 0 offen nt
s_waitcnt lgkmcnt(1)
buffer_store_dwordx4 v[92:95], v103, s[28:31], 0 offen nt
s_waitcnt lgkmcnt(0)
buffer_store_dwordx4 v[112:115], v104, s[28:31], 0 offen nt
s_waitcnt vmcnt(9)
s_nop 0
v_lshlrev_b32 v112, 3, v16
v_and_b32 v112, 0x7ff8, v112
ds_read_b64 v[64:65], v112 offset:3072
v_lshlrev_b32 v112, 3, v17
v_and_b32 v112, 0x7ff8, v112
ds_read_b64 v[66:67], v112 offset:3072
v_lshlrev_b32 v112, 3, v18
v_and_b32 v112, 0x7ff8, v112
ds_read_b64 v[68:69], v112 offset:3072
v_lshlrev_b32 v112, 3, v19
v_and_b32 v112, 0x7ff8, v112
ds_read_b64 v[70:71], v112 offset:3072
v_cmp_ne_u16 vcc, 0, v32
v_lshrrev_b32 v96, 14, v16
v_and_b32 v96, 0x3fc, v96
v_cndmask_b32 v96, v12, v96, vcc
ds_add_rtn_u32 v100, v96, v14 offset:0
v_cmp_lt_u32 vcc, 0xffff, v32
v_lshrrev_b32 v97, 14, v17
v_and_b32 v97, 0x3fc, v97
v_cndmask_b32 v97, v12, v97, vcc
ds_add_rtn_u32 v101, v97, v14 offset:0
v_cmp_ne_u16 vcc, 0, v33
v_lshrrev_b32 v98, 14, v18
v_and_b32 v98, 0x3fc, v98
v_cndmask_b32 v98, v12, v98, vcc
ds_add_rtn_u32 v102, v98, v14 offset:0
v_cmp_lt_u32 vcc, 0xffff, v33
v_lshrrev_b32 v99, 14, v19
v_and_b32 v99, 0x3fc, v99
v_cndmask_b32 v99, v12, v99, vcc
ds_add_rtn_u32 v103, v99, v14 offset:0
v_lshlrev_b32 v112, 3, v20
v_and_b32 v112, 0x7ff8, v112
ds_read_b64 v[72:73], v112 offset:3072
v_lshlrev_b32 v112, 3, v21
v_and_b32 v112, 0x7ff8, v112
ds_read_b64 v[74:75], v112 offset:3072
v_lshlrev_b32 v112, 3, v22
v_and_b32 v112, 0x7ff8, v112
ds_read_b64 v[76:77], v112 offset:3072
v_lshlrev_b32 v112, 3, v23
v_and_b32 v112, 0x7ff8, v112
ds_read_b64 v[78:79], v112 offset:3072
v_cmp_ne_u16 vcc, 0, v34
v_lshrrev_b32 v104, 14, v20
v_and_b32 v104, 0x3fc, v104
v_cndmask_b32 v104, v12, v104, vcc
ds_add_rtn_u32 v108, v104, v14 offset:0
v_cmp_lt_u32 vcc, 0xffff, v34
v_lshrrev_b32 v105, 14, v21
v_and_b32 v105, 0x3fc, v105
v_cndmask_b32 v105, v12, v105, vcc
ds_add_rtn_u32 v109, v105, v14 offset:0
v_cmp_ne_u16 vcc, 0, v35
v_lshrrev_b32 v106, 14, v22
v_and_b32 v106, 0x3fc, v106
v_cndmask_b32 v106, v12, v106, vcc
ds_add_rtn_u32 v110, v106, v14 offset:0
v_cmp_lt_u32 vcc, 0xffff, v35
v_lshrrev_b32 v107, 14, v23
v_and_b32 v107, 0x3fc, v107
v_cndmask_b32 v107, v12, v107, vcc
ds_add_rtn_u32 v111, v107, v14 offset:0
s_waitcnt lgkmcnt(12)
v_pk_mul_f16 v64, v64, v32 op_sel:[0,0] op_sel_hi:[1,0]
v_pk_mul_f16 v65, v65, v32 op_sel:[0,0] op_sel_hi:[1,0]
v_lshrrev_b32 v113, 20, v16
v_lshrrev_b32 v114, 12, v16
v_bfi_b32 v113, 15, v114, v113
v_add_u32 v64, 0x00040004, v64
v_add_u32 v65, 0x00040004, v65
v_lshl_or_b32 v114, v113, 13, v113
v_lshrrev_b32 v115, 6, v113
v_bfi_b32 v64, s72, v114, v64
v_lshl_or_b32 v115, v115, 13, v115
v_bfi_b32 v65, s72, v115, v65
v_pk_mul_f16 v66, v66, v32 op_sel:[0,1] op_sel_hi:[1,1]
v_pk_mul_f16 v67, v67, v32 op_sel:[0,1] op_sel_hi:[1,1]
v_lshrrev_b32 v113, 20, v17
v_lshrrev_b32 v114, 12, v17
v_bfi_b32 v113, 15, v114, v113
v_add_u32 v66, 0x00040004, v66
v_add_u32 v67, 0x00040004, v67
v_lshl_or_b32 v114, v113, 13, v113
v_lshrrev_b32 v115, 6, v113
v_bfi_b32 v66, s72, v114, v66
v_lshl_or_b32 v115, v115, 13, v115
v_bfi_b32 v67, s72, v115, v67
v_pk_mul_f16 v68, v68, v33 op_sel:[0,0] op_sel_hi:[1,0]
v_pk_mul_f16 v69, v69, v33 op_sel:[0,0] op_sel_hi:[1,0]
v_lshrrev_b32 v113, 20, v18
v_lshrrev_b32 v114, 12, v18
v_bfi_b32 v113, 15, v114, v113
v_add_u32 v68, 0x00040004, v68
v_add_u32 v69, 0x00040004, v69
v_lshl_or_b32 v114, v113, 13, v113
v_lshrrev_b32 v115, 6, v113
v_bfi_b32 v68, s72, v114, v68
v_lshl_or_b32 v115, v115, 13, v115
v_bfi_b32 v69, s72, v115, v69
v_pk_mul_f16 v70, v70, v33 op_sel:[0,1] op_sel_hi:[1,1]
v_pk_mul_f16 v71, v71, v33 op_sel:[0,1] op_sel_hi:[1,1]
v_lshrrev_b32 v113, 20, v19
v_lshrrev_b32 v114, 12, v19
v_bfi_b32 v113, 15, v114, v113
v_add_u32 v70, 0x00040004, v70
v_add_u32 v71, 0x00040004, v71
v_lshl_or_b32 v114, v113, 13, v113
v_lshrrev_b32 v115, 6, v113
v_bfi_b32 v70, s72, v114, v70
v_lshl_or_b32 v115, v115, 13, v115
v_bfi_b32 v71, s72, v115, v71
s_waitcnt lgkmcnt(8)
v_lshl_or_b32 v16, v100, 18, v96
v_lshl_or_b32 v17, v101, 18, v97
v_lshl_or_b32 v18, v102, 18, v98
v_lshl_or_b32 v19, v103, 18, v99
v_lshlrev_b32 v112, 3, v24
v_and_b32 v112, 0x7ff8, v112
ds_read_b64 v[80:81], v112 offset:3072
v_lshlrev_b32 v112, 3, v25
v_and_b32 v112, 0x7ff8, v112
ds_read_b64 v[82:83], v112 offset:3072
v_lshlrev_b32 v112, 3, v26
v_and_b32 v112, 0x7ff8, v112
ds_read_b64 v[84:85], v112 offset:3072
v_lshlrev_b32 v112, 3, v27
v_and_b32 v112, 0x7ff8, v112
ds_read_b64 v[86:87], v112 offset:3072
v_cmp_ne_u16 vcc, 0, v36
v_lshrrev_b32 v96, 14, v24
v_and_b32 v96, 0x3fc, v96
v_cndmask_b32 v96, v12, v96, vcc
ds_add_rtn_u32 v100, v96, v14 offset:0
v_cmp_lt_u32 vcc, 0xffff, v36
v_lshrrev_b32 v97, 14, v25
v_and_b32 v97, 0x3fc, v97
v_cndmask_b32 v97, v12, v97, vcc
ds_add_rtn_u32 v101, v97, v14 offset:0
v_cmp_ne_u16 vcc, 0, v37
v_lshrrev_b32 v98, 14, v26
v_and_b32 v98, 0x3fc, v98
v_cndmask_b32 v98, v12, v98, vcc
ds_add_rtn_u32 v102, v98, v14 offset:0
v_cmp_lt_u32 vcc, 0xffff, v37
v_lshrrev_b32 v99, 14, v27
v_and_b32 v99, 0x3fc, v99
v_cndmask_b32 v99, v12, v99, vcc
ds_add_rtn_u32 v103, v99, v14 offset:0
s_waitcnt lgkmcnt(12)
v_pk_mul_f16 v72, v72, v34 op_sel:[0,0] op_sel_hi:[1,0]
v_pk_mul_f16 v73, v73, v34 op_sel:[0,0] op_sel_hi:[1,0]
v_lshrrev_b32 v113, 20, v20
v_lshrrev_b32 v114, 12, v20
v_bfi_b32 v113, 15, v114, v113
v_add_u32 v72, 0x00040004, v72
v_add_u32 v73, 0x00040004, v73
v_lshl_or_b32 v114, v113, 13, v113
v_lshrrev_b32 v115, 6, v113
v_bfi_b32 v72, s72, v114, v72
v_lshl_or_b32 v115, v115, 13, v115
v_bfi_b32 v73, s72, v115, v73
v_pk_mul_f16 v74, v74, v34 op_sel:[0,1] op_sel_hi:[1,1]
v_pk_mul_f16 v75, v75, v34 op_sel:[0,1] op_sel_hi:[1,1]
v_lshrrev_b32 v113, 20, v21
v_lshrrev_b32 v114, 12, v21
v_bfi_b32 v113, 15, v114, v113
v_add_u32 v74, 0x00040004, v74
v_add_u32 v75, 0x00040004, v75
v_lshl_or_b32 v114, v113, 13, v113
v_lshrrev_b32 v115, 6, v113
v_bfi_b32 v74, s72, v114, v74
v_lshl_or_b32 v115, v115, 13, v115
v_bfi_b32 v75, s72, v115, v75
v_pk_mul_f16 v76, v76, v35 op_sel:[0,0] op_sel_hi:[1,0]
v_pk_mul_f16 v77, v77, v35 op_sel:[0,0] op_sel_hi:[1,0]
v_lshrrev_b32 v113, 20, v22
v_lshrrev_b32 v114, 12, v22
v_bfi_b32 v113, 15, v114, v113
v_add_u32 v76, 0x00040004, v76
v_add_u32 v77, 0x00040004, v77
v_lshl_or_b32 v114, v113, 13, v113
v_lshrrev_b32 v115, 6, v113
v_bfi_b32 v76, s72, v114, v76
v_lshl_or_b32 v115, v115, 13, v115
v_bfi_b32 v77, s72, v115, v77
v_pk_mul_f16 v78, v78, v35 op_sel:[0,1] op_sel_hi:[1,1]
v_pk_mul_f16 v79, v79, v35 op_sel:[0,1] op_sel_hi:[1,1]
v_lshrrev_b32 v113, 20, v23
v_lshrrev_b32 v114, 12, v23
v_bfi_b32 v113, 15, v114, v113
v_add_u32 v78, 0x00040004, v78
v_add_u32 v79, 0x00040004, v79
v_lshl_or_b32 v114, v113, 13, v113
v_lshrrev_b32 v115, 6, v113
v_bfi_b32 v78, s72, v114, v78
v_lshl_or_b32 v115, v115, 13, v115
v_bfi_b32 v79, s72, v115, v79
s_waitcnt lgkmcnt(8)
v_lshl_or_b32 v20, v108, 18, v104
v_lshl_or_b32 v21, v109, 18, v105
v_lshl_or_b32 v22, v110, 18, v106
v_lshl_or_b32 v23, v111, 18, v107
v_lshlrev_b32 v112, 3, v28
v_and_b32 v112, 0x7ff8, v112
ds_read_b64 v[88:89], v112 offset:3072
v_lshlrev_b32 v112, 3, v29
v_and_b32 v112, 0x7ff8, v112
ds_read_b64 v[90:91], v112 offset:3072
v_lshlrev_b32 v112, 3, v30
v_and_b32 v112, 0x7ff8, v112
ds_read_b64 v[92:93], v112 offset:3072
v_lshlrev_b32 v112, 3, v31
v_and_b32 v112, 0x7ff8, v112
ds_read_b64 v[94:95], v112 offset:3072
v_cmp_ne_u16 vcc, 0, v38
v_lshrrev_b32 v104, 14, v28
v_and_b32 v104, 0x3fc, v104
v_cndmask_b32 v104, v12, v104, vcc
ds_add_rtn_u32 v108, v104, v14 offset:0
v_cmp_lt_u32 vcc, 0xffff, v38
v_lshrrev_b32 v105, 14, v29
v_and_b32 v105, 0x3fc, v105
v_cndmask_b32 v105, v12, v105, vcc
ds_add_rtn_u32 v109, v105, v14 offset:0
v_cmp_ne_u16 vcc, 0, v39
v_lshrrev_b32 v106, 14, v30
v_and_b32 v106, 0x3fc, v106
v_cndmask_b32 v106, v12, v106, vcc
ds_add_rtn_u32 v110, v106, v14 offset:0
v_cmp_lt_u32 vcc, 0xffff, v39
v_lshrrev_b32 v107, 14, v31
v_and_b32 v107, 0x3fc, v107
v_cndmask_b32 v107, v12, v107, vcc
ds_add_rtn_u32 v111, v107, v14 offset:0
s_waitcnt lgkmcnt(12)
v_pk_mul_f16 v80, v80, v36 op_sel:[0,0] op_sel_hi:[1,0]
v_pk_mul_f16 v81, v81, v36 op_sel:[0,0] op_sel_hi:[1,0]
v_lshrrev_b32 v113, 20, v24
v_lshrrev_b32 v114, 12, v24
v_bfi_b32 v113, 15, v114, v113
v_add_u32 v80, 0x00040004, v80
v_add_u32 v81, 0x00040004, v81
v_lshl_or_b32 v114, v113, 13, v113
v_lshrrev_b32 v115, 6, v113
v_bfi_b32 v80, s72, v114, v80
v_lshl_or_b32 v115, v115, 13, v115
v_bfi_b32 v81, s72, v115, v81
v_pk_mul_f16 v82, v82, v36 op_sel:[0,1] op_sel_hi:[1,1]
v_pk_mul_f16 v83, v83, v36 op_sel:[0,1] op_sel_hi:[1,1]
v_lshrrev_b32 v113, 20, v25
v_lshrrev_b32 v114, 12, v25
v_bfi_b32 v113, 15, v114, v113
v_add_u32 v82, 0x00040004, v82
v_add_u32 v83, 0x00040004, v83
v_lshl_or_b32 v114, v113, 13, v113
v_lshrrev_b32 v115, 6, v113
v_bfi_b32 v82, s72, v114, v82
v_lshl_or_b32 v115, v115, 13, v115
v_bfi_b32 v83, s72, v115, v83
v_pk_mul_f16 v84, v84, v37 op_sel:[0,0] op_sel_hi:[1,0]
v_pk_mul_f16 v85, v85, v37 op_sel:[0,0] op_sel_hi:[1,0]
v_lshrrev_b32 v113, 20, v26
v_lshrrev_b32 v114, 12, v26
v_bfi_b32 v113, 15, v114, v113
v_add_u32 v84, 0x00040004, v84
v_add_u32 v85, 0x00040004, v85
v_lshl_or_b32 v114, v113, 13, v113
v_lshrrev_b32 v115, 6, v113
v_bfi_b32 v84, s72, v114, v84
v_lshl_or_b32 v115, v115, 13, v115
v_bfi_b32 v85, s72, v115, v85
v_pk_mul_f16 v86, v86, v37 op_sel:[0,1] op_sel_hi:[1,1]
v_pk_mul_f16 v87, v87, v37 op_sel:[0,1] op_sel_hi:[1,1]
v_lshrrev_b32 v113, 20, v27
v_lshrrev_b32 v114, 12, v27
v_bfi_b32 v113, 15, v114, v113
v_add_u32 v86, 0x00040004, v86
v_add_u32 v87, 0x00040004, v87
v_lshl_or_b32 v114, v113, 13, v113
v_lshrrev_b32 v115, 6, v113
v_bfi_b32 v86, s72, v114, v86
v_lshl_or_b32 v115, v115, 13, v115
v_bfi_b32 v87, s72, v115, v87
s_waitcnt lgkmcnt(8)
v_lshl_or_b32 v24, v100, 18, v96
v_lshl_or_b32 v25, v101, 18, v97
v_lshl_or_b32 v26, v102, 18, v98
v_lshl_or_b32 v27, v103, 18, v99
s_waitcnt lgkmcnt(4)
v_pk_mul_f16 v88, v88, v38 op_sel:[0,0] op_sel_hi:[1,0]
v_pk_mul_f16 v89, v89, v38 op_sel:[0,0] op_sel_hi:[1,0]
v_lshrrev_b32 v113, 20, v28
v_lshrrev_b32 v114, 12, v28
v_bfi_b32 v113, 15, v114, v113
v_add_u32 v88, 0x00040004, v88
v_add_u32 v89, 0x00040004, v89
v_lshl_or_b32 v114, v113, 13, v113
v_lshrrev_b32 v115, 6, v113
v_bfi_b32 v88, s72, v114, v88
v_lshl_or_b32 v115, v115, 13, v115
v_bfi_b32 v89, s72, v115, v89
v_pk_mul_f16 v90, v90, v38 op_sel:[0,1] op_sel_hi:[1,1]
v_pk_mul_f16 v91, v91, v38 op_sel:[0,1] op_sel_hi:[1,1]
v_lshrrev_b32 v113, 20, v29
v_lshrrev_b32 v114, 12, v29
v_bfi_b32 v113, 15, v114, v113
v_add_u32 v90, 0x00040004, v90
v_add_u32 v91, 0x00040004, v91
v_lshl_or_b32 v114, v113, 13, v113
v_lshrrev_b32 v115, 6, v113
v_bfi_b32 v90, s72, v114, v90
v_lshl_or_b32 v115, v115, 13, v115
v_bfi_b32 v91, s72, v115, v91
v_pk_mul_f16 v92, v92, v39 op_sel:[0,0] op_sel_hi:[1,0]
v_pk_mul_f16 v93, v93, v39 op_sel:[0,0] op_sel_hi:[1,0]
v_lshrrev_b32 v113, 20, v30
v_lshrrev_b32 v114, 12, v30
v_bfi_b32 v113, 15, v114, v113
v_add_u32 v92, 0x00040004, v92
v_add_u32 v93, 0x00040004, v93
v_lshl_or_b32 v114, v113, 13, v113
v_lshrrev_b32 v115, 6, v113
v_bfi_b32 v92, s72, v114, v92
v_lshl_or_b32 v115, v115, 13, v115
v_bfi_b32 v93, s72, v115, v93
v_pk_mul_f16 v94, v94, v39 op_sel:[0,1] op_sel_hi:[1,1]
v_pk_mul_f16 v95, v95, v39 op_sel:[0,1] op_sel_hi:[1,1]
v_lshrrev_b32 v113, 20, v31
v_lshrrev_b32 v114, 12, v31
v_bfi_b32 v113, 15, v114, v113
v_add_u32 v94, 0x00040004, v94
v_add_u32 v95, 0x00040004, v95
v_lshl_or_b32 v114, v113, 13, v113
v_lshrrev_b32 v115, 6, v113
v_bfi_b32 v94, s72, v114, v94
v_lshl_or_b32 v115, v115, 13, v115
v_bfi_b32 v95, s72, v115, v95
s_waitcnt lgkmcnt(0)
v_lshl_or_b32 v28, v108, 18, v104
v_lshl_or_b32 v29, v109, 18, v105
v_lshl_or_b32 v30, v110, 18, v106
v_lshl_or_b32 v31, v111, 18, v107
s_barrier
ds_read_b128 v[96:99], v2 offset:0
s_waitcnt lgkmcnt(0)
v_add_u32 v100, 1, v96
v_lshrrev_b32 v100, 1, v100
v_add_u32 v101, 1, v97
v_lshrrev_b32 v101, 1, v101
v_add_u32 v102, 1, v98
v_lshrrev_b32 v102, 1, v102
v_add_u32 v103, 1, v99
v_lshrrev_b32 v103, 1, v103
v_add_u32 v106, v100, v101
v_add_u32 v107, v106, v102
v_add_u32 v108, v107, v103
v_mov_b32 v109, v108
s_nop 1
v_add_u32_dpp v109, v109, v109 row_shr:1 row_mask:0xf bank_mask:0xf bound_ctrl:0
s_nop 1
v_add_u32_dpp v109, v109, v109 row_shr:2 row_mask:0xf bank_mask:0xf bound_ctrl:0
s_nop 1
v_add_u32_dpp v109, v109, v109 row_shr:4 row_mask:0xf bank_mask:0xf bound_ctrl:0
s_nop 1
v_add_u32_dpp v109, v109, v109 row_shr:8 row_mask:0xf bank_mask:0xf bound_ctrl:0
s_nop 1
v_add_u32_dpp v109, v109, v109 row_bcast:15 row_mask:0xa bank_mask:0xf
s_nop 1
v_add_u32_dpp v109, v109, v109 row_bcast:31 row_mask:0xc bank_mask:0xf
v_sub_u32 v104, v109, v108
v_add_u32 v105, v104, v100
v_add_u32 v106, v104, v106
v_add_u32 v107, v104, v107
v_readlane_b32 s61, v109, 63
v_lshl_or_b32 v100, v100, 16, v104
v_lshl_or_b32 v101, v101, 16, v105
v_lshl_or_b32 v102, v102, 16, v106
v_lshl_or_b32 v103, v103, 16, v107
v_lshlrev_b32 v104, 4, v104
v_lshlrev_b32 v105, 4, v105
v_lshlrev_b32 v106, 4, v106
v_lshlrev_b32 v107, 4, v107
ds_write_b128 v2, v[104:107] offset:2048
ds_write_b128 v2, v[4:7] offset:1024
s_cmp_lg_u32 s43, 0
s_cbranch_scc1 k2w0_76
s_mul_i32 s50, s42, 7
s_add_u32 s50, s50, 4
s_lshl_b32 s50, s50, 10
buffer_store_dwordx4 v[100:103], v2, s[32:35], s50 offen
v_and_b32 v111, 1, v96
v_cmp_eq_u32 vcc, 1, v111
v_lshl_add_u32 v110, v96, 3, v104
s_nop 0
v_cndmask_b32 v110, v12, v110, vcc
ds_write_b64 v110, v[4:5] offset:28160
v_and_b32 v111, 1, v97
v_cmp_eq_u32 vcc, 1, v111
v_lshl_add_u32 v110, v97, 3, v105
s_nop 0
v_cndmask_b32 v110, v12, v110, vcc
ds_write_b64 v110, v[4:5] offset:28160
v_and_b32 v111, 1, v98
v_cmp_eq_u32 vcc, 1, v111
v_lshl_add_u32 v110, v98, 3, v106
s_nop 0
v_cndmask_b32 v110, v12, v110, vcc
ds_write_b64 v110, v[4:5] offset:28160
v_and_b32 v111, 1, v99
v_cmp_eq_u32 vcc, 1, v111
v_lshl_add_u32 v110, v99, 3, v107
s_nop 0
v_cndmask_b32 v110, v12, v110, vcc
ds_write_b64 v110, v[4:5] offset:28160
k2w0_76:
s_mul_i32 s50, s42, 7
s_add_u32 s50, s50, 4
s_mul_i32 s51, s50, 133120
s_add_u32 s28, s52, s51
s_addc_u32 s29, s53, 0
s_and_b32 s29, s29, 0xffff
s_lshl_b32 s30, s61, 4
s_add_u32 s30, s30, 127
s_and_b32 s30, s30, 0xffffff80
s_waitcnt lgkmcnt(0)
s_cmp_lt_u32 s64, s46
s_cbranch_scc1 k2ns_77
s_cmp_lg_u32 s65, 0
s_cbranch_scc1 k2ns_77
v_mov_b32 v8, v10
v_mov_b32 v9, v11
s_mov_b32 s46, s47
s_mov_b32 s64, 0
s_mov_b32 s65, 1
s_mov_b32 s66, 0
v_readlane_b32 s67, v8, 0
k2ns_77:
v_mov_b32 v96, s68
s_add_u32 s69, s64, 64
s_cmp_lt_u32 s67, s69
s_cbranch_scc0 gwek2_79
gwk2_78:
v_readlane_b32 s68, v9, s66
s_add_u32 s66, s66, 1
s_sub_u32 s70, s67, s64
s_max_i32 s70, s70, 0
v_readlane_b32 s67, v8, s66
s_lshl_b64 exec, -1, s70
v_mov_b32 v96, s68
s_cmp_lt_u32 s67, s69
s_cbranch_scc1 gwk2_78
s_mov_b64 exec, -1
gwek2_79:
v_add3_u32 v96, v96, s64, v3
s_add_u32 s64, s64, 64
v_mul_u32_u24 v96, 24, v96
buffer_load_dwordx4 v[40:43], v96, s[8:11], 0 offen
buffer_load_dwordx2 v[56:57], v96, s[8:11], 0 offen offset:16
s_cmp_lt_u32 s64, s46
s_cbranch_scc1 k2ns_80
s_cmp_lg_u32 s65, 0
s_cbranch_scc1 k2ns_80
v_mov_b32 v8, v10
v_mov_b32 v9, v11
s_mov_b32 s46, s47
s_mov_b32 s64, 0
s_mov_b32 s65, 1
s_mov_b32 s66, 0
v_readlane_b32 s67, v8, 0
k2ns_80:
v_mov_b32 v98, s68
s_add_u32 s69, s64, 64
s_cmp_lt_u32 s67, s69
s_cbranch_scc0 gwek2_82
gwk2_81:
v_readlane_b32 s68, v9, s66
s_add_u32 s66, s66, 1
s_sub_u32 s70, s67, s64
s_max_i32 s70, s70, 0
v_readlane_b32 s67, v8, s66
s_lshl_b64 exec, -1, s70
v_mov_b32 v98, s68
s_cmp_lt_u32 s67, s69
s_cbranch_scc1 gwk2_81
s_mov_b64 exec, -1
gwek2_82:
v_add3_u32 v98, v98, s64, v3
s_add_u32 s64, s64, 64
v_mul_u32_u24 v98, 24, v98
buffer_load_dwordx4 v[44:47], v98, s[8:11], 0 offen
buffer_load_dwordx2 v[58:59], v98, s[8:11], 0 offen offset:16
s_cmp_lt_u32 s64, s46
s_cbranch_scc1 k2ns_83
s_cmp_lg_u32 s65, 0
s_cbranch_scc1 k2ns_83
v_mov_b32 v8, v10
v_mov_b32 v9, v11
s_mov_b32 s46, s47
s_mov_b32 s64, 0
s_mov_b32 s65, 1
s_mov_b32 s66, 0
v_readlane_b32 s67, v8, 0
k2ns_83:
v_mov_b32 v100, s68
s_add_u32 s69, s64, 64
s_cmp_lt_u32 s67, s69
s_cbranch_scc0 gwek2_85
gwk2_84:
v_readlane_b32 s68, v9, s66
s_add_u32 s66, s66, 1
s_sub_u32 s70, s67, s64
s_max_i32 s70, s70, 0
v_readlane_b32 s67, v8, s66
s_lshl_b64 exec, -1, s70
v_mov_b32 v100, s68
s_cmp_lt_u32 s67, s69
s_cbranch_scc1 gwk2_84
s_mov_b64 exec, -1
gwek2_85:
v_add3_u32 v100, v100, s64, v3
s_add_u32 s64, s64, 64
v_mul_u32_u24 v100, 24, v100
buffer_load_dwordx4 v[48:51], v100, s[8:11], 0 offen
buffer_load_dwordx2 v[60:61], v100, s[8:11], 0 offen offset:16
s_cmp_lt_u32 s64, s46
s_cbranch_scc1 k2ns_86
s_cmp_lg_u32 s65, 0
s_cbranch_scc1 k2ns_86
v_mov_b32 v8, v10
v_mov_b32 v9, v11
s_mov_b32 s46, s47
s_mov_b32 s64, 0
s_mov_b32 s65, 1
s_mov_b32 s66, 0
v_readlane_b32 s67, v8, 0
k2ns_86:
v_mov_b32 v102, s68
s_add_u32 s69, s64, 64
s_cmp_lt_u32 s67, s69
s_cbranch_scc0 gwek2_88
gwk2_87:
v_readlane_b32 s68, v9, s66
s_add_u32 s66, s66, 1
s_sub_u32 s70, s67, s64
s_max_i32 s70, s70, 0
v_readlane_b32 s67, v8, s66
s_lshl_b64 exec, -1, s70
v_mov_b32 v102, s68
s_cmp_lt_u32 s67, s69
s_cbranch_scc1 gwk2_87
s_mov_b64 exec, -1
gwek2_88:
v_add3_u32 v102, v102, s64, v3
s_add_u32 s64, s64, 64
v_mul_u32_u24 v102, 24, v102
buffer_load_dwordx4 v[52:55], v102, s[8:11], 0 offen
buffer_load_dwordx2 v[62:63], v102, s[8:11], 0 offen offset:16
v_and_b32 v96, 0x3ffff, v16
ds_read_b32 v96, v96 offset:2048
v_and_b32 v97, 0x3ffff, v17
ds_read_b32 v97, v97 offset:2048
v_and_b32 v98, 0x3ffff, v18
ds_read_b32 v98, v98 offset:2048
v_and_b32 v99, 0x3ffff, v19
ds_read_b32 v99, v99 offset:2048
v_and_b32 v100, 0x3ffff, v20
ds_read_b32 v100, v100 offset:2048
v_and_b32 v101, 0x3ffff, v21
ds_read_b32 v101, v101 offset:2048
v_and_b32 v102, 0x3ffff, v22
ds_read_b32 v102, v102 offset:2048
v_and_b32 v103, 0x3ffff, v23
ds_read_b32 v103, v103 offset:2048
s_waitcnt lgkmcnt(0)
v_lshrrev_b32 v104, 18, v16
v_lshl_add_u32 v96, v104, 3, v96
v_and_or_b32 v96, v16, s73, v96
ds_write_b64 v96, v[64:65] offset:28160
v_lshrrev_b32 v104, 18, v17
v_lshl_add_u32 v97, v104, 3, v97
v_and_or_b32 v97, v17, s73, v97
ds_write_b64 v97, v[66:67] offset:28160
v_lshrrev_b32 v104, 18, v18
v_lshl_add_u32 v98, v104, 3, v98
v_and_or_b32 v98, v18, s73, v98
ds_write_b64 v98, v[68:69] offset:28160
v_lshrrev_b32 v104, 18, v19
v_lshl_add_u32 v99, v104, 3, v99
v_and_or_b32 v99, v19, s73, v99
ds_write_b64 v99, v[70:71] offset:28160
v_lshrrev_b32 v104, 18, v20
v_lshl_add_u32 v100, v104, 3, v100
v_and_or_b32 v100, v20, s73, v100
ds_write_b64 v100, v[72:73] offset:28160
v_lshrrev_b32 v104, 18, v21
v_lshl_add_u32 v101, v104, 3, v101
v_and_or_b32 v101, v21, s73, v101
ds_write_b64 v101, v[74:75] offset:28160
v_lshrrev_b32 v104, 18, v22
v_lshl_add_u32 v102, v104, 3, v102
v_and_or_b32 v102, v22, s73, v102
ds_write_b64 v102, v[76:77] offset:28160
v_lshrrev_b32 v104, 18, v23
v_lshl_add_u32 v103, v104, 3, v103
v_and_or_b32 v103, v23, s73, v103
ds_write_b64 v103, v[78:79] offset:28160
v_and_b32 v96, 0x3ffff, v24
ds_read_b32 v96, v96 offset:2048
v_and_b32 v97, 0x3ffff, v25
ds_read_b32 v97, v97 offset:2048
v_and_b32 v98, 0x3ffff, v26
ds_read_b32 v98, v98 offset:2048
v_and_b32 v99, 0x3ffff, v27
ds_read_b32 v99, v99 offset:2048
v_and_b32 v100, 0x3ffff, v28
ds_read_b32 v100, v100 offset:2048
v_and_b32 v101, 0x3ffff, v29
ds_read_b32 v101, v101 offset:2048
v_and_b32 v102, 0x3ffff, v30
ds_read_b32 v102, v102 offset:2048
v_and_b32 v103, 0x3ffff, v31
ds_read_b32 v103, v103 offset:2048
s_waitcnt lgkmcnt(0)
v_lshrrev_b32 v104, 18, v24
v_lshl_add_u32 v96, v104, 3, v96
v_and_or_b32 v96, v24, s73, v96
ds_write_b64 v96, v[80:81] offset:28160
v_lshrrev_b32 v104, 18, v25
v_lshl_add_u32 v97, v104, 3, v97
v_and_or_b32 v97, v25, s73, v97
ds_write_b64 v97, v[82:83] offset:28160
v_lshrrev_b32 v104, 18, v26
v_lshl_add_u32 v98, v104, 3, v98
v_and_or_b32 v98, v26, s73, v98
ds_write_b64 v98, v[84:85] offset:28160
v_lshrrev_b32 v104, 18, v27
v_lshl_add_u32 v99, v104, 3, v99
v_and_or_b32 v99, v27, s73, v99
ds_write_b64 v99, v[86:87] offset:28160
v_lshrrev_b32 v104, 18, v28
v_lshl_add_u32 v100, v104, 3, v100
v_and_or_b32 v100, v28, s73, v100
ds_write_b64 v100, v[88:89] offset:28160
v_lshrrev_b32 v104, 18, v29
v_lshl_add_u32 v101, v104, 3, v101
v_and_or_b32 v101, v29, s73, v101
ds_write_b64 v101, v[90:91] offset:28160
v_lshrrev_b32 v104, 18, v30
v_lshl_add_u32 v102, v104, 3, v102
v_and_or_b32 v102, v30, s73, v102
ds_write_b64 v102, v[92:93] offset:28160
v_lshrrev_b32 v104, 18, v31
v_lshl_add_u32 v103, v104, 3, v103
v_and_or_b32 v103, v31, s73, v103
ds_write_b64 v103, v[94:95] offset:28160
s_waitcnt lgkmcnt(0)
s_barrier
v_add_u32 v96, 0, v1
ds_read_b128 v[64:67], v96 offset:28160
v_add_u32 v97, 16384, v1
ds_read_b128 v[68:71], v97 offset:28160
v_add_u32 v98, 32768, v1
ds_read_b128 v[72:75], v98 offset:28160
v_add_u32 v99, 49152, v1
ds_read_b128 v[76:79], v99 offset:28160
v_add_u32 v100, 65536, v1
ds_read_b128 v[80:83], v100 offset:28160
v_add_u32 v101, 81920, v1
ds_read_b128 v[84:87], v101 offset:28160
v_add_u32 v102, 98304, v1
ds_read_b128 v[88:91], v102 offset:28160
v_add_u32 v103, 114688, v1
ds_read_b128 v[92:95], v103 offset:28160
v_add_u32 v104, 131072, v1
ds_read_b128 v[112:115], v104 offset:28160
s_waitcnt lgkmcnt(8)
buffer_store_dwordx4 v[64:67], v96, s[28:31], 0 offen nt
s_waitcnt lgkmcnt(7)
buffer_store_dwordx4 v[68:71], v97, s[28:31], 0 offen nt
s_waitcnt lgkmcnt(6)
buffer_store_dwordx4 v[72:75], v98, s[28:31], 0 offen nt
s_waitcnt lgkmcnt(5)
buffer_store_dwordx4 v[76:79], v99, s[28:31], 0 offen nt
s_waitcnt lgkmcnt(4)
buffer_store_dwordx4 v[80:83], v100, s[28:31], 0 offen nt
s_waitcnt lgkmcnt(3)
buffer_store_dwordx4 v[84:87], v101, s[28:31], 0 offen nt
s_waitcnt lgkmcnt(2)
buffer_store_dwordx4 v[88:91], v102, s[28:31], 0 offen nt
s_waitcnt lgkmcnt(1)
buffer_store_dwordx4 v[92:95], v103, s[28:31], 0 offen nt
s_waitcnt lgkmcnt(0)
buffer_store_dwordx4 v[112:115], v104, s[28:31], 0 offen nt
s_waitcnt vmcnt(9)
s_nop 0
v_lshlrev_b32 v112, 3, v40
v_and_b32 v112, 0x7ff8, v112
ds_read_b64 v[64:65], v112 offset:3072
v_lshlrev_b32 v112, 3, v41
v_and_b32 v112, 0x7ff8, v112
ds_read_b64 v[66:67], v112 offset:3072
v_lshlrev_b32 v112, 3, v42
v_and_b32 v112, 0x7ff8, v112
ds_read_b64 v[68:69], v112 offset:3072
v_lshlrev_b32 v112, 3, v43
v_and_b32 v112, 0x7ff8, v112
ds_read_b64 v[70:71], v112 offset:3072
v_cmp_ne_u16 vcc, 0, v56
v_lshrrev_b32 v96, 14, v40
v_and_b32 v96, 0x3fc, v96
v_cndmask_b32 v96, v12, v96, vcc
ds_add_rtn_u32 v100, v96, v14 offset:1024
v_cmp_lt_u32 vcc, 0xffff, v56
v_lshrrev_b32 v97, 14, v41
v_and_b32 v97, 0x3fc, v97
v_cndmask_b32 v97, v12, v97, vcc
ds_add_rtn_u32 v101, v97, v14 offset:1024
v_cmp_ne_u16 vcc, 0, v57
v_lshrrev_b32 v98, 14, v42
v_and_b32 v98, 0x3fc, v98
v_cndmask_b32 v98, v12, v98, vcc
ds_add_rtn_u32 v102, v98, v14 offset:1024
v_cmp_lt_u32 vcc, 0xffff, v57
v_lshrrev_b32 v99, 14, v43
v_and_b32 v99, 0x3fc, v99
v_cndmask_b32 v99, v12, v99, vcc
ds_add_rtn_u32 v103, v99, v14 offset:1024
v_lshlrev_b32 v112, 3, v44
v_and_b32 v112, 0x7ff8, v112
ds_read_b64 v[72:73], v112 offset:3072
v_lshlrev_b32 v112, 3, v45
v_and_b32 v112, 0x7ff8, v112
ds_read_b64 v[74:75], v112 offset:3072
v_lshlrev_b32 v112, 3, v46
v_and_b32 v112, 0x7ff8, v112
ds_read_b64 v[76:77], v112 offset:3072
v_lshlrev_b32 v112, 3, v47
v_and_b32 v112, 0x7ff8, v112
ds_read_b64 v[78:79], v112 offset:3072
v_cmp_ne_u16 vcc, 0, v58
v_lshrrev_b32 v104, 14, v44
v_and_b32 v104, 0x3fc, v104
v_cndmask_b32 v104, v12, v104, vcc
ds_add_rtn_u32 v108, v104, v14 offset:1024
v_cmp_lt_u32 vcc, 0xffff, v58
v_lshrrev_b32 v105, 14, v45
v_and_b32 v105, 0x3fc, v105
v_cndmask_b32 v105, v12, v105, vcc
ds_add_rtn_u32 v109, v105, v14 offset:1024
v_cmp_ne_u16 vcc, 0, v59
v_lshrrev_b32 v106, 14, v46
v_and_b32 v106, 0x3fc, v106
v_cndmask_b32 v106, v12, v106, vcc
ds_add_rtn_u32 v110, v106, v14 offset:1024
v_cmp_lt_u32 vcc, 0xffff, v59
v_lshrrev_b32 v107, 14, v47
v_and_b32 v107, 0x3fc, v107
v_cndmask_b32 v107, v12, v107, vcc
ds_add_rtn_u32 v111, v107, v14 offset:1024
s_waitcnt lgkmcnt(12)
v_pk_mul_f16 v64, v64, v56 op_sel:[0,0] op_sel_hi:[1,0]
v_pk_mul_f16 v65, v65, v56 op_sel:[0,0] op_sel_hi:[1,0]
v_lshrrev_b32 v113, 20, v40
v_lshrrev_b32 v114, 12, v40
v_bfi_b32 v113, 15, v114, v113
v_add_u32 v64, 0x00040004, v64
v_add_u32 v65, 0x00040004, v65
v_lshl_or_b32 v114, v113, 13, v113
v_lshrrev_b32 v115, 6, v113
v_bfi_b32 v64, s72, v114, v64
v_lshl_or_b32 v115, v115, 13, v115
v_bfi_b32 v65, s72, v115, v65
v_pk_mul_f16 v66, v66, v56 op_sel:[0,1] op_sel_hi:[1,1]
v_pk_mul_f16 v67, v67, v56 op_sel:[0,1] op_sel_hi:[1,1]
v_lshrrev_b32 v113, 20, v41
v_lshrrev_b32 v114, 12, v41
v_bfi_b32 v113, 15, v114, v113
v_add_u32 v66, 0x00040004, v66
v_add_u32 v67, 0x00040004, v67
v_lshl_or_b32 v114, v113, 13, v113
v_lshrrev_b32 v115, 6, v113
v_bfi_b32 v66, s72, v114, v66
v_lshl_or_b32 v115, v115, 13, v115
v_bfi_b32 v67, s72, v115, v67
v_pk_mul_f16 v68, v68, v57 op_sel:[0,0] op_sel_hi:[1,0]
v_pk_mul_f16 v69, v69, v57 op_sel:[0,0] op_sel_hi:[1,0]
v_lshrrev_b32 v113, 20, v42
v_lshrrev_b32 v114, 12, v42
v_bfi_b32 v113, 15, v114, v113
v_add_u32 v68, 0x00040004, v68
v_add_u32 v69, 0x00040004, v69
v_lshl_or_b32 v114, v113, 13, v113
v_lshrrev_b32 v115, 6, v113
v_bfi_b32 v68, s72, v114, v68
v_lshl_or_b32 v115, v115, 13, v115
v_bfi_b32 v69, s72, v115, v69
v_pk_mul_f16 v70, v70, v57 op_sel:[0,1] op_sel_hi:[1,1]
v_pk_mul_f16 v71, v71, v57 op_sel:[0,1] op_sel_hi:[1,1]
v_lshrrev_b32 v113, 20, v43
v_lshrrev_b32 v114, 12, v43
v_bfi_b32 v113, 15, v114, v113
v_add_u32 v70, 0x00040004, v70
v_add_u32 v71, 0x00040004, v71
v_lshl_or_b32 v114, v113, 13, v113
v_lshrrev_b32 v115, 6, v113
v_bfi_b32 v70, s72, v114, v70
v_lshl_or_b32 v115, v115, 13, v115
v_bfi_b32 v71, s72, v115, v71
s_waitcnt lgkmcnt(8)
v_lshl_or_b32 v40, v100, 18, v96
v_lshl_or_b32 v41, v101, 18, v97
v_lshl_or_b32 v42, v102, 18, v98
v_lshl_or_b32 v43, v103, 18, v99
v_lshlrev_b32 v112, 3, v48
v_and_b32 v112, 0x7ff8, v112
ds_read_b64 v[80:81], v112 offset:3072
v_lshlrev_b32 v112, 3, v49
v_and_b32 v112, 0x7ff8, v112
ds_read_b64 v[82:83], v112 offset:3072
v_lshlrev_b32 v112, 3, v50
v_and_b32 v112, 0x7ff8, v112
ds_read_b64 v[84:85], v112 offset:3072
v_lshlrev_b32 v112, 3, v51
v_and_b32 v112, 0x7ff8, v112
ds_read_b64 v[86:87], v112 offset:3072
v_cmp_ne_u16 vcc, 0, v60
v_lshrrev_b32 v96, 14, v48
v_and_b32 v96, 0x3fc, v96
v_cndmask_b32 v96, v12, v96, vcc
ds_add_rtn_u32 v100, v96, v14 offset:1024
v_cmp_lt_u32 vcc, 0xffff, v60
v_lshrrev_b32 v97, 14, v49
v_and_b32 v97, 0x3fc, v97
v_cndmask_b32 v97, v12, v97, vcc
ds_add_rtn_u32 v101, v97, v14 offset:1024
v_cmp_ne_u16 vcc, 0, v61
v_lshrrev_b32 v98, 14, v50
v_and_b32 v98, 0x3fc, v98
v_cndmask_b32 v98, v12, v98, vcc
ds_add_rtn_u32 v102, v98, v14 offset:1024
v_cmp_lt_u32 vcc, 0xffff, v61
v_lshrrev_b32 v99, 14, v51
v_and_b32 v99, 0x3fc, v99
v_cndmask_b32 v99, v12, v99, vcc
ds_add_rtn_u32 v103, v99, v14 offset:1024
s_waitcnt lgkmcnt(12)
v_pk_mul_f16 v72, v72, v58 op_sel:[0,0] op_sel_hi:[1,0]
v_pk_mul_f16 v73, v73, v58 op_sel:[0,0] op_sel_hi:[1,0]
v_lshrrev_b32 v113, 20, v44
v_lshrrev_b32 v114, 12, v44
v_bfi_b32 v113, 15, v114, v113
v_add_u32 v72, 0x00040004, v72
v_add_u32 v73, 0x00040004, v73
v_lshl_or_b32 v114, v113, 13, v113
v_lshrrev_b32 v115, 6, v113
v_bfi_b32 v72, s72, v114, v72
v_lshl_or_b32 v115, v115, 13, v115
v_bfi_b32 v73, s72, v115, v73
v_pk_mul_f16 v74, v74, v58 op_sel:[0,1] op_sel_hi:[1,1]
v_pk_mul_f16 v75, v75, v58 op_sel:[0,1] op_sel_hi:[1,1]
v_lshrrev_b32 v113, 20, v45
v_lshrrev_b32 v114, 12, v45
v_bfi_b32 v113, 15, v114, v113
v_add_u32 v74, 0x00040004, v74
v_add_u32 v75, 0x00040004, v75
v_lshl_or_b32 v114, v113, 13, v113
v_lshrrev_b32 v115, 6, v113
v_bfi_b32 v74, s72, v114, v74
v_lshl_or_b32 v115, v115, 13, v115
v_bfi_b32 v75, s72, v115, v75
v_pk_mul_f16 v76, v76, v59 op_sel:[0,0] op_sel_hi:[1,0]
v_pk_mul_f16 v77, v77, v59 op_sel:[0,0] op_sel_hi:[1,0]
v_lshrrev_b32 v113, 20, v46
v_lshrrev_b32 v114, 12, v46
v_bfi_b32 v113, 15, v114, v113
v_add_u32 v76, 0x00040004, v76
v_add_u32 v77, 0x00040004, v77
v_lshl_or_b32 v114, v113, 13, v113
v_lshrrev_b32 v115, 6, v113
v_bfi_b32 v76, s72, v114, v76
v_lshl_or_b32 v115, v115, 13, v115
v_bfi_b32 v77, s72, v115, v77
v_pk_mul_f16 v78, v78, v59 op_sel:[0,1] op_sel_hi:[1,1]
v_pk_mul_f16 v79, v79, v59 op_sel:[0,1] op_sel_hi:[1,1]
v_lshrrev_b32 v113, 20, v47
v_lshrrev_b32 v114, 12, v47
v_bfi_b32 v113, 15, v114, v113
v_add_u32 v78, 0x00040004, v78
v_add_u32 v79, 0x00040004, v79
v_lshl_or_b32 v114, v113, 13, v113
v_lshrrev_b32 v115, 6, v113
v_bfi_b32 v78, s72, v114, v78
v_lshl_or_b32 v115, v115, 13, v115
v_bfi_b32 v79, s72, v115, v79
s_waitcnt lgkmcnt(8)
v_lshl_or_b32 v44, v108, 18, v104
v_lshl_or_b32 v45, v109, 18, v105
v_lshl_or_b32 v46, v110, 18, v106
v_lshl_or_b32 v47, v111, 18, v107
v_lshlrev_b32 v112, 3, v52
v_and_b32 v112, 0x7ff8, v112
ds_read_b64 v[88:89], v112 offset:3072
v_lshlrev_b32 v112, 3, v53
v_and_b32 v112, 0x7ff8, v112
ds_read_b64 v[90:91], v112 offset:3072
v_lshlrev_b32 v112, 3, v54
v_and_b32 v112, 0x7ff8, v112
ds_read_b64 v[92:93], v112 offset:3072
v_lshlrev_b32 v112, 3, v55
v_and_b32 v112, 0x7ff8, v112
ds_read_b64 v[94:95], v112 offset:3072
v_cmp_ne_u16 vcc, 0, v62
v_lshrrev_b32 v104, 14, v52
v_and_b32 v104, 0x3fc, v104
v_cndmask_b32 v104, v12, v104, vcc
ds_add_rtn_u32 v108, v104, v14 offset:1024
v_cmp_lt_u32 vcc, 0xffff, v62
v_lshrrev_b32 v105, 14, v53
v_and_b32 v105, 0x3fc, v105
v_cndmask_b32 v105, v12, v105, vcc
ds_add_rtn_u32 v109, v105, v14 offset:1024
v_cmp_ne_u16 vcc, 0, v63
v_lshrrev_b32 v106, 14, v54
v_and_b32 v106, 0x3fc, v106
v_cndmask_b32 v106, v12, v106, vcc
ds_add_rtn_u32 v110, v106, v14 offset:1024
v_cmp_lt_u32 vcc, 0xffff, v63
v_lshrrev_b32 v107, 14, v55
v_and_b32 v107, 0x3fc, v107
v_cndmask_b32 v107, v12, v107, vcc
ds_add_rtn_u32 v111, v107, v14 offset:1024
s_waitcnt lgkmcnt(12)
v_pk_mul_f16 v80, v80, v60 op_sel:[0,0] op_sel_hi:[1,0]
v_pk_mul_f16 v81, v81, v60 op_sel:[0,0] op_sel_hi:[1,0]
v_lshrrev_b32 v113, 20, v48
v_lshrrev_b32 v114, 12, v48
v_bfi_b32 v113, 15, v114, v113
v_add_u32 v80, 0x00040004, v80
v_add_u32 v81, 0x00040004, v81
v_lshl_or_b32 v114, v113, 13, v113
v_lshrrev_b32 v115, 6, v113
v_bfi_b32 v80, s72, v114, v80
v_lshl_or_b32 v115, v115, 13, v115
v_bfi_b32 v81, s72, v115, v81
v_pk_mul_f16 v82, v82, v60 op_sel:[0,1] op_sel_hi:[1,1]
v_pk_mul_f16 v83, v83, v60 op_sel:[0,1] op_sel_hi:[1,1]
v_lshrrev_b32 v113, 20, v49
v_lshrrev_b32 v114, 12, v49
v_bfi_b32 v113, 15, v114, v113
v_add_u32 v82, 0x00040004, v82
v_add_u32 v83, 0x00040004, v83
v_lshl_or_b32 v114, v113, 13, v113
v_lshrrev_b32 v115, 6, v113
v_bfi_b32 v82, s72, v114, v82
v_lshl_or_b32 v115, v115, 13, v115
v_bfi_b32 v83, s72, v115, v83
v_pk_mul_f16 v84, v84, v61 op_sel:[0,0] op_sel_hi:[1,0]
v_pk_mul_f16 v85, v85, v61 op_sel:[0,0] op_sel_hi:[1,0]
v_lshrrev_b32 v113, 20, v50
v_lshrrev_b32 v114, 12, v50
v_bfi_b32 v113, 15, v114, v113
v_add_u32 v84, 0x00040004, v84
v_add_u32 v85, 0x00040004, v85
v_lshl_or_b32 v114, v113, 13, v113
v_lshrrev_b32 v115, 6, v113
v_bfi_b32 v84, s72, v114, v84
v_lshl_or_b32 v115, v115, 13, v115
v_bfi_b32 v85, s72, v115, v85
v_pk_mul_f16 v86, v86, v61 op_sel:[0,1] op_sel_hi:[1,1]
v_pk_mul_f16 v87, v87, v61 op_sel:[0,1] op_sel_hi:[1,1]
v_lshrrev_b32 v113, 20, v51
v_lshrrev_b32 v114, 12, v51
v_bfi_b32 v113, 15, v114, v113
v_add_u32 v86, 0x00040004, v86
v_add_u32 v87, 0x00040004, v87
v_lshl_or_b32 v114, v113, 13, v113
v_lshrrev_b32 v115, 6, v113
v_bfi_b32 v86, s72, v114, v86
v_lshl_or_b32 v115, v115, 13, v115
v_bfi_b32 v87, s72, v115, v87
s_waitcnt lgkmcnt(8)
v_lshl_or_b32 v48, v100, 18, v96
v_lshl_or_b32 v49, v101, 18, v97
v_lshl_or_b32 v50, v102, 18, v98
v_lshl_or_b32 v51, v103, 18, v99
s_waitcnt lgkmcnt(4)
v_pk_mul_f16 v88, v88, v62 op_sel:[0,0] op_sel_hi:[1,0]
v_pk_mul_f16 v89, v89, v62 op_sel:[0,0] op_sel_hi:[1,0]
v_lshrrev_b32 v113, 20, v52
v_lshrrev_b32 v114, 12, v52
v_bfi_b32 v113, 15, v114, v113
v_add_u32 v88, 0x00040004, v88
v_add_u32 v89, 0x00040004, v89
v_lshl_or_b32 v114, v113, 13, v113
v_lshrrev_b32 v115, 6, v113
v_bfi_b32 v88, s72, v114, v88
v_lshl_or_b32 v115, v115, 13, v115
v_bfi_b32 v89, s72, v115, v89
v_pk_mul_f16 v90, v90, v62 op_sel:[0,1] op_sel_hi:[1,1]
v_pk_mul_f16 v91, v91, v62 op_sel:[0,1] op_sel_hi:[1,1]
v_lshrrev_b32 v113, 20, v53
v_lshrrev_b32 v114, 12, v53
v_bfi_b32 v113, 15, v114, v113
v_add_u32 v90, 0x00040004, v90
v_add_u32 v91, 0x00040004, v91
v_lshl_or_b32 v114, v113, 13, v113
v_lshrrev_b32 v115, 6, v113
v_bfi_b32 v90, s72, v114, v90
v_lshl_or_b32 v115, v115, 13, v115
v_bfi_b32 v91, s72, v115, v91
v_pk_mul_f16 v92, v92, v63 op_sel:[0,0] op_sel_hi:[1,0]
v_pk_mul_f16 v93, v93, v63 op_sel:[0,0] op_sel_hi:[1,0]
v_lshrrev_b32 v113, 20, v54
v_lshrrev_b32 v114, 12, v54
v_bfi_b32 v113, 15, v114, v113
v_add_u32 v92, 0x00040004, v92
v_add_u32 v93, 0x00040004, v93
v_lshl_or_b32 v114, v113, 13, v113
v_lshrrev_b32 v115, 6, v113
v_bfi_b32 v92, s72, v114, v92
v_lshl_or_b32 v115, v115, 13, v115
v_bfi_b32 v93, s72, v115, v93
v_pk_mul_f16 v94, v94, v63 op_sel:[0,1] op_sel_hi:[1,1]
v_pk_mul_f16 v95, v95, v63 op_sel:[0,1] op_sel_hi:[1,1]
v_lshrrev_b32 v113, 20, v55
v_lshrrev_b32 v114, 12, v55
v_bfi_b32 v113, 15, v114, v113
v_add_u32 v94, 0x00040004, v94
v_add_u32 v95, 0x00040004, v95
v_lshl_or_b32 v114, v113, 13, v113
v_lshrrev_b32 v115, 6, v113
v_bfi_b32 v94, s72, v114, v94
v_lshl_or_b32 v115, v115, 13, v115
v_bfi_b32 v95, s72, v115, v95
s_waitcnt lgkmcnt(0)
v_lshl_or_b32 v52, v108, 18, v104
v_lshl_or_b32 v53, v109, 18, v105
v_lshl_or_b32 v54, v110, 18, v106
v_lshl_or_b32 v55, v111, 18, v107
s_barrier
ds_read_b128 v[96:99], v2 offset:1024
s_waitcnt lgkmcnt(0)
v_add_u32 v100, 1, v96
v_lshrrev_b32 v100, 1, v100
v_add_u32 v101, 1, v97
v_lshrrev_b32 v101, 1, v101
v_add_u32 v102, 1, v98
v_lshrrev_b32 v102, 1, v102
v_add_u32 v103, 1, v99
v_lshrrev_b32 v103, 1, v103
v_add_u32 v106, v100, v101
v_add_u32 v107, v106, v102
v_add_u32 v108, v107, v103
v_mov_b32 v109, v108
s_nop 1
v_add_u32_dpp v109, v109, v109 row_shr:1 row_mask:0xf bank_mask:0xf bound_ctrl:0
s_nop 1
v_add_u32_dpp v109, v109, v109 row_shr:2 row_mask:0xf bank_mask:0xf bound_ctrl:0
s_nop 1
v_add_u32_dpp v109, v109, v109 row_shr:4 row_mask:0xf bank_mask:0xf bound_ctrl:0
s_nop 1
v_add_u32_dpp v109, v109, v109 row_shr:8 row_mask:0xf bank_mask:0xf bound_ctrl:0
s_nop 1
v_add_u32_dpp v109, v109, v109 row_bcast:15 row_mask:0xa bank_mask:0xf
s_nop 1
v_add_u32_dpp v109, v109, v109 row_bcast:31 row_mask:0xc bank_mask:0xf
v_sub_u32 v104, v109, v108
v_add_u32 v105, v104, v100
v_add_u32 v106, v104, v106
v_add_u32 v107, v104, v107
v_readlane_b32 s61, v109, 63
v_lshl_or_b32 v100, v100, 16, v104
v_lshl_or_b32 v101, v101, 16, v105
v_lshl_or_b32 v102, v102, 16, v106
v_lshl_or_b32 v103, v103, 16, v107
v_lshlrev_b32 v104, 4, v104
v_lshlrev_b32 v105, 4, v105
v_lshlrev_b32 v106, 4, v106
v_lshlrev_b32 v107, 4, v107
ds_write_b128 v2, v[104:107] offset:2048
ds_write_b128 v2, v[4:7] offset:0
s_cmp_lg_u32 s43, 0
s_cbranch_scc1 k2w0_89
s_mul_i32 s50, s42, 7
s_add_u32 s50, s50, 5
s_lshl_b32 s50, s50, 10
buffer_store_dwordx4 v[100:103], v2, s[32:35], s50 offen
v_and_b32 v111, 1, v96
v_cmp_eq_u32 vcc, 1, v111
v_lshl_add_u32 v110, v96, 3, v104
s_nop 0
v_cndmask_b32 v110, v12, v110, vcc
ds_write_b64 v110, v[4:5] offset:28160
v_and_b32 v111, 1, v97
v_cmp_eq_u32 vcc, 1, v111
v_lshl_add_u32 v110, v97, 3, v105
s_nop 0
v_cndmask_b32 v110, v12, v110, vcc
ds_write_b64 v110, v[4:5] offset:28160
v_and_b32 v111, 1, v98
v_cmp_eq_u32 vcc, 1, v111
v_lshl_add_u32 v110, v98, 3, v106
s_nop 0
v_cndmask_b32 v110, v12, v110, vcc
ds_write_b64 v110, v[4:5] offset:28160
v_and_b32 v111, 1, v99
v_cmp_eq_u32 vcc, 1, v111
v_lshl_add_u32 v110, v99, 3, v107
s_nop 0
v_cndmask_b32 v110, v12, v110, vcc
ds_write_b64 v110, v[4:5] offset:28160
k2w0_89:
s_mul_i32 s50, s42, 7
s_add_u32 s50, s50, 5
s_mul_i32 s51, s50, 133120
s_add_u32 s28, s52, s51
s_addc_u32 s29, s53, 0
s_and_b32 s29, s29, 0xffff
s_lshl_b32 s30, s61, 4
s_add_u32 s30, s30, 127
s_and_b32 s30, s30, 0xffffff80
s_waitcnt lgkmcnt(0)
s_cmp_lt_u32 s64, s46
s_cbranch_scc1 k2ns_90
s_cmp_lg_u32 s65, 0
s_cbranch_scc1 k2ns_90
v_mov_b32 v8, v10
v_mov_b32 v9, v11
s_mov_b32 s46, s47
s_mov_b32 s64, 0
s_mov_b32 s65, 1
s_mov_b32 s66, 0
v_readlane_b32 s67, v8, 0
k2ns_90:
v_mov_b32 v96, s68
s_add_u32 s69, s64, 64
s_cmp_lt_u32 s67, s69
s_cbranch_scc0 gwek2_92
gwk2_91:
v_readlane_b32 s68, v9, s66
s_add_u32 s66, s66, 1
s_sub_u32 s70, s67, s64
s_max_i32 s70, s70, 0
v_readlane_b32 s67, v8, s66
s_lshl_b64 exec, -1, s70
v_mov_b32 v96, s68
s_cmp_lt_u32 s67, s69
s_cbranch_scc1 gwk2_91
s_mov_b64 exec, -1
gwek2_92:
v_add3_u32 v96, v96, s64, v3
s_add_u32 s64, s64, 64
v_mul_u32_u24 v96, 24, v96
buffer_load_dwordx4 v[16:19], v96, s[8:11], 0 offen
buffer_load_dwordx2 v[32:33], v96, s[8:11], 0 offen offset:16
s_cmp_lt_u32 s64, s46
s_cbranch_scc1 k2ns_93
s_cmp_lg_u32 s65, 0
s_cbranch_scc1 k2ns_93
v_mov_b32 v8, v10
v_mov_b32 v9, v11
s_mov_b32 s46, s47
s_mov_b32 s64, 0
s_mov_b32 s65, 1
s_mov_b32 s66, 0
v_readlane_b32 s67, v8, 0
k2ns_93:
v_mov_b32 v98, s68
s_add_u32 s69, s64, 64
s_cmp_lt_u32 s67, s69
s_cbranch_scc0 gwek2_95
gwk2_94:
v_readlane_b32 s68, v9, s66
s_add_u32 s66, s66, 1
s_sub_u32 s70, s67, s64
s_max_i32 s70, s70, 0
v_readlane_b32 s67, v8, s66
s_lshl_b64 exec, -1, s70
v_mov_b32 v98, s68
s_cmp_lt_u32 s67, s69
s_cbranch_scc1 gwk2_94
s_mov_b64 exec, -1
gwek2_95:
v_add3_u32 v98, v98, s64, v3
s_add_u32 s64, s64, 64
v_mul_u32_u24 v98, 24, v98
buffer_load_dwordx4 v[20:23], v98, s[8:11], 0 offen
buffer_load_dwordx2 v[34:35], v98, s[8:11], 0 offen offset:16
s_cmp_lt_u32 s64, s46
s_cbranch_scc1 k2ns_96
s_cmp_lg_u32 s65, 0
s_cbranch_scc1 k2ns_96
v_mov_b32 v8, v10
v_mov_b32 v9, v11
s_mov_b32 s46, s47
s_mov_b32 s64, 0
s_mov_b32 s65, 1
s_mov_b32 s66, 0
v_readlane_b32 s67, v8, 0
k2ns_96:
v_mov_b32 v100, s68
s_add_u32 s69, s64, 64
s_cmp_lt_u32 s67, s69
s_cbranch_scc0 gwek2_98
gwk2_97:
v_readlane_b32 s68, v9, s66
s_add_u32 s66, s66, 1
s_sub_u32 s70, s67, s64
s_max_i32 s70, s70, 0
v_readlane_b32 s67, v8, s66
s_lshl_b64 exec, -1, s70
v_mov_b32 v100, s68
s_cmp_lt_u32 s67, s69
s_cbranch_scc1 gwk2_97
s_mov_b64 exec, -1
gwek2_98:
v_add3_u32 v100, v100, s64, v3
s_add_u32 s64, s64, 64
v_mul_u32_u24 v100, 24, v100
buffer_load_dwordx4 v[24:27], v100, s[8:11], 0 offen
buffer_load_dwordx2 v[36:37], v100, s[8:11], 0 offen offset:16
s_cmp_lt_u32 s64, s46
s_cbranch_scc1 k2ns_99
s_cmp_lg_u32 s65, 0
s_cbranch_scc1 k2ns_99
v_mov_b32 v8, v10
v_mov_b32 v9, v11
s_mov_b32 s46, s47
s_mov_b32 s64, 0
s_mov_b32 s65, 1
s_mov_b32 s66, 0
v_readlane_b32 s67, v8, 0
k2ns_99:
v_mov_b32 v102, s68
s_add_u32 s69, s64, 64
s_cmp_lt_u32 s67, s69
s_cbranch_scc0 gwek2_101
gwk2_100:
v_readlane_b32 s68, v9, s66
s_add_u32 s66, s66, 1
s_sub_u32 s70, s67, s64
s_max_i32 s70, s70, 0
v_readlane_b32 s67, v8, s66
s_lshl_b64 exec, -1, s70
v_mov_b32 v102, s68
s_cmp_lt_u32 s67, s69
s_cbranch_scc1 gwk2_100
s_mov_b64 exec, -1
gwek2_101:
v_add3_u32 v102, v102, s64, v3
s_add_u32 s64, s64, 64
v_mul_u32_u24 v102, 24, v102
buffer_load_dwordx4 v[28:31], v102, s[8:11], 0 offen
buffer_load_dwordx2 v[38:39], v102, s[8:11], 0 offen offset:16
v_and_b32 v96, 0x3ffff, v40
ds_read_b32 v96, v96 offset:2048
v_and_b32 v97, 0x3ffff, v41
ds_read_b32 v97, v97 offset:2048
v_and_b32 v98, 0x3ffff, v42
ds_read_b32 v98, v98 offset:2048
v_and_b32 v99, 0x3ffff, v43
ds_read_b32 v99, v99 offset:2048
v_and_b32 v100, 0x3ffff, v44
ds_read_b32 v100, v100 offset:2048
v_and_b32 v101, 0x3ffff, v45
ds_read_b32 v101, v101 offset:2048
v_and_b32 v102, 0x3ffff, v46
ds_read_b32 v102, v102 offset:2048
v_and_b32 v103, 0x3ffff, v47
ds_read_b32 v103, v103 offset:2048
s_waitcnt lgkmcnt(0)
v_lshrrev_b32 v104, 18, v40
v_lshl_add_u32 v96, v104, 3, v96
v_and_or_b32 v96, v40, s73, v96
ds_write_b64 v96, v[64:65] offset:28160
v_lshrrev_b32 v104, 18, v41
v_lshl_add_u32 v97, v104, 3, v97
v_and_or_b32 v97, v41, s73, v97
ds_write_b64 v97, v[66:67] offset:28160
v_lshrrev_b32 v104, 18, v42
v_lshl_add_u32 v98, v104, 3, v98
v_and_or_b32 v98, v42, s73, v98
ds_write_b64 v98, v[68:69] offset:28160
v_lshrrev_b32 v104, 18, v43
v_lshl_add_u32 v99, v104, 3, v99
v_and_or_b32 v99, v43, s73, v99
ds_write_b64 v99, v[70:71] offset:28160
v_lshrrev_b32 v104, 18, v44
v_lshl_add_u32 v100, v104, 3, v100
v_and_or_b32 v100, v44, s73, v100
ds_write_b64 v100, v[72:73] offset:28160
v_lshrrev_b32 v104, 18, v45
v_lshl_add_u32 v101, v104, 3, v101
v_and_or_b32 v101, v45, s73, v101
ds_write_b64 v101, v[74:75] offset:28160
v_lshrrev_b32 v104, 18, v46
v_lshl_add_u32 v102, v104, 3, v102
v_and_or_b32 v102, v46, s73, v102
ds_write_b64 v102, v[76:77] offset:28160
v_lshrrev_b32 v104, 18, v47
v_lshl_add_u32 v103, v104, 3, v103
v_and_or_b32 v103, v47, s73, v103
ds_write_b64 v103, v[78:79] offset:28160
v_and_b32 v96, 0x3ffff, v48
ds_read_b32 v96, v96 offset:2048
v_and_b32 v97, 0x3ffff, v49
ds_read_b32 v97, v97 offset:2048
v_and_b32 v98, 0x3ffff, v50
ds_read_b32 v98, v98 offset:2048
v_and_b32 v99, 0x3ffff, v51
ds_read_b32 v99, v99 offset:2048
v_and_b32 v100, 0x3ffff, v52
ds_read_b32 v100, v100 offset:2048
v_and_b32 v101, 0x3ffff, v53
ds_read_b32 v101, v101 offset:2048
v_and_b32 v102, 0x3ffff, v54
ds_read_b32 v102, v102 offset:2048
v_and_b32 v103, 0x3ffff, v55
ds_read_b32 v103, v103 offset:2048
s_waitcnt lgkmcnt(0)
v_lshrrev_b32 v104, 18, v48
v_lshl_add_u32 v96, v104, 3, v96
v_and_or_b32 v96, v48, s73, v96
ds_write_b64 v96, v[80:81] offset:28160
v_lshrrev_b32 v104, 18, v49
v_lshl_add_u32 v97, v104, 3, v97
v_and_or_b32 v97, v49, s73, v97
ds_write_b64 v97, v[82:83] offset:28160
v_lshrrev_b32 v104, 18, v50
v_lshl_add_u32 v98, v104, 3, v98
v_and_or_b32 v98, v50, s73, v98
ds_write_b64 v98, v[84:85] offset:28160
v_lshrrev_b32 v104, 18, v51
v_lshl_add_u32 v99, v104, 3, v99
v_and_or_b32 v99, v51, s73, v99
ds_write_b64 v99, v[86:87] offset:28160
v_lshrrev_b32 v104, 18, v52
v_lshl_add_u32 v100, v104, 3, v100
v_and_or_b32 v100, v52, s73, v100
ds_write_b64 v100, v[88:89] offset:28160
v_lshrrev_b32 v104, 18, v53
v_lshl_add_u32 v101, v104, 3, v101
v_and_or_b32 v101, v53, s73, v101
ds_write_b64 v101, v[90:91] offset:28160
v_lshrrev_b32 v104, 18, v54
v_lshl_add_u32 v102, v104, 3, v102
v_and_or_b32 v102, v54, s73, v102
ds_write_b64 v102, v[92:93] offset:28160
v_lshrrev_b32 v104, 18, v55
v_lshl_add_u32 v103, v104, 3, v103
v_and_or_b32 v103, v55, s73, v103
ds_write_b64 v103, v[94:95] offset:28160
s_waitcnt lgkmcnt(0)
s_barrier
v_add_u32 v96, 0, v1
ds_read_b128 v[64:67], v96 offset:28160
v_add_u32 v97, 16384, v1
ds_read_b128 v[68:71], v97 offset:28160
v_add_u32 v98, 32768, v1
ds_read_b128 v[72:75], v98 offset:28160
v_add_u32 v99, 49152, v1
ds_read_b128 v[76:79], v99 offset:28160
v_add_u32 v100, 65536, v1
ds_read_b128 v[80:83], v100 offset:28160
v_add_u32 v101, 81920, v1
ds_read_b128 v[84:87], v101 offset:28160
v_add_u32 v102, 98304, v1
ds_read_b128 v[88:91], v102 offset:28160
v_add_u32 v103, 114688, v1
ds_read_b128 v[92:95], v103 offset:28160
v_add_u32 v104, 131072, v1
ds_read_b128 v[112:115], v104 offset:28160
s_waitcnt lgkmcnt(8)
buffer_store_dwordx4 v[64:67], v96, s[28:31], 0 offen nt
s_waitcnt lgkmcnt(7)
buffer_store_dwordx4 v[68:71], v97, s[28:31], 0 offen nt
s_waitcnt lgkmcnt(6)
buffer_store_dwordx4 v[72:75], v98, s[28:31], 0 offen nt
s_waitcnt lgkmcnt(5)
buffer_store_dwordx4 v[76:79], v99, s[28:31], 0 offen nt
s_waitcnt lgkmcnt(4)
buffer_store_dwordx4 v[80:83], v100, s[28:31], 0 offen nt
s_waitcnt lgkmcnt(3)
buffer_store_dwordx4 v[84:87], v101, s[28:31], 0 offen nt
s_waitcnt lgkmcnt(2)
buffer_store_dwordx4 v[88:91], v102, s[28:31], 0 offen nt
s_waitcnt lgkmcnt(1)
buffer_store_dwordx4 v[92:95], v103, s[28:31], 0 offen nt
s_waitcnt lgkmcnt(0)
buffer_store_dwordx4 v[112:115], v104, s[28:31], 0 offen nt
s_waitcnt vmcnt(9)
s_nop 0
v_lshlrev_b32 v112, 3, v16
v_and_b32 v112, 0x7ff8, v112
ds_read_b64 v[64:65], v112 offset:3072
v_lshlrev_b32 v112, 3, v17
v_and_b32 v112, 0x7ff8, v112
ds_read_b64 v[66:67], v112 offset:3072
v_lshlrev_b32 v112, 3, v18
v_and_b32 v112, 0x7ff8, v112
ds_read_b64 v[68:69], v112 offset:3072
v_lshlrev_b32 v112, 3, v19
v_and_b32 v112, 0x7ff8, v112
ds_read_b64 v[70:71], v112 offset:3072
v_cmp_ne_u16 vcc, 0, v32
v_lshrrev_b32 v96, 14, v16
v_and_b32 v96, 0x3fc, v96
v_cndmask_b32 v96, v12, v96, vcc
ds_add_rtn_u32 v100, v96, v14 offset:0
v_cmp_lt_u32 vcc, 0xffff, v32
v_lshrrev_b32 v97, 14, v17
v_and_b32 v97, 0x3fc, v97
v_cndmask_b32 v97, v12, v97, vcc
ds_add_rtn_u32 v101, v97, v14 offset:0
v_cmp_ne_u16 vcc, 0, v33
v_lshrrev_b32 v98, 14, v18
v_and_b32 v98, 0x3fc, v98
v_cndmask_b32 v98, v12, v98, vcc
ds_add_rtn_u32 v102, v98, v14 offset:0
v_cmp_lt_u32 vcc, 0xffff, v33
v_lshrrev_b32 v99, 14, v19
v_and_b32 v99, 0x3fc, v99
v_cndmask_b32 v99, v12, v99, vcc
ds_add_rtn_u32 v103, v99, v14 offset:0
v_lshlrev_b32 v112, 3, v20
v_and_b32 v112, 0x7ff8, v112
ds_read_b64 v[72:73], v112 offset:3072
v_lshlrev_b32 v112, 3, v21
v_and_b32 v112, 0x7ff8, v112
ds_read_b64 v[74:75], v112 offset:3072
v_lshlrev_b32 v112, 3, v22
v_and_b32 v112, 0x7ff8, v112
ds_read_b64 v[76:77], v112 offset:3072
v_lshlrev_b32 v112, 3, v23
v_and_b32 v112, 0x7ff8, v112
ds_read_b64 v[78:79], v112 offset:3072
v_cmp_ne_u16 vcc, 0, v34
v_lshrrev_b32 v104, 14, v20
v_and_b32 v104, 0x3fc, v104
v_cndmask_b32 v104, v12, v104, vcc
ds_add_rtn_u32 v108, v104, v14 offset:0
v_cmp_lt_u32 vcc, 0xffff, v34
v_lshrrev_b32 v105, 14, v21
v_and_b32 v105, 0x3fc, v105
v_cndmask_b32 v105, v12, v105, vcc
ds_add_rtn_u32 v109, v105, v14 offset:0
v_cmp_ne_u16 vcc, 0, v35
v_lshrrev_b32 v106, 14, v22
v_and_b32 v106, 0x3fc, v106
v_cndmask_b32 v106, v12, v106, vcc
ds_add_rtn_u32 v110, v106, v14 offset:0
v_cmp_lt_u32 vcc, 0xffff, v35
v_lshrrev_b32 v107, 14, v23
v_and_b32 v107, 0x3fc, v107
v_cndmask_b32 v107, v12, v107, vcc
ds_add_rtn_u32 v111, v107, v14 offset:0
s_waitcnt lgkmcnt(12)
v_pk_mul_f16 v64, v64, v32 op_sel:[0,0] op_sel_hi:[1,0]
v_pk_mul_f16 v65, v65, v32 op_sel:[0,0] op_sel_hi:[1,0]
v_lshrrev_b32 v113, 20, v16
v_lshrrev_b32 v114, 12, v16
v_bfi_b32 v113, 15, v114, v113
v_add_u32 v64, 0x00040004, v64
v_add_u32 v65, 0x00040004, v65
v_lshl_or_b32 v114, v113, 13, v113
v_lshrrev_b32 v115, 6, v113
v_bfi_b32 v64, s72, v114, v64
v_lshl_or_b32 v115, v115, 13, v115
v_bfi_b32 v65, s72, v115, v65
v_pk_mul_f16 v66, v66, v32 op_sel:[0,1] op_sel_hi:[1,1]
v_pk_mul_f16 v67, v67, v32 op_sel:[0,1] op_sel_hi:[1,1]
v_lshrrev_b32 v113, 20, v17
v_lshrrev_b32 v114, 12, v17
v_bfi_b32 v113, 15, v114, v113
v_add_u32 v66, 0x00040004, v66
v_add_u32 v67, 0x00040004, v67
v_lshl_or_b32 v114, v113, 13, v113
v_lshrrev_b32 v115, 6, v113
v_bfi_b32 v66, s72, v114, v66
v_lshl_or_b32 v115, v115, 13, v115
v_bfi_b32 v67, s72, v115, v67
v_pk_mul_f16 v68, v68, v33 op_sel:[0,0] op_sel_hi:[1,0]
v_pk_mul_f16 v69, v69, v33 op_sel:[0,0] op_sel_hi:[1,0]
v_lshrrev_b32 v113, 20, v18
v_lshrrev_b32 v114, 12, v18
v_bfi_b32 v113, 15, v114, v113
v_add_u32 v68, 0x00040004, v68
v_add_u32 v69, 0x00040004, v69
v_lshl_or_b32 v114, v113, 13, v113
v_lshrrev_b32 v115, 6, v113
v_bfi_b32 v68, s72, v114, v68
v_lshl_or_b32 v115, v115, 13, v115
v_bfi_b32 v69, s72, v115, v69
v_pk_mul_f16 v70, v70, v33 op_sel:[0,1] op_sel_hi:[1,1]
v_pk_mul_f16 v71, v71, v33 op_sel:[0,1] op_sel_hi:[1,1]
v_lshrrev_b32 v113, 20, v19
v_lshrrev_b32 v114, 12, v19
v_bfi_b32 v113, 15, v114, v113
v_add_u32 v70, 0x00040004, v70
v_add_u32 v71, 0x00040004, v71
v_lshl_or_b32 v114, v113, 13, v113
v_lshrrev_b32 v115, 6, v113
v_bfi_b32 v70, s72, v114, v70
v_lshl_or_b32 v115, v115, 13, v115
v_bfi_b32 v71, s72, v115, v71
s_waitcnt lgkmcnt(8)
v_lshl_or_b32 v16, v100, 18, v96
v_lshl_or_b32 v17, v101, 18, v97
v_lshl_or_b32 v18, v102, 18, v98
v_lshl_or_b32 v19, v103, 18, v99
v_lshlrev_b32 v112, 3, v24
v_and_b32 v112, 0x7ff8, v112
ds_read_b64 v[80:81], v112 offset:3072
v_lshlrev_b32 v112, 3, v25
v_and_b32 v112, 0x7ff8, v112
ds_read_b64 v[82:83], v112 offset:3072
v_lshlrev_b32 v112, 3, v26
v_and_b32 v112, 0x7ff8, v112
ds_read_b64 v[84:85], v112 offset:3072
v_lshlrev_b32 v112, 3, v27
v_and_b32 v112, 0x7ff8, v112
ds_read_b64 v[86:87], v112 offset:3072
v_cmp_ne_u16 vcc, 0, v36
v_lshrrev_b32 v96, 14, v24
v_and_b32 v96, 0x3fc, v96
v_cndmask_b32 v96, v12, v96, vcc
ds_add_rtn_u32 v100, v96, v14 offset:0
v_cmp_lt_u32 vcc, 0xffff, v36
v_lshrrev_b32 v97, 14, v25
v_and_b32 v97, 0x3fc, v97
v_cndmask_b32 v97, v12, v97, vcc
ds_add_rtn_u32 v101, v97, v14 offset:0
v_cmp_ne_u16 vcc, 0, v37
v_lshrrev_b32 v98, 14, v26
v_and_b32 v98, 0x3fc, v98
v_cndmask_b32 v98, v12, v98, vcc
ds_add_rtn_u32 v102, v98, v14 offset:0
v_cmp_lt_u32 vcc, 0xffff, v37
v_lshrrev_b32 v99, 14, v27
v_and_b32 v99, 0x3fc, v99
v_cndmask_b32 v99, v12, v99, vcc
ds_add_rtn_u32 v103, v99, v14 offset:0
s_waitcnt lgkmcnt(12)
v_pk_mul_f16 v72, v72, v34 op_sel:[0,0] op_sel_hi:[1,0]
v_pk_mul_f16 v73, v73, v34 op_sel:[0,0] op_sel_hi:[1,0]
v_lshrrev_b32 v113, 20, v20
v_lshrrev_b32 v114, 12, v20
v_bfi_b32 v113, 15, v114, v113
v_add_u32 v72, 0x00040004, v72
v_add_u32 v73, 0x00040004, v73
v_lshl_or_b32 v114, v113, 13, v113
v_lshrrev_b32 v115, 6, v113
v_bfi_b32 v72, s72, v114, v72
v_lshl_or_b32 v115, v115, 13, v115
v_bfi_b32 v73, s72, v115, v73
v_pk_mul_f16 v74, v74, v34 op_sel:[0,1] op_sel_hi:[1,1]
v_pk_mul_f16 v75, v75, v34 op_sel:[0,1] op_sel_hi:[1,1]
v_lshrrev_b32 v113, 20, v21
v_lshrrev_b32 v114, 12, v21
v_bfi_b32 v113, 15, v114, v113
v_add_u32 v74, 0x00040004, v74
v_add_u32 v75, 0x00040004, v75
v_lshl_or_b32 v114, v113, 13, v113
v_lshrrev_b32 v115, 6, v113
v_bfi_b32 v74, s72, v114, v74
v_lshl_or_b32 v115, v115, 13, v115
v_bfi_b32 v75, s72, v115, v75
v_pk_mul_f16 v76, v76, v35 op_sel:[0,0] op_sel_hi:[1,0]
v_pk_mul_f16 v77, v77, v35 op_sel:[0,0] op_sel_hi:[1,0]
v_lshrrev_b32 v113, 20, v22
v_lshrrev_b32 v114, 12, v22
v_bfi_b32 v113, 15, v114, v113
v_add_u32 v76, 0x00040004, v76
v_add_u32 v77, 0x00040004, v77
v_lshl_or_b32 v114, v113, 13, v113
v_lshrrev_b32 v115, 6, v113
v_bfi_b32 v76, s72, v114, v76
v_lshl_or_b32 v115, v115, 13, v115
v_bfi_b32 v77, s72, v115, v77
v_pk_mul_f16 v78, v78, v35 op_sel:[0,1] op_sel_hi:[1,1]
v_pk_mul_f16 v79, v79, v35 op_sel:[0,1] op_sel_hi:[1,1]
v_lshrrev_b32 v113, 20, v23
v_lshrrev_b32 v114, 12, v23
v_bfi_b32 v113, 15, v114, v113
v_add_u32 v78, 0x00040004, v78
v_add_u32 v79, 0x00040004, v79
v_lshl_or_b32 v114, v113, 13, v113
v_lshrrev_b32 v115, 6, v113
v_bfi_b32 v78, s72, v114, v78
v_lshl_or_b32 v115, v115, 13, v115
v_bfi_b32 v79, s72, v115, v79
s_waitcnt lgkmcnt(8)
v_lshl_or_b32 v20, v108, 18, v104
v_lshl_or_b32 v21, v109, 18, v105
v_lshl_or_b32 v22, v110, 18, v106
v_lshl_or_b32 v23, v111, 18, v107
v_lshlrev_b32 v112, 3, v28
v_and_b32 v112, 0x7ff8, v112
ds_read_b64 v[88:89], v112 offset:3072
v_lshlrev_b32 v112, 3, v29
v_and_b32 v112, 0x7ff8, v112
ds_read_b64 v[90:91], v112 offset:3072
v_lshlrev_b32 v112, 3, v30
v_and_b32 v112, 0x7ff8, v112
ds_read_b64 v[92:93], v112 offset:3072
v_lshlrev_b32 v112, 3, v31
v_and_b32 v112, 0x7ff8, v112
ds_read_b64 v[94:95], v112 offset:3072
v_cmp_ne_u16 vcc, 0, v38
v_lshrrev_b32 v104, 14, v28
v_and_b32 v104, 0x3fc, v104
v_cndmask_b32 v104, v12, v104, vcc
ds_add_rtn_u32 v108, v104, v14 offset:0
v_cmp_lt_u32 vcc, 0xffff, v38
v_lshrrev_b32 v105, 14, v29
v_and_b32 v105, 0x3fc, v105
v_cndmask_b32 v105, v12, v105, vcc
ds_add_rtn_u32 v109, v105, v14 offset:0
v_cmp_ne_u16 vcc, 0, v39
v_lshrrev_b32 v106, 14, v30
v_and_b32 v106, 0x3fc, v106
v_cndmask_b32 v106, v12, v106, vcc
ds_add_rtn_u32 v110, v106, v14 offset:0
v_cmp_lt_u32 vcc, 0xffff, v39
v_lshrrev_b32 v107, 14, v31
v_and_b32 v107, 0x3fc, v107
v_cndmask_b32 v107, v12, v107, vcc
ds_add_rtn_u32 v111, v107, v14 offset:0
s_waitcnt lgkmcnt(12)
v_pk_mul_f16 v80, v80, v36 op_sel:[0,0] op_sel_hi:[1,0]
v_pk_mul_f16 v81, v81, v36 op_sel:[0,0] op_sel_hi:[1,0]
v_lshrrev_b32 v113, 20, v24
v_lshrrev_b32 v114, 12, v24
v_bfi_b32 v113, 15, v114, v113
v_add_u32 v80, 0x00040004, v80
v_add_u32 v81, 0x00040004, v81
v_lshl_or_b32 v114, v113, 13, v113
v_lshrrev_b32 v115, 6, v113
v_bfi_b32 v80, s72, v114, v80
v_lshl_or_b32 v115, v115, 13, v115
v_bfi_b32 v81, s72, v115, v81
v_pk_mul_f16 v82, v82, v36 op_sel:[0,1] op_sel_hi:[1,1]
v_pk_mul_f16 v83, v83, v36 op_sel:[0,1] op_sel_hi:[1,1]
v_lshrrev_b32 v113, 20, v25
v_lshrrev_b32 v114, 12, v25
v_bfi_b32 v113, 15, v114, v113
v_add_u32 v82, 0x00040004, v82
v_add_u32 v83, 0x00040004, v83
v_lshl_or_b32 v114, v113, 13, v113
v_lshrrev_b32 v115, 6, v113
v_bfi_b32 v82, s72, v114, v82
v_lshl_or_b32 v115, v115, 13, v115
v_bfi_b32 v83, s72, v115, v83
v_pk_mul_f16 v84, v84, v37 op_sel:[0,0] op_sel_hi:[1,0]
v_pk_mul_f16 v85, v85, v37 op_sel:[0,0] op_sel_hi:[1,0]
v_lshrrev_b32 v113, 20, v26
v_lshrrev_b32 v114, 12, v26
v_bfi_b32 v113, 15, v114, v113
v_add_u32 v84, 0x00040004, v84
v_add_u32 v85, 0x00040004, v85
v_lshl_or_b32 v114, v113, 13, v113
v_lshrrev_b32 v115, 6, v113
v_bfi_b32 v84, s72, v114, v84
v_lshl_or_b32 v115, v115, 13, v115
v_bfi_b32 v85, s72, v115, v85
v_pk_mul_f16 v86, v86, v37 op_sel:[0,1] op_sel_hi:[1,1]
v_pk_mul_f16 v87, v87, v37 op_sel:[0,1] op_sel_hi:[1,1]
v_lshrrev_b32 v113, 20, v27
v_lshrrev_b32 v114, 12, v27
v_bfi_b32 v113, 15, v114, v113
v_add_u32 v86, 0x00040004, v86
v_add_u32 v87, 0x00040004, v87
v_lshl_or_b32 v114, v113, 13, v113
v_lshrrev_b32 v115, 6, v113
v_bfi_b32 v86, s72, v114, v86
v_lshl_or_b32 v115, v115, 13, v115
v_bfi_b32 v87, s72, v115, v87
s_waitcnt lgkmcnt(8)
v_lshl_or_b32 v24, v100, 18, v96
v_lshl_or_b32 v25, v101, 18, v97
v_lshl_or_b32 v26, v102, 18, v98
v_lshl_or_b32 v27, v103, 18, v99
s_waitcnt lgkmcnt(4)
v_pk_mul_f16 v88, v88, v38 op_sel:[0,0] op_sel_hi:[1,0]
v_pk_mul_f16 v89, v89, v38 op_sel:[0,0] op_sel_hi:[1,0]
v_lshrrev_b32 v113, 20, v28
v_lshrrev_b32 v114, 12, v28
v_bfi_b32 v113, 15, v114, v113
v_add_u32 v88, 0x00040004, v88
v_add_u32 v89, 0x00040004, v89
v_lshl_or_b32 v114, v113, 13, v113
v_lshrrev_b32 v115, 6, v113
v_bfi_b32 v88, s72, v114, v88
v_lshl_or_b32 v115, v115, 13, v115
v_bfi_b32 v89, s72, v115, v89
v_pk_mul_f16 v90, v90, v38 op_sel:[0,1] op_sel_hi:[1,1]
v_pk_mul_f16 v91, v91, v38 op_sel:[0,1] op_sel_hi:[1,1]
v_lshrrev_b32 v113, 20, v29
v_lshrrev_b32 v114, 12, v29
v_bfi_b32 v113, 15, v114, v113
v_add_u32 v90, 0x00040004, v90
v_add_u32 v91, 0x00040004, v91
v_lshl_or_b32 v114, v113, 13, v113
v_lshrrev_b32 v115, 6, v113
v_bfi_b32 v90, s72, v114, v90
v_lshl_or_b32 v115, v115, 13, v115
v_bfi_b32 v91, s72, v115, v91
v_pk_mul_f16 v92, v92, v39 op_sel:[0,0] op_sel_hi:[1,0]
v_pk_mul_f16 v93, v93, v39 op_sel:[0,0] op_sel_hi:[1,0]
v_lshrrev_b32 v113, 20, v30
v_lshrrev_b32 v114, 12, v30
v_bfi_b32 v113, 15, v114, v113
v_add_u32 v92, 0x00040004, v92
v_add_u32 v93, 0x00040004, v93
v_lshl_or_b32 v114, v113, 13, v113
v_lshrrev_b32 v115, 6, v113
v_bfi_b32 v92, s72, v114, v92
v_lshl_or_b32 v115, v115, 13, v115
v_bfi_b32 v93, s72, v115, v93
v_pk_mul_f16 v94, v94, v39 op_sel:[0,1] op_sel_hi:[1,1]
v_pk_mul_f16 v95, v95, v39 op_sel:[0,1] op_sel_hi:[1,1]
v_lshrrev_b32 v113, 20, v31
v_lshrrev_b32 v114, 12, v31
v_bfi_b32 v113, 15, v114, v113
v_add_u32 v94, 0x00040004, v94
v_add_u32 v95, 0x00040004, v95
v_lshl_or_b32 v114, v113, 13, v113
v_lshrrev_b32 v115, 6, v113
v_bfi_b32 v94, s72, v114, v94
v_lshl_or_b32 v115, v115, 13, v115
v_bfi_b32 v95, s72, v115, v95
s_waitcnt lgkmcnt(0)
v_lshl_or_b32 v28, v108, 18, v104
v_lshl_or_b32 v29, v109, 18, v105
v_lshl_or_b32 v30, v110, 18, v106
v_lshl_or_b32 v31, v111, 18, v107
s_barrier
ds_read_b128 v[96:99], v2 offset:0
s_waitcnt lgkmcnt(0)
v_add_u32 v100, 1, v96
v_lshrrev_b32 v100, 1, v100
v_add_u32 v101, 1, v97
v_lshrrev_b32 v101, 1, v101
v_add_u32 v102, 1, v98
v_lshrrev_b32 v102, 1, v102
v_add_u32 v103, 1, v99
v_lshrrev_b32 v103, 1, v103
v_add_u32 v106, v100, v101
v_add_u32 v107, v106, v102
v_add_u32 v108, v107, v103
v_mov_b32 v109, v108
s_nop 1
v_add_u32_dpp v109, v109, v109 row_shr:1 row_mask:0xf bank_mask:0xf bound_ctrl:0
s_nop 1
v_add_u32_dpp v109, v109, v109 row_shr:2 row_mask:0xf bank_mask:0xf bound_ctrl:0
s_nop 1
v_add_u32_dpp v109, v109, v109 row_shr:4 row_mask:0xf bank_mask:0xf bound_ctrl:0
s_nop 1
v_add_u32_dpp v109, v109, v109 row_shr:8 row_mask:0xf bank_mask:0xf bound_ctrl:0
s_nop 1
v_add_u32_dpp v109, v109, v109 row_bcast:15 row_mask:0xa bank_mask:0xf
s_nop 1
v_add_u32_dpp v109, v109, v109 row_bcast:31 row_mask:0xc bank_mask:0xf
v_sub_u32 v104, v109, v108
v_add_u32 v105, v104, v100
v_add_u32 v106, v104, v106
v_add_u32 v107, v104, v107
v_readlane_b32 s61, v109, 63
v_lshl_or_b32 v100, v100, 16, v104
v_lshl_or_b32 v101, v101, 16, v105
v_lshl_or_b32 v102, v102, 16, v106
v_lshl_or_b32 v103, v103, 16, v107
v_lshlrev_b32 v104, 4, v104
v_lshlrev_b32 v105, 4, v105
v_lshlrev_b32 v106, 4, v106
v_lshlrev_b32 v107, 4, v107
ds_write_b128 v2, v[104:107] offset:2048
ds_write_b128 v2, v[4:7] offset:1024
s_cmp_lg_u32 s43, 0
s_cbranch_scc1 k2w0_102
s_mul_i32 s50, s42, 7
s_add_u32 s50, s50, 6
s_lshl_b32 s50, s50, 10
buffer_store_dwordx4 v[100:103], v2, s[32:35], s50 offen
v_and_b32 v111, 1, v96
v_cmp_eq_u32 vcc, 1, v111
v_lshl_add_u32 v110, v96, 3, v104
s_nop 0
v_cndmask_b32 v110, v12, v110, vcc
ds_write_b64 v110, v[4:5] offset:28160
v_and_b32 v111, 1, v97
v_cmp_eq_u32 vcc, 1, v111
v_lshl_add_u32 v110, v97, 3, v105
s_nop 0
v_cndmask_b32 v110, v12, v110, vcc
ds_write_b64 v110, v[4:5] offset:28160
v_and_b32 v111, 1, v98
v_cmp_eq_u32 vcc, 1, v111
v_lshl_add_u32 v110, v98, 3, v106
s_nop 0
v_cndmask_b32 v110, v12, v110, vcc
ds_write_b64 v110, v[4:5] offset:28160
v_and_b32 v111, 1, v99
v_cmp_eq_u32 vcc, 1, v111
v_lshl_add_u32 v110, v99, 3, v107
s_nop 0
v_cndmask_b32 v110, v12, v110, vcc
ds_write_b64 v110, v[4:5] offset:28160
k2w0_102:
s_mul_i32 s50, s42, 7
s_add_u32 s50, s50, 6
s_mul_i32 s51, s50, 133120
s_add_u32 s28, s52, s51
s_addc_u32 s29, s53, 0
s_and_b32 s29, s29, 0xffff
s_lshl_b32 s30, s61, 4
s_add_u32 s30, s30, 127
s_and_b32 s30, s30, 0xffffff80
s_waitcnt lgkmcnt(0)
v_and_b32 v96, 0x3ffff, v16
ds_read_b32 v96, v96 offset:2048
v_and_b32 v97, 0x3ffff, v17
ds_read_b32 v97, v97 offset:2048
v_and_b32 v98, 0x3ffff, v18
ds_read_b32 v98, v98 offset:2048
v_and_b32 v99, 0x3ffff, v19
ds_read_b32 v99, v99 offset:2048
v_and_b32 v100, 0x3ffff, v20
ds_read_b32 v100, v100 offset:2048
v_and_b32 v101, 0x3ffff, v21
ds_read_b32 v101, v101 offset:2048
v_and_b32 v102, 0x3ffff, v22
ds_read_b32 v102, v102 offset:2048
v_and_b32 v103, 0x3ffff, v23
ds_read_b32 v103, v103 offset:2048
s_waitcnt lgkmcnt(0)
v_lshrrev_b32 v104, 18, v16
v_lshl_add_u32 v96, v104, 3, v96
v_and_or_b32 v96, v16, s73, v96
ds_write_b64 v96, v[64:65] offset:28160
v_lshrrev_b32 v104, 18, v17
v_lshl_add_u32 v97, v104, 3, v97
v_and_or_b32 v97, v17, s73, v97
ds_write_b64 v97, v[66:67] offset:28160
v_lshrrev_b32 v104, 18, v18
v_lshl_add_u32 v98, v104, 3, v98
v_and_or_b32 v98, v18, s73, v98
ds_write_b64 v98, v[68:69] offset:28160
v_lshrrev_b32 v104, 18, v19
v_lshl_add_u32 v99, v104, 3, v99
v_and_or_b32 v99, v19, s73, v99
ds_write_b64 v99, v[70:71] offset:28160
v_lshrrev_b32 v104, 18, v20
v_lshl_add_u32 v100, v104, 3, v100
v_and_or_b32 v100, v20, s73, v100
ds_write_b64 v100, v[72:73] offset:28160
v_lshrrev_b32 v104, 18, v21
v_lshl_add_u32 v101, v104, 3, v101
v_and_or_b32 v101, v21, s73, v101
ds_write_b64 v101, v[74:75] offset:28160
v_lshrrev_b32 v104, 18, v22
v_lshl_add_u32 v102, v104, 3, v102
v_and_or_b32 v102, v22, s73, v102
ds_write_b64 v102, v[76:77] offset:28160
v_lshrrev_b32 v104, 18, v23
v_lshl_add_u32 v103, v104, 3, v103
v_and_or_b32 v103, v23, s73, v103
ds_write_b64 v103, v[78:79] offset:28160
v_and_b32 v96, 0x3ffff, v24
ds_read_b32 v96, v96 offset:2048
v_and_b32 v97, 0x3ffff, v25
ds_read_b32 v97, v97 offset:2048
v_and_b32 v98, 0x3ffff, v26
ds_read_b32 v98, v98 offset:2048
v_and_b32 v99, 0x3ffff, v27
ds_read_b32 v99, v99 offset:2048
v_and_b32 v100, 0x3ffff, v28
ds_read_b32 v100, v100 offset:2048
v_and_b32 v101, 0x3ffff, v29
ds_read_b32 v101, v101 offset:2048
v_and_b32 v102, 0x3ffff, v30
ds_read_b32 v102, v102 offset:2048
v_and_b32 v103, 0x3ffff, v31
ds_read_b32 v103, v103 offset:2048
s_waitcnt lgkmcnt(0)
v_lshrrev_b32 v104, 18, v24
v_lshl_add_u32 v96, v104, 3, v96
v_and_or_b32 v96, v24, s73, v96
ds_write_b64 v96, v[80:81] offset:28160
v_lshrrev_b32 v104, 18, v25
v_lshl_add_u32 v97, v104, 3, v97
v_and_or_b32 v97, v25, s73, v97
ds_write_b64 v97, v[82:83] offset:28160
v_lshrrev_b32 v104, 18, v26
v_lshl_add_u32 v98, v104, 3, v98
v_and_or_b32 v98, v26, s73, v98
ds_write_b64 v98, v[84:85] offset:28160
v_lshrrev_b32 v104, 18, v27
v_lshl_add_u32 v99, v104, 3, v99
v_and_or_b32 v99, v27, s73, v99
ds_write_b64 v99, v[86:87] offset:28160
v_lshrrev_b32 v104, 18, v28
v_lshl_add_u32 v100, v104, 3, v100
v_and_or_b32 v100, v28, s73, v100
ds_write_b64 v100, v[88:89] offset:28160
v_lshrrev_b32 v104, 18, v29
v_lshl_add_u32 v101, v104, 3, v101
v_and_or_b32 v101, v29, s73, v101
ds_write_b64 v101, v[90:91] offset:28160
v_lshrrev_b32 v104, 18, v30
v_lshl_add_u32 v102, v104, 3, v102
v_and_or_b32 v102, v30, s73, v102
ds_write_b64 v102, v[92:93] offset:28160
v_lshrrev_b32 v104, 18, v31
v_lshl_add_u32 v103, v104, 3, v103
v_and_or_b32 v103, v31, s73, v103
ds_write_b64 v103, v[94:95] offset:28160
s_waitcnt lgkmcnt(0)
s_barrier
v_add_u32 v96, 0, v1
ds_read_b128 v[64:67], v96 offset:28160
v_add_u32 v97, 16384, v1
ds_read_b128 v[68:71], v97 offset:28160
v_add_u32 v98, 32768, v1
ds_read_b128 v[72:75], v98 offset:28160
v_add_u32 v99, 49152, v1
ds_read_b128 v[76:79], v99 offset:28160
v_add_u32 v100, 65536, v1
ds_read_b128 v[80:83], v100 offset:28160
v_add_u32 v101, 81920, v1
ds_read_b128 v[84:87], v101 offset:28160
v_add_u32 v102, 98304, v1
ds_read_b128 v[88:91], v102 offset:28160
v_add_u32 v103, 114688, v1
ds_read_b128 v[92:95], v103 offset:28160
v_add_u32 v104, 131072, v1
ds_read_b128 v[112:115], v104 offset:28160
s_waitcnt lgkmcnt(8)
buffer_store_dwordx4 v[64:67], v96, s[28:31], 0 offen nt
s_waitcnt lgkmcnt(7)
buffer_store_dwordx4 v[68:71], v97, s[28:31], 0 offen nt
s_waitcnt lgkmcnt(6)
buffer_store_dwordx4 v[72:75], v98, s[28:31], 0 offen nt
s_waitcnt lgkmcnt(5)
buffer_store_dwordx4 v[76:79], v99, s[28:31], 0 offen nt
s_waitcnt lgkmcnt(4)
buffer_store_dwordx4 v[80:83], v100, s[28:31], 0 offen nt
s_waitcnt lgkmcnt(3)
buffer_store_dwordx4 v[84:87], v101, s[28:31], 0 offen nt
s_waitcnt lgkmcnt(2)
buffer_store_dwordx4 v[88:91], v102, s[28:31], 0 offen nt
s_waitcnt lgkmcnt(1)
buffer_store_dwordx4 v[92:95], v103, s[28:31], 0 offen nt
s_waitcnt lgkmcnt(0)
buffer_store_dwordx4 v[112:115], v104, s[28:31], 0 offen nt
s_waitcnt vmcnt(0) lgkmcnt(0)
k2_end:
s_endpgm
.globl acc_kernel
.p2align 8
.type acc_kernel,@function
acc_kernel:
s_cmp_ge_u32 s2, 256
s_cbranch_scc1 k3_end
s_load_dwordx2 s[52:53], s[0:1], 104
s_load_dwordx2 s[54:55], s[0:1], 0
s_load_dwordx2 s[58:59], s[0:1], 24
s_load_dwordx2 s[62:63], s[0:1], 88
v_lshlrev_b32 v1, 4, v0
v_and_b32 v3, 63, v0
v_lshlrev_b32 v2, 4, v3
v_mov_b32 v4, 0
v_mov_b32 v5, 0
v_mov_b32 v6, 0
v_mov_b32 v7, 0
v_lshrrev_b32 v44, 6, v0
s_nop 0
v_readfirstlane_b32 s57, v44
v_mov_b32 v13, 2147483648
v_mov_b32 v15, 196608
v_mov_b32 v14, 0x43800000
v_mov_b32 v12, 1
s_and_b32 s56, s2, 7
s_lshl_b32 s56, s56, 5
s_lshr_b32 s3, s2, 3
s_add_u32 s56, s56, s3
s_mul_i32 s60, s57, 112
v_add_u32 v46, s60, v3
v_add_u32 v47, 56, v46
s_lshl_b32 s61, s56, 2
v_lshlrev_b32 v44, 10, v46
v_lshlrev_b32 v45, 10, v47
v_cmp_gt_u32 vcc, 56, v3
s_nop 1
v_cndmask_b32 v44, v13, v44, vcc
v_cndmask_b32 v45, v13, v45, vcc
ds_write_b128 v1, v[4:7] offset:0
ds_write_b128 v1, v[4:7] offset:16384
ds_write_b128 v1, v[4:7] offset:32768
ds_write_b128 v1, v[4:7] offset:49152
v_mov_b32 v56, 100352
ds_write_b32 v56, v4
s_waitcnt lgkmcnt(0)
s_add_u32 s12, s52, 399605760
s_addc_u32 s13, s53, 0
s_and_b32 s13, s13, 0xffff
s_mov_b32 s14, 1835008
s_mov_b32 s15, 0x00020000
s_add_u32 s16, s52, 401440768
s_addc_u32 s17, s53, 0
s_and_b32 s17, s17, 0xffff
s_mov_b32 s18, 1028
s_mov_b32 s19, 0x00020000
buffer_load_dword v48, v44, s[12:15], s61 offen
buffer_load_dword v49, v45, s[12:15], s61 offen
buffer_load_dword v50, v4, s[16:19], 0 offen offset:1024
buffer_load_dwordx4 v[52:55], v2, s[16:19], 0 offen
s_barrier
s_add_u32 s8, s52, 159744000
s_addc_u32 s9, s53, 0
s_and_b32 s9, s9, 0xffff
s_mov_b32 s10, 238551040
s_mov_b32 s11, 0x00020000
s_mov_b32 s24, s54
s_and_b32 s25, s55, 0xffff
s_mov_b32 s26, 6400000
s_mov_b32 s27, 0x00020000
s_mov_b32 s28, s58
s_and_b32 s29, s59, 0xffff
s_mov_b32 s30, 1600000
s_mov_b32 s31, 0x00020000
s_mov_b32 s32, s62
s_and_b32 s33, s63, 0xffff
s_mov_b32 s34, 6400000
s_mov_b32 s35, 0x00020000
s_load_dwordx2 s[52:53], s[0:1], 40
s_load_dwordx2 s[54:55], s[0:1], 56
s_load_dwordx2 s[58:59], s[0:1], 64
s_load_dwordx2 s[62:63], s[0:1], 72
s_load_dwordx2 s[78:79], s[0:1], 80
s_waitcnt vmcnt(0)
v_max_u32 v52, v52, v53
v_max_u32 v54, v54, v55
v_max_u32 v52, v52, v54
s_nop 1
v_max_u32_dpp v52, v52, v52 row_shr:1 row_mask:0xf bank_mask:0xf bound_ctrl:0
s_nop 1
v_max_u32_dpp v52, v52, v52 row_shr:2 row_mask:0xf bank_mask:0xf bound_ctrl:0
s_nop 1
v_max_u32_dpp v52, v52, v52 row_shr:4 row_mask:0xf bank_mask:0xf bound_ctrl:0
s_nop 1
v_max_u32_dpp v52, v52, v52 row_shr:8 row_mask:0xf bank_mask:0xf bound_ctrl:0
s_nop 1
v_max_u32_dpp v52, v52, v52 row_bcast:15 row_mask:0xa bank_mask:0xf
s_nop 1
v_max_u32_dpp v52, v52, v52 row_bcast:31 row_mask:0xc bank_mask:0xf
s_nop 0
v_readlane_b32 s61, v52, 63
s_nop 1
s_lshr_b32 s61, s61, 7
s_sub_u32 s60, 268, s61
s_min_u32 s60, s60, 254
s_max_u32 s60, s60, 1
v_readfirstlane_b32 s64, v50
v_lshrrev_b32 v8, 16, v48
v_mov_b32 v44, v8
s_nop 0
v_add_u32_dpp v8, v8, v8 row_shr:1 row_mask:0xf bank_mask:0xf bound_ctrl:0
s_nop 1
v_add_u32_dpp v8, v8, v8 row_shr:2 row_mask:0xf bank_mask:0xf bound_ctrl:0
s_nop 1
v_add_u32_dpp v8, v8, v8 row_shr:4 row_mask:0xf bank_mask:0xf bound_ctrl:0
s_nop 1
v_add_u32_dpp v8, v8, v8 row_shr:8 row_mask:0xf bank_mask:0xf bound_ctrl:0
s_nop 1
v_add_u32_dpp v8, v8, v8 row_bcast:15 row_mask:0xa bank_mask:0xf
s_nop 1
v_add_u32_dpp v8, v8, v8 row_bcast:31 row_mask:0xc bank_mask:0xf
s_nop 0
v_readlane_b32 s66, v8, 63
v_sub_u32 v8, v8, v44
v_and_b32 v48, 0xffff, v48
v_sub_u32 v48, v48, v8
v_mov_b32 v44, 8320
v_mad_u32_u24 v9, v46, v44, v48
s_sub_u32 s3, 134217728, s66
v_mov_b32 v44, s3
v_cmp_eq_u32 vcc, 56, v3
s_nop 1
v_cndmask_b32 v9, v9, v44, vcc
v_mov_b32 v44, -1
v_cmp_lt_u32 vcc, 56, v3
s_nop 1
v_cndmask_b32 v8, v8, v44, vcc
v_lshrrev_b32 v10, 16, v49
v_mov_b32 v45, v10
s_nop 0
v_add_u32_dpp v10, v10, v10 row_shr:1 row_mask:0xf bank_mask:0xf bound_ctrl:0
s_nop 1
v_add_u32_dpp v10, v10, v10 row_shr:2 row_mask:0xf bank_mask:0xf bound_ctrl:0
s_nop 1
v_add_u32_dpp v10, v10, v10 row_shr:4 row_mask:0xf bank_mask:0xf bound_ctrl:0
s_nop 1
v_add_u32_dpp v10, v10, v10 row_shr:8 row_mask:0xf bank_mask:0xf bound_ctrl:0
s_nop 1
v_add_u32_dpp v10, v10, v10 row_bcast:15 row_mask:0xa bank_mask:0xf
s_nop 1
v_add_u32_dpp v10, v10, v10 row_bcast:31 row_mask:0xc bank_mask:0xf
s_nop 0
v_readlane_b32 s67, v10, 63
v_sub_u32 v10, v10, v45
v_and_b32 v49, 0xffff, v49
v_sub_u32 v49, v49, v10
v_mov_b32 v45, 8320
v_mad_u32_u24 v11, v47, v45, v49
s_sub_u32 s3, 134217728, s67
v_mov_b32 v45, s3
v_cmp_eq_u32 vcc, 56, v3
s_nop 1
v_cndmask_b32 v11, v11, v45, vcc
v_mov_b32 v45, -1
v_cmp_lt_u32 vcc, 56, v3
s_nop 1
v_cndmask_b32 v10, v10, v45, vcc
s_mov_b32 s68, 0
s_mov_b32 s69, 0
s_mov_b32 s70, 0
s_mov_b32 s72, 0
s_mov_b32 s73, 0x00070007
s_mov_b32 s74, 0xfff8fff8
v_readlane_b32 s71, v8, 0
s_cmp_lt_u32 s68, s66
s_cbranch_scc1 k3ns_103
s_cmp_lg_u32 s69, 0
s_cbranch_scc1 k3ns_103
v_mov_b32 v8, v10
v_mov_b32 v9, v11
s_mov_b32 s66, s67
s_mov_b32 s68, 0
s_mov_b32 s69, 1
s_mov_b32 s70, 0
v_readlane_b32 s71, v8, 0
k3ns_103:
v_mov_b32 v44, s72
s_add_u32 s76, s68, 64
s_cmp_lt_u32 s71, s76
s_cbranch_scc0 gwek3_105
gwk3_104:
v_readlane_b32 s72, v9, s70
s_add_u32 s70, s70, 1
s_sub_u32 s77, s71, s68
s_max_i32 s77, s77, 0
v_readlane_b32 s71, v8, s70
s_lshl_b64 exec, -1, s77
v_mov_b32 v44, s72
s_cmp_lt_u32 s71, s76
s_cbranch_scc1 gwk3_104
s_mov_b64 exec, -1
gwek3_105:
v_add3_u32 v44, v44, s68, v3
s_add_u32 s68, s68, 64
v_lshlrev_b32 v44, 4, v44
buffer_load_dwordx4 v[28:31], v44, s[8:11], 0 offen nt
s_cmp_lt_u32 s68, s66
s_cbranch_scc1 k3ns_106
s_cmp_lg_u32 s69, 0
s_cbranch_scc1 k3ns_106
v_mov_b32 v8, v10
v_mov_b32 v9, v11
s_mov_b32 s66, s67
s_mov_b32 s68, 0
s_mov_b32 s69, 1
s_mov_b32 s70, 0
v_readlane_b32 s71, v8, 0
k3ns_106:
v_mov_b32 v45, s72
s_add_u32 s76, s68, 64
s_cmp_lt_u32 s71, s76
s_cbranch_scc0 gwek3_108
gwk3_107:
v_readlane_b32 s72, v9, s70
s_add_u32 s70, s70, 1
s_sub_u32 s77, s71, s68
s_max_i32 s77, s77, 0
v_readlane_b32 s71, v8, s70
s_lshl_b64 exec, -1, s77
v_mov_b32 v45, s72
s_cmp_lt_u32 s71, s76
s_cbranch_scc1 gwk3_107
s_mov_b64 exec, -1
gwek3_108:
v_add3_u32 v45, v45, s68, v3
s_add_u32 s68, s68, 64
v_lshlrev_b32 v45, 4, v45
buffer_load_dwordx4 v[32:35], v45, s[8:11], 0 offen nt
s_lshl_b32 s3, s56, 4
v_lshrrev_b32 v56, 2, v0
v_lshlrev_b32 v56, 12, v56
v_and_b32 v57, 3, v0
v_lshlrev_b32 v57, 2, v57
v_or3_b32 v56, v56, v57, s3
v_cmp_gt_u32 vcc, 784, v0
v_mov_b32 v57, 0x0fffffff
s_nop 0
v_cndmask_b32 v56, v57, v56, vcc
v_lshlrev_b32 v57, 1, v56
v_lshlrev_b32 v56, 3, v56
buffer_load_dwordx4 v[16:19], v56, s[24:27], 0 offen
buffer_load_dwordx4 v[20:23], v56, s[24:27], 0 offen offset:16
buffer_load_dwordx2 v[24:25], v57, s[28:31], 0 offen
s_waitcnt lgkmcnt(0)
s_load_dwordx4 s[20:23], s[52:53], 0
s_load_dwordx8 s[12:19], s[62:63], 0
s_load_dwordx8 s[24:31], s[78:79], 0
s_load_dwordx16 s[80:95], s[54:55], 0
s_load_dwordx16 s[36:51], s[58:59], 0
s_cmp_lg_u32 s64, 0
s_cbranch_scc1 k3_fallback
s_mov_b32 s75, 0
k3_loop:
s_cmp_eq_u32 s69, 0
s_cbranch_scc1 k3g_111
s_cmp_lt_u32 s68, s66
s_cbranch_scc0 k3n_109
k3g_111:
s_cmp_lt_u32 s68, s66
s_cbranch_scc1 k3ns_112
s_cmp_lg_u32 s69, 0
s_cbranch_scc1 k3ns_112
v_mov_b32 v8, v10
v_mov_b32 v9, v11
s_mov_b32 s66, s67
s_mov_b32 s68, 0
s_mov_b32 s69, 1
s_mov_b32 s70, 0
v_readlane_b32 s71, v8, 0
k3ns_112:
v_mov_b32 v44, s72
s_add_u32 s76, s68, 64
s_cmp_lt_u32 s71, s76
s_cbranch_scc0 gwek3_114
gwk3_113:
v_readlane_b32 s72, v9, s70
s_add_u32 s70, s70, 1
s_sub_u32 s77, s71, s68
s_max_i32 s77, s77, 0
v_readlane_b32 s71, v8, s70
s_lshl_b64 exec, -1, s77
v_mov_b32 v44, s72
s_cmp_lt_u32 s71, s76
s_cbranch_scc1 gwk3_113
s_mov_b64 exec, -1
gwek3_114:
v_add3_u32 v44, v44, s68, v3
s_add_u32 s68, s68, 64
v_lshlrev_b32 v44, 4, v44
buffer_load_dwordx4 v[36:39], v44, s[8:11], 0 offen nt
s_cmp_lt_u32 s68, s66
s_cbranch_scc1 k3ns_115
s_cmp_lg_u32 s69, 0
s_cbranch_scc1 k3ns_115
v_mov_b32 v8, v10
v_mov_b32 v9, v11
s_mov_b32 s66, s67
s_mov_b32 s68, 0
s_mov_b32 s69, 1
s_mov_b32 s70, 0
v_readlane_b32 s71, v8, 0
k3ns_115:
v_mov_b32 v45, s72
s_add_u32 s76, s68, 64
s_cmp_lt_u32 s71, s76
s_cbranch_scc0 gwek3_117
gwk3_116:
v_readlane_b32 s72, v9, s70
s_add_u32 s70, s70, 1
s_sub_u32 s77, s71, s68
s_max_i32 s77, s77, 0
v_readlane_b32 s71, v8, s70
s_lshl_b64 exec, -1, s77
v_mov_b32 v45, s72
s_cmp_lt_u32 s71, s76
s_cbranch_scc1 gwk3_116
s_mov_b64 exec, -1
gwek3_117:
v_add3_u32 v45, v45, s68, v3
s_add_u32 s68, s68, 64
v_lshlrev_b32 v45, 4, v45
buffer_load_dwordx4 v[40:43], v45, s[8:11], 0 offen nt
s_waitcnt vmcnt(2)
s_branch k3j_110
k3n_109:
s_add_u32 s75, s75, 1
s_waitcnt vmcnt(0)
k3j_110:
v_cmp_eq_u64 vcc, 0, v[28:29]
v_and_b32 v52, s73, v28
v_and_b32 v53, s73, v29
v_lshl_or_b32 v52, v53, 6, v52
v_and_b32 v53, 0xffff, v52
v_lshrrev_b32 v52, 10, v52
v_lshl_or_b32 v54, v53, 3, v52
v_and_b32 v52, s74, v28
v_and_b32 v53, s74, v29
v_cndmask_b32 v54, v54, v15, vcc
v_fma_mix_f32 v56, v52, v14, 0 op_sel:[0,0,0] op_sel_hi:[1,0,0]
v_fma_mix_f32 v57, v52, v14, 0 op_sel:[1,0,0] op_sel_hi:[1,0,0]
v_fma_mix_f32 v58, v53, v14, 0 op_sel:[0,0,0] op_sel_hi:[1,0,0]
v_fma_mix_f32 v59, v53, v14, 0 op_sel:[1,0,0] op_sel_hi:[1,0,0]
v_cvt_i32_f32 v56, v56
v_cvt_i32_f32 v57, v57
v_cvt_i32_f32 v58, v58
v_cvt_i32_f32 v59, v59
v_lshrrev_b32 v55, 1, v54
v_ashrrev_i32 v52, 31, v56
v_ashrrev_i32 v53, 31, v58
v_add_u32 v57, v57, v52
v_add_u32 v59, v59, v53
ds_add_u64 v54, v[56:57]
ds_add_u64 v54, v[58:59] offset:25088
ds_add_u32 v55, v12 offset:50176
v_cmp_eq_u64 vcc, 0, v[30:31]
v_and_b32 v60, s73, v30
v_and_b32 v61, s73, v31
v_lshl_or_b32 v60, v61, 6, v60
v_and_b32 v61, 0xffff, v60
v_lshrrev_b32 v60, 10, v60
v_lshl_or_b32 v62, v61, 3, v60
v_and_b32 v60, s74, v30
v_and_b32 v61, s74, v31
v_cndmask_b32 v62, v62, v15, vcc
v_fma_mix_f32 v64, v60, v14, 0 op_sel:[0,0,0] op_sel_hi:[1,0,0]
v_fma_mix_f32 v65, v60, v14, 0 op_sel:[1,0,0] op_sel_hi:[1,0,0]
v_fma_mix_f32 v66, v61, v14, 0 op_sel:[0,0,0] op_sel_hi:[1,0,0]
v_fma_mix_f32 v67, v61, v14, 0 op_sel:[1,0,0] op_sel_hi:[1,0,0]
v_cvt_i32_f32 v64, v64
v_cvt_i32_f32 v65, v65
v_cvt_i32_f32 v66, v66
v_cvt_i32_f32 v67, v67
v_lshrrev_b32 v63, 1, v62
v_ashrrev_i32 v60, 31, v64
v_ashrrev_i32 v61, 31, v66
v_add_u32 v65, v65, v60
v_add_u32 v67, v67, v61
ds_add_u64 v62, v[64:65]
ds_add_u64 v62, v[66:67] offset:25088
ds_add_u32 v63, v12 offset:50176
v_cmp_eq_u64 vcc, 0, v[32:33]
v_and_b32 v52, s73, v32
v_and_b32 v53, s73, v33
v_lshl_or_b32 v52, v53, 6, v52
v_and_b32 v53, 0xffff, v52
v_lshrrev_b32 v52, 10, v52
v_lshl_or_b32 v54, v53, 3, v52
v_and_b32 v52, s74, v32
v_and_b32 v53, s74, v33
v_cndmask_b32 v54, v54, v15, vcc
v_fma_mix_f32 v56, v52, v14, 0 op_sel:[0,0,0] op_sel_hi:[1,0,0]
v_fma_mix_f32 v57, v52, v14, 0 op_sel:[1,0,0] op_sel_hi:[1,0,0]
v_fma_mix_f32 v58, v53, v14, 0 op_sel:[0,0,0] op_sel_hi:[1,0,0]
v_fma_mix_f32 v59, v53, v14, 0 op_sel:[1,0,0] op_sel_hi:[1,0,0]
v_cvt_i32_f32 v56, v56
v_cvt_i32_f32 v57, v57
v_cvt_i32_f32 v58, v58
v_cvt_i32_f32 v59, v59
v_lshrrev_b32 v55, 1, v54
v_ashrrev_i32 v52, 31, v56
v_ashrrev_i32 v53, 31, v58
v_add_u32 v57, v57, v52
v_add_u32 v59, v59, v53
ds_add_u64 v54, v[56:57]
ds_add_u64 v54, v[58:59] offset:25088
ds_add_u32 v55, v12 offset:50176
v_cmp_eq_u64 vcc, 0, v[34:35]
v_and_b32 v60, s73, v34
v_and_b32 v61, s73, v35
v_lshl_or_b32 v60, v61, 6, v60
v_and_b32 v61, 0xffff, v60
v_lshrrev_b32 v60, 10, v60
v_lshl_or_b32 v62, v61, 3, v60
v_and_b32 v60, s74, v34
v_and_b32 v61, s74, v35
v_cndmask_b32 v62, v62, v15, vcc
v_fma_mix_f32 v64, v60, v14, 0 op_sel:[0,0,0] op_sel_hi:[1,0,0]
v_fma_mix_f32 v65, v60, v14, 0 op_sel:[1,0,0] op_sel_hi:[1,0,0]
v_fma_mix_f32 v66, v61, v14, 0 op_sel:[0,0,0] op_sel_hi:[1,0,0]
v_fma_mix_f32 v67, v61, v14, 0 op_sel:[1,0,0] op_sel_hi:[1,0,0]
v_cvt_i32_f32 v64, v64
v_cvt_i32_f32 v65, v65
v_cvt_i32_f32 v66, v66
v_cvt_i32_f32 v67, v67
v_lshrrev_b32 v63, 1, v62
v_ashrrev_i32 v60, 31, v64
v_ashrrev_i32 v61, 31, v66
v_add_u32 v65, v65, v60
v_add_u32 v67, v67, v61
ds_add_u64 v62, v[64:65]
ds_add_u64 v62, v[66:67] offset:25088
ds_add_u32 v63, v12 offset:50176
s_cmp_ge_u32 s75, 1
s_cbranch_scc1 k3_done
s_cmp_eq_u32 s69, 0
s_cbranch_scc1 k3g_120
s_cmp_lt_u32 s68, s66
s_cbranch_scc0 k3n_118
k3g_120:
s_cmp_lt_u32 s68, s66
s_cbranch_scc1 k3ns_121
s_cmp_lg_u32 s69, 0
s_cbranch_scc1 k3ns_121
v_mov_b32 v8, v10
v_mov_b32 v9, v11
s_mov_b32 s66, s67
s_mov_b32 s68, 0
s_mov_b32 s69, 1
s_mov_b32 s70, 0
v_readlane_b32 s71, v8, 0
k3ns_121:
v_mov_b32 v44, s72
s_add_u32 s76, s68, 64
s_cmp_lt_u32 s71, s76
s_cbranch_scc0 gwek3_123
gwk3_122:
v_readlane_b32 s72, v9, s70
s_add_u32 s70, s70, 1
s_sub_u32 s77, s71, s68
s_max_i32 s77, s77, 0
v_readlane_b32 s71, v8, s70
s_lshl_b64 exec, -1, s77
v_mov_b32 v44, s72
s_cmp_lt_u32 s71, s76
s_cbranch_scc1 gwk3_122
s_mov_b64 exec, -1
gwek3_123:
v_add3_u32 v44, v44, s68, v3
s_add_u32 s68, s68, 64
v_lshlrev_b32 v44, 4, v44
buffer_load_dwordx4 v[28:31], v44, s[8:11], 0 offen nt
s_cmp_lt_u32 s68, s66
s_cbranch_scc1 k3ns_124
s_cmp_lg_u32 s69, 0
s_cbranch_scc1 k3ns_124
v_mov_b32 v8, v10
v_mov_b32 v9, v11
s_mov_b32 s66, s67
s_mov_b32 s68, 0
s_mov_b32 s69, 1
s_mov_b32 s70, 0
v_readlane_b32 s71, v8, 0
k3ns_124:
v_mov_b32 v45, s72
s_add_u32 s76, s68, 64
s_cmp_lt_u32 s71, s76
s_cbranch_scc0 gwek3_126
gwk3_125:
v_readlane_b32 s72, v9, s70
s_add_u32 s70, s70, 1
s_sub_u32 s77, s71, s68
s_max_i32 s77, s77, 0
v_readlane_b32 s71, v8, s70
s_lshl_b64 exec, -1, s77
v_mov_b32 v45, s72
s_cmp_lt_u32 s71, s76
s_cbranch_scc1 gwk3_125
s_mov_b64 exec, -1
gwek3_126:
v_add3_u32 v45, v45, s68, v3
s_add_u32 s68, s68, 64
v_lshlrev_b32 v45, 4, v45
buffer_load_dwordx4 v[32:35], v45, s[8:11], 0 offen nt
s_waitcnt vmcnt(2)
s_branch k3j_119
k3n_118:
s_add_u32 s75, s75, 1
s_waitcnt vmcnt(0)
k3j_119:
v_cmp_eq_u64 vcc, 0, v[36:37]
v_and_b32 v52, s73, v36
v_and_b32 v53, s73, v37
v_lshl_or_b32 v52, v53, 6, v52
v_and_b32 v53, 0xffff, v52
v_lshrrev_b32 v52, 10, v52
v_lshl_or_b32 v54, v53, 3, v52
v_and_b32 v52, s74, v36
v_and_b32 v53, s74, v37
v_cndmask_b32 v54, v54, v15, vcc
v_fma_mix_f32 v56, v52, v14, 0 op_sel:[0,0,0] op_sel_hi:[1,0,0]
v_fma_mix_f32 v57, v52, v14, 0 op_sel:[1,0,0] op_sel_hi:[1,0,0]
v_fma_mix_f32 v58, v53, v14, 0 op_sel:[0,0,0] op_sel_hi:[1,0,0]
v_fma_mix_f32 v59, v53, v14, 0 op_sel:[1,0,0] op_sel_hi:[1,0,0]
v_cvt_i32_f32 v56, v56
v_cvt_i32_f32 v57, v57
v_cvt_i32_f32 v58, v58
v_cvt_i32_f32 v59, v59
v_lshrrev_b32 v55, 1, v54
v_ashrrev_i32 v52, 31, v56
v_ashrrev_i32 v53, 31, v58
v_add_u32 v57, v57, v52
v_add_u32 v59, v59, v53
ds_add_u64 v54, v[56:57]
ds_add_u64 v54, v[58:59] offset:25088
ds_add_u32 v55, v12 offset:50176
v_cmp_eq_u64 vcc, 0, v[38:39]
v_and_b32 v60, s73, v38
v_and_b32 v61, s73, v39
v_lshl_or_b32 v60, v61, 6, v60
v_and_b32 v61, 0xffff, v60
v_lshrrev_b32 v60, 10, v60
v_lshl_or_b32 v62, v61, 3, v60
v_and_b32 v60, s74, v38
v_and_b32 v61, s74, v39
v_cndmask_b32 v62, v62, v15, vcc
v_fma_mix_f32 v64, v60, v14, 0 op_sel:[0,0,0] op_sel_hi:[1,0,0]
v_fma_mix_f32 v65, v60, v14, 0 op_sel:[1,0,0] op_sel_hi:[1,0,0]
v_fma_mix_f32 v66, v61, v14, 0 op_sel:[0,0,0] op_sel_hi:[1,0,0]
v_fma_mix_f32 v67, v61, v14, 0 op_sel:[1,0,0] op_sel_hi:[1,0,0]
v_cvt_i32_f32 v64, v64
v_cvt_i32_f32 v65, v65
v_cvt_i32_f32 v66, v66
v_cvt_i32_f32 v67, v67
v_lshrrev_b32 v63, 1, v62
v_ashrrev_i32 v60, 31, v64
v_ashrrev_i32 v61, 31, v66
v_add_u32 v65, v65, v60
v_add_u32 v67, v67, v61
ds_add_u64 v62, v[64:65]
ds_add_u64 v62, v[66:67] offset:25088
ds_add_u32 v63, v12 offset:50176
v_cmp_eq_u64 vcc, 0, v[40:41]
v_and_b32 v52, s73, v40
v_and_b32 v53, s73, v41
v_lshl_or_b32 v52, v53, 6, v52
v_and_b32 v53, 0xffff, v52
v_lshrrev_b32 v52, 10, v52
v_lshl_or_b32 v54, v53, 3, v52
v_and_b32 v52, s74, v40
v_and_b32 v53, s74, v41
v_cndmask_b32 v54, v54, v15, vcc
v_fma_mix_f32 v56, v52, v14, 0 op_sel:[0,0,0] op_sel_hi:[1,0,0]
v_fma_mix_f32 v57, v52, v14, 0 op_sel:[1,0,0] op_sel_hi:[1,0,0]
v_fma_mix_f32 v58, v53, v14, 0 op_sel:[0,0,0] op_sel_hi:[1,0,0]
v_fma_mix_f32 v59, v53, v14, 0 op_sel:[1,0,0] op_sel_hi:[1,0,0]
v_cvt_i32_f32 v56, v56
v_cvt_i32_f32 v57, v57
v_cvt_i32_f32 v58, v58
v_cvt_i32_f32 v59, v59
v_lshrrev_b32 v55, 1, v54
v_ashrrev_i32 v52, 31, v56
v_ashrrev_i32 v53, 31, v58
v_add_u32 v57, v57, v52
v_add_u32 v59, v59, v53
ds_add_u64 v54, v[56:57]
ds_add_u64 v54, v[58:59] offset:25088
ds_add_u32 v55, v12 offset:50176
v_cmp_eq_u64 vcc, 0, v[42:43]
v_and_b32 v60, s73, v42
v_and_b32 v61, s73, v43
v_lshl_or_b32 v60, v61, 6, v60
v_and_b32 v61, 0xffff, v60
v_lshrrev_b32 v60, 10, v60
v_lshl_or_b32 v62, v61, 3, v60
v_and_b32 v60, s74, v42
v_and_b32 v61, s74, v43
v_cndmask_b32 v62, v62, v15, vcc
v_fma_mix_f32 v64, v60, v14, 0 op_sel:[0,0,0] op_sel_hi:[1,0,0]
v_fma_mix_f32 v65, v60, v14, 0 op_sel:[1,0,0] op_sel_hi:[1,0,0]
v_fma_mix_f32 v66, v61, v14, 0 op_sel:[0,0,0] op_sel_hi:[1,0,0]
v_fma_mix_f32 v67, v61, v14, 0 op_sel:[1,0,0] op_sel_hi:[1,0,0]
v_cvt_i32_f32 v64, v64
v_cvt_i32_f32 v65, v65
v_cvt_i32_f32 v66, v66
v_cvt_i32_f32 v67, v67
v_lshrrev_b32 v63, 1, v62
v_ashrrev_i32 v60, 31, v64
v_ashrrev_i32 v61, 31, v66
v_add_u32 v65, v65, v60
v_add_u32 v67, v67, v61
ds_add_u64 v62, v[64:65]
ds_add_u64 v62, v[66:67] offset:25088
ds_add_u32 v63, v12 offset:50176
s_cmp_ge_u32 s75, 1
s_cbranch_scc1 k3_done
s_branch k3_loop
k3_done:
s_mov_b32 s65, 0
s_waitcnt vmcnt(0) lgkmcnt(0)
s_barrier
s_branch k3_fin
k3_fallback:
s_waitcnt vmcnt(0) lgkmcnt(0)
s_barrier
v_add_u32 v44, 0, v1
ds_write_b128 v44, v[4:7]
v_add_u32 v44, 16384, v1
ds_write_b128 v44, v[4:7]
v_add_u32 v44, 32768, v1
ds_write_b128 v44, v[4:7]
v_add_u32 v44, 49152, v1
ds_write_b128 v44, v[4:7]
v_add_u32 v44, 65536, v1
ds_write_b128 v44, v[4:7]
v_add_u32 v44, 81920, v1
ds_write_b128 v44, v[4:7]
v_add_u32 v44, 98304, v1
v_cmp_gt_u32 vcc, 128, v0
s_nop 1
v_cndmask_b32 v44, v15, v44, vcc
ds_write_b128 v44, v[4:7]
v_mov_b32 v44, 100352
ds_write_b32 v44, v4
s_load_dwordx2 s[66:67], s[0:1], 8
s_load_dwordx2 s[68:69], s[0:1], 16
s_load_dwordx2 s[70:71], s[0:1], 32
s_load_dwordx2 s[72:73], s[0:1], 48
s_load_dwordx2 s[74:75], s[0:1], 0
s_waitcnt lgkmcnt(0)
s_load_dword s76, s[72:73], 0
s_mov_b32 s36, s66
s_and_b32 s37, s67, 0xffff
s_mov_b32 s38, 102400000
s_mov_b32 s39, 0x00020000
s_mov_b32 s40, s68
s_and_b32 s41, s69, 0xffff
s_mov_b32 s42, 102400000
s_mov_b32 s43, 0x00020000
s_mov_b32 s44, s70
s_and_b32 s45, s71, 0xffff
s_mov_b32 s46, 51200000
s_mov_b32 s47, 0x00020000
s_mov_b32 s24, s74
s_and_b32 s25, s75, 0xffff
s_mov_b32 s26, 6400000
s_mov_b32 s27, 0x00020000
s_waitcnt lgkmcnt(0)
s_barrier
s_lshl_b32 s76, s76, 16
v_mov_b32 v44, 0x3e22f983
v_mul_f32 v44, s76, v44
s_lshl_b32 s75, s60, 23
v_mov_b32 v45, s75
v_mov_b32 v55, 0x47800000
s_mov_b32 s76, 0
v_lshlrev_b32 v46, 2, v0
v_lshlrev_b32 v47, 1, v0
k3_fb_loop:
s_lshl_b32 s77, s76, 2
s_lshl_b32 s78, s76, 1
buffer_load_dword v48, v46, s[40:43], s77 offen
buffer_load_dword v49, v46, s[36:39], s77 offen
buffer_load_ushort v50, v47, s[44:47], s78 offen
s_waitcnt vmcnt(0)
v_bfe_u32 v51, v48, 4, 8
v_cmp_eq_u32 vcc, s56, v51
s_nop 1
s_and_saveexec_b64 s[62:63], vcc
s_cbranch_execz k3_fb_skip
v_lshlrev_b32 v49, 3, v49
buffer_load_dwordx2 v[52:53], v49, s[24:27], 0 offen
v_lshlrev_b32 v50, 16, v50
v_mul_f32 v50, v44, v50
v_fract_f32 v50, v50
v_cos_f32 v50, v50
v_lshrrev_b32 v51, 8, v48
v_bfi_b32 v51, 15, v48, v51
v_lshlrev_b32 v51, 3, v51
v_mul_f32 v50, v50, v55
v_add_u32 v54, 50176, v51
s_waitcnt vmcnt(0)
v_lshlrev_b32 v56, 16, v52
v_and_b32 v58, 0xffff0000, v52
v_lshlrev_b32 v60, 16, v53
v_and_b32 v62, 0xffff0000, v53
v_mul_f32 v56, v45, v56
v_mul_f32 v58, v45, v58
v_mul_f32 v60, v45, v60
v_mul_f32 v62, v45, v62
v_mul_f32 v56, v50, v56
v_mul_f32 v58, v50, v58
v_mul_f32 v60, v50, v60
v_mul_f32 v62, v50, v62
v_cvt_i32_f32 v56, v56
v_cvt_i32_f32 v58, v58
v_cvt_i32_f32 v60, v60
v_cvt_i32_f32 v62, v62
v_ashrrev_i32 v57, 31, v56
v_ashrrev_i32 v59, 31, v58
v_ashrrev_i32 v61, 31, v60
v_ashrrev_i32 v63, 31, v62
ds_add_u64 v51, v[56:57]
ds_add_u64 v51, v[58:59] offset:25088
ds_add_u64 v54, v[60:61]
ds_add_u64 v54, v[62:63] offset:25088
k3_fb_skip:
s_mov_b64 exec, s[62:63]
s_add_u32 s76, s76, 1024
s_cmp_lt_u32 s76, 25600000
s_cbranch_scc1 k3_fb_loop
s_load_dwordx2 s[52:53], s[0:1], 40
s_load_dwordx2 s[54:55], s[0:1], 56
s_load_dwordx2 s[58:59], s[0:1], 64
s_load_dwordx2 s[62:63], s[0:1], 72
s_load_dwordx2 s[78:79], s[0:1], 80
s_waitcnt vmcnt(0) lgkmcnt(0)
s_load_dwordx4 s[20:23], s[52:53], 0
s_load_dwordx8 s[12:19], s[62:63], 0
s_load_dwordx8 s[24:31], s[78:79], 0
s_load_dwordx16 s[80:95], s[54:55], 0
s_load_dwordx16 s[36:51], s[58:59], 0
s_mov_b32 s65, 1
s_waitcnt lgkmcnt(0)
s_barrier
k3_fin:
s_mov_b32 s61, 238
s_cmp_eq_u32 s65, 0
s_cselect_b32 s61, 246, s61
s_sub_u32 s61, s61, s60
s_max_i32 s61, s61, 1
s_lshl_b32 s61, s61, 23
s_mov_b32 s98, 0xc166d4ca
v_cmp_gt_u32 vcc, 784, v0
s_nop 1
s_and_saveexec_b64 s[62:63], vcc
s_cbranch_execz k3_fin_skip
v_lshlrev_b32 v108, 5, v0
s_cmp_lg_u32 s65, 0
s_cbranch_scc1 fm1_127
v_lshlrev_b32 v109, 4, v0
ds_read_b128 v[44:47], v108
ds_read_b128 v[48:51], v108 offset:16
ds_read_b128 v[52:55], v108 offset:25088
ds_read_b128 v[56:59], v108 offset:25104
ds_read_b128 v[60:63], v109 offset:50176
s_waitcnt lgkmcnt(0)
v_max3_u32 v110, v60, v61, v62
v_max_u32 v110, v110, v63
v_cmp_lt_u32 vcc, 255, v110
v_mov_b32 v111, 100352
s_nop 0
v_cndmask_b32 v111, v15, v111, vcc
ds_write_b32 v111, v12
v_ashrrev_i32 v112, 31, v44
v_sub_u32 v45, v45, v112
v_cvt_f32_i32 v28, v44
v_cvt_f32_i32 v32, v45
v_ashrrev_i32 v112, 31, v52
v_sub_u32 v53, v53, v112
v_cvt_f32_i32 v36, v52
v_cvt_f32_i32 v40, v53
v_ashrrev_i32 v112, 31, v46
v_sub_u32 v47, v47, v112
v_cvt_f32_i32 v29, v46
v_cvt_f32_i32 v33, v47
v_ashrrev_i32 v112, 31, v54
v_sub_u32 v55, v55, v112
v_cvt_f32_i32 v37, v54
v_cvt_f32_i32 v41, v55
v_ashrrev_i32 v112, 31, v48
v_sub_u32 v49, v49, v112
v_cvt_f32_i32 v30, v48
v_cvt_f32_i32 v34, v49
v_ashrrev_i32 v112, 31, v56
v_sub_u32 v57, v57, v112
v_cvt_f32_i32 v38, v56
v_cvt_f32_i32 v42, v57
v_ashrrev_i32 v112, 31, v50
v_sub_u32 v51, v51, v112
v_cvt_f32_i32 v31, v50
v_cvt_f32_i32 v35, v51
v_ashrrev_i32 v112, 31, v58
v_sub_u32 v59, v59, v112
v_cvt_f32_i32 v39, v58
v_cvt_f32_i32 v43, v59
s_branch fmj_128
fm1_127:
v_add_u32 v109, 50176, v108
ds_read_b128 v[44:47], v108 offset:0
ds_read_b128 v[48:51], v108 offset:16
s_waitcnt lgkmcnt(0)
v_cvt_f32_i32 v28, v45
v_cvt_f32_u32 v112, v44
v_mov_b32 v113, 0x4f800000
v_fma_f32 v28, v28, v113, v112
v_cvt_f32_i32 v29, v47
v_cvt_f32_u32 v112, v46
v_mov_b32 v113, 0x4f800000
v_fma_f32 v29, v29, v113, v112
v_cvt_f32_i32 v30, v49
v_cvt_f32_u32 v112, v48
v_mov_b32 v113, 0x4f800000
v_fma_f32 v30, v30, v113, v112
v_cvt_f32_i32 v31, v51
v_cvt_f32_u32 v112, v50
v_mov_b32 v113, 0x4f800000
v_fma_f32 v31, v31, v113, v112
ds_read_b128 v[44:47], v108 offset:25088
ds_read_b128 v[48:51], v108 offset:25104
s_waitcnt lgkmcnt(0)
v_cvt_f32_i32 v32, v45
v_cvt_f32_u32 v112, v44
v_mov_b32 v113, 0x4f800000
v_fma_f32 v32, v32, v113, v112
v_cvt_f32_i32 v33, v47
v_cvt_f32_u32 v112, v46
v_mov_b32 v113, 0x4f800000
v_fma_f32 v33, v33, v113, v112
v_cvt_f32_i32 v34, v49
v_cvt_f32_u32 v112, v48
v_mov_b32 v113, 0x4f800000
v_fma_f32 v34, v34, v113, v112
v_cvt_f32_i32 v35, v51
v_cvt_f32_u32 v112, v50
v_mov_b32 v113, 0x4f800000
v_fma_f32 v35, v35, v113, v112
ds_read_b128 v[44:47], v109 offset:0
ds_read_b128 v[48:51], v109 offset:16
s_waitcnt lgkmcnt(0)
v_cvt_f32_i32 v36, v45
v_cvt_f32_u32 v112, v44
v_mov_b32 v113, 0x4f800000
v_fma_f32 v36, v36, v113, v112
v_cvt_f32_i32 v37, v47
v_cvt_f32_u32 v112, v46
v_mov_b32 v113, 0x4f800000
v_fma_f32 v37, v37, v113, v112
v_cvt_f32_i32 v38, v49
v_cvt_f32_u32 v112, v48
v_mov_b32 v113, 0x4f800000
v_fma_f32 v38, v38, v113, v112
v_cvt_f32_i32 v39, v51
v_cvt_f32_u32 v112, v50
v_mov_b32 v113, 0x4f800000
v_fma_f32 v39, v39, v113, v112
ds_read_b128 v[44:47], v109 offset:25088
ds_read_b128 v[48:51], v109 offset:25104
s_waitcnt lgkmcnt(0)
v_cvt_f32_i32 v40, v45
v_cvt_f32_u32 v112, v44
v_mov_b32 v113, 0x4f800000
v_fma_f32 v40, v40, v113, v112
v_cvt_f32_i32 v41, v47
v_cvt_f32_u32 v112, v46
v_mov_b32 v113, 0x4f800000
v_fma_f32 v41, v41, v113, v112
v_cvt_f32_i32 v42, v49
v_cvt_f32_u32 v112, v48
v_mov_b32 v113, 0x4f800000
v_fma_f32 v42, v42, v113, v112
v_cvt_f32_i32 v43, v51
v_cvt_f32_u32 v112, v50
v_mov_b32 v113, 0x4f800000
v_fma_f32 v43, v43, v113, v112
fmj_128:
s_mov_b32 s100, s61
v_pk_mul_f32 v[28:29], v[28:29], s[100:101] op_sel_hi:[1,0]
v_pk_mul_f32 v[30:31], v[30:31], s[100:101] op_sel_hi:[1,0]
v_pk_mul_f32 v[32:33], v[32:33], s[100:101] op_sel_hi:[1,0]
v_pk_mul_f32 v[34:35], v[34:35], s[100:101] op_sel_hi:[1,0]
v_pk_mul_f32 v[36:37], v[36:37], s[100:101] op_sel_hi:[1,0]
v_pk_mul_f32 v[38:39], v[38:39], s[100:101] op_sel_hi:[1,0]
v_pk_mul_f32 v[40:41], v[40:41], s[100:101] op_sel_hi:[1,0]
v_pk_mul_f32 v[42:43], v[42:43], s[100:101] op_sel_hi:[1,0]
v_lshlrev_b32 v112, 16, v24
v_and_b32 v113, 0xffff0000, v24
v_lshlrev_b32 v114, 16, v25
v_and_b32 v115, 0xffff0000, v25
s_lshl_b32 s100, s20, 16
v_pk_add_f32 v[44:45], v[112:113], s[100:101] op_sel_hi:[1,0] neg_lo:[0,1] neg_hi:[0,1]
v_pk_add_f32 v[46:47], v[114:115], s[100:101] op_sel_hi:[1,0] neg_lo:[0,1] neg_hi:[0,1]
v_pk_mul_f32 v[44:45], v[44:45], v[44:45]
v_pk_mul_f32 v[46:47], v[46:47], v[46:47]
v_pk_mul_f32 v[44:45], v[44:45], s[98:99] op_sel_hi:[1,0]
v_pk_mul_f32 v[46:47], v[46:47], s[98:99] op_sel_hi:[1,0]
v_exp_f32 v44, v44
v_exp_f32 v45, v45
v_exp_f32 v46, v46
v_exp_f32 v47, v47
s_and_b32 s100, s20, 0xffff0000
v_pk_add_f32 v[48:49], v[112:113], s[100:101] op_sel_hi:[1,0] neg_lo:[0,1] neg_hi:[0,1]
v_pk_add_f32 v[50:51], v[114:115], s[100:101] op_sel_hi:[1,0] neg_lo:[0,1] neg_hi:[0,1]
v_pk_mul_f32 v[48:49], v[48:49], v[48:49]
v_pk_mul_f32 v[50:51], v[50:51], v[50:51]
v_pk_mul_f32 v[48:49], v[48:49], s[98:99] op_sel_hi:[1,0]
v_pk_mul_f32 v[50:51], v[50:51], s[98:99] op_sel_hi:[1,0]
v_exp_f32 v48, v48
v_exp_f32 v49, v49
v_exp_f32 v50, v50
v_exp_f32 v51, v51
s_lshl_b32 s100, s21, 16
v_pk_add_f32 v[52:53], v[112:113], s[100:101] op_sel_hi:[1,0] neg_lo:[0,1] neg_hi:[0,1]
v_pk_add_f32 v[54:55], v[114:115], s[100:101] op_sel_hi:[1,0] neg_lo:[0,1] neg_hi:[0,1]
v_pk_mul_f32 v[52:53], v[52:53], v[52:53]
v_pk_mul_f32 v[54:55], v[54:55], v[54:55]
v_pk_mul_f32 v[52:53], v[52:53], s[98:99] op_sel_hi:[1,0]
v_pk_mul_f32 v[54:55], v[54:55], s[98:99] op_sel_hi:[1,0]
v_exp_f32 v52, v52
v_exp_f32 v53, v53
v_exp_f32 v54, v54
v_exp_f32 v55, v55
s_and_b32 s100, s21, 0xffff0000
v_pk_add_f32 v[56:57], v[112:113], s[100:101] op_sel_hi:[1,0] neg_lo:[0,1] neg_hi:[0,1]
v_pk_add_f32 v[58:59], v[114:115], s[100:101] op_sel_hi:[1,0] neg_lo:[0,1] neg_hi:[0,1]
v_pk_mul_f32 v[56:57], v[56:57], v[56:57]
v_pk_mul_f32 v[58:59], v[58:59], v[58:59]
v_pk_mul_f32 v[56:57], v[56:57], s[98:99] op_sel_hi:[1,0]
v_pk_mul_f32 v[58:59], v[58:59], s[98:99] op_sel_hi:[1,0]
v_exp_f32 v56, v56
v_exp_f32 v57, v57
v_exp_f32 v58, v58
v_exp_f32 v59, v59
s_lshl_b32 s100, s22, 16
v_pk_add_f32 v[60:61], v[112:113], s[100:101] op_sel_hi:[1,0] neg_lo:[0,1] neg_hi:[0,1]
v_pk_add_f32 v[62:63], v[114:115], s[100:101] op_sel_hi:[1,0] neg_lo:[0,1] neg_hi:[0,1]
v_pk_mul_f32 v[60:61], v[60:61], v[60:61]
v_pk_mul_f32 v[62:63], v[62:63], v[62:63]
v_pk_mul_f32 v[60:61], v[60:61], s[98:99] op_sel_hi:[1,0]
v_pk_mul_f32 v[62:63], v[62:63], s[98:99] op_sel_hi:[1,0]
v_exp_f32 v60, v60
v_exp_f32 v61, v61
v_exp_f32 v62, v62
v_exp_f32 v63, v63
s_and_b32 s100, s22, 0xffff0000
v_pk_add_f32 v[64:65], v[112:113], s[100:101] op_sel_hi:[1,0] neg_lo:[0,1] neg_hi:[0,1]
v_pk_add_f32 v[66:67], v[114:115], s[100:101] op_sel_hi:[1,0] neg_lo:[0,1] neg_hi:[0,1]
v_pk_mul_f32 v[64:65], v[64:65], v[64:65]
v_pk_mul_f32 v[66:67], v[66:67], v[66:67]
v_pk_mul_f32 v[64:65], v[64:65], s[98:99] op_sel_hi:[1,0]
v_pk_mul_f32 v[66:67], v[66:67], s[98:99] op_sel_hi:[1,0]
v_exp_f32 v64, v64
v_exp_f32 v65, v65
v_exp_f32 v66, v66
v_exp_f32 v67, v67
s_lshl_b32 s100, s23, 16
v_pk_add_f32 v[68:69], v[112:113], s[100:101] op_sel_hi:[1,0] neg_lo:[0,1] neg_hi:[0,1]
v_pk_add_f32 v[70:71], v[114:115], s[100:101] op_sel_hi:[1,0] neg_lo:[0,1] neg_hi:[0,1]
v_pk_mul_f32 v[68:69], v[68:69], v[68:69]
v_pk_mul_f32 v[70:71], v[70:71], v[70:71]
v_pk_mul_f32 v[68:69], v[68:69], s[98:99] op_sel_hi:[1,0]
v_pk_mul_f32 v[70:71], v[70:71], s[98:99] op_sel_hi:[1,0]
v_exp_f32 v68, v68
v_exp_f32 v69, v69
v_exp_f32 v70, v70
v_exp_f32 v71, v71
s_and_b32 s100, s23, 0xffff0000
v_pk_add_f32 v[72:73], v[112:113], s[100:101] op_sel_hi:[1,0] neg_lo:[0,1] neg_hi:[0,1]
v_pk_add_f32 v[74:75], v[114:115], s[100:101] op_sel_hi:[1,0] neg_lo:[0,1] neg_hi:[0,1]
v_pk_mul_f32 v[72:73], v[72:73], v[72:73]
v_pk_mul_f32 v[74:75], v[74:75], v[74:75]
v_pk_mul_f32 v[72:73], v[72:73], s[98:99] op_sel_hi:[1,0]
v_pk_mul_f32 v[74:75], v[74:75], s[98:99] op_sel_hi:[1,0]
v_exp_f32 v72, v72
v_exp_f32 v73, v73
v_exp_f32 v74, v74
v_exp_f32 v75, v75
s_lshl_b32 s100, s36, 16
v_pk_mul_f32 v[76:77], v[44:45], s[100:101] op_sel_hi:[1,0]
v_pk_mul_f32 v[78:79], v[46:47], s[100:101] op_sel_hi:[1,0]
s_lshl_b32 s100, s80, 16
v_pk_mul_f32 v[92:93], v[44:45], s[100:101] op_sel_hi:[1,0]
v_pk_mul_f32 v[94:95], v[46:47], s[100:101] op_sel_hi:[1,0]
s_lshl_b32 s100, s38, 16
v_pk_fma_f32 v[76:77], v[48:49], s[100:101], v[76:77] op_sel_hi:[1,0,1]
v_pk_fma_f32 v[78:79], v[50:51], s[100:101], v[78:79] op_sel_hi:[1,0,1]
s_lshl_b32 s100, s82, 16
v_pk_fma_f32 v[92:93], v[48:49], s[100:101], v[92:93] op_sel_hi:[1,0,1]
v_pk_fma_f32 v[94:95], v[50:51], s[100:101], v[94:95] op_sel_hi:[1,0,1]
s_lshl_b32 s100, s40, 16
v_pk_fma_f32 v[76:77], v[52:53], s[100:101], v[76:77] op_sel_hi:[1,0,1]
v_pk_fma_f32 v[78:79], v[54:55], s[100:101], v[78:79] op_sel_hi:[1,0,1]
s_lshl_b32 s100, s84, 16
v_pk_fma_f32 v[92:93], v[52:53], s[100:101], v[92:93] op_sel_hi:[1,0,1]
v_pk_fma_f32 v[94:95], v[54:55], s[100:101], v[94:95] op_sel_hi:[1,0,1]
s_lshl_b32 s100, s42, 16
v_pk_fma_f32 v[76:77], v[56:57], s[100:101], v[76:77] op_sel_hi:[1,0,1]
v_pk_fma_f32 v[78:79], v[58:59], s[100:101], v[78:79] op_sel_hi:[1,0,1]
s_lshl_b32 s100, s86, 16
v_pk_fma_f32 v[92:93], v[56:57], s[100:101], v[92:93] op_sel_hi:[1,0,1]
v_pk_fma_f32 v[94:95], v[58:59], s[100:101], v[94:95] op_sel_hi:[1,0,1]
s_lshl_b32 s100, s44, 16
v_pk_fma_f32 v[76:77], v[60:61], s[100:101], v[76:77] op_sel_hi:[1,0,1]
v_pk_fma_f32 v[78:79], v[62:63], s[100:101], v[78:79] op_sel_hi:[1,0,1]
s_lshl_b32 s100, s88, 16
v_pk_fma_f32 v[92:93], v[60:61], s[100:101], v[92:93] op_sel_hi:[1,0,1]
v_pk_fma_f32 v[94:95], v[62:63], s[100:101], v[94:95] op_sel_hi:[1,0,1]
s_lshl_b32 s100, s46, 16
v_pk_fma_f32 v[76:77], v[64:65], s[100:101], v[76:77] op_sel_hi:[1,0,1]
v_pk_fma_f32 v[78:79], v[66:67], s[100:101], v[78:79] op_sel_hi:[1,0,1]
s_lshl_b32 s100, s90, 16
v_pk_fma_f32 v[92:93], v[64:65], s[100:101], v[92:93] op_sel_hi:[1,0,1]
v_pk_fma_f32 v[94:95], v[66:67], s[100:101], v[94:95] op_sel_hi:[1,0,1]
s_lshl_b32 s100, s48, 16
v_pk_fma_f32 v[76:77], v[68:69], s[100:101], v[76:77] op_sel_hi:[1,0,1]
v_pk_fma_f32 v[78:79], v[70:71], s[100:101], v[78:79] op_sel_hi:[1,0,1]
s_lshl_b32 s100, s92, 16
v_pk_fma_f32 v[92:93], v[68:69], s[100:101], v[92:93] op_sel_hi:[1,0,1]
v_pk_fma_f32 v[94:95], v[70:71], s[100:101], v[94:95] op_sel_hi:[1,0,1]
s_lshl_b32 s100, s50, 16
v_pk_fma_f32 v[76:77], v[72:73], s[100:101], v[76:77] op_sel_hi:[1,0,1]
v_pk_fma_f32 v[78:79], v[74:75], s[100:101], v[78:79] op_sel_hi:[1,0,1]
s_lshl_b32 s100, s94, 16
v_pk_fma_f32 v[92:93], v[72:73], s[100:101], v[92:93] op_sel_hi:[1,0,1]
v_pk_fma_f32 v[94:95], v[74:75], s[100:101], v[94:95] op_sel_hi:[1,0,1]
s_and_b32 s100, s36, 0xffff0000
v_pk_mul_f32 v[80:81], v[44:45], s[100:101] op_sel_hi:[1,0]
v_pk_mul_f32 v[82:83], v[46:47], s[100:101] op_sel_hi:[1,0]
s_and_b32 s100, s80, 0xffff0000
v_pk_mul_f32 v[96:97], v[44:45], s[100:101] op_sel_hi:[1,0]
v_pk_mul_f32 v[98:99], v[46:47], s[100:101] op_sel_hi:[1,0]
s_and_b32 s100, s38, 0xffff0000
v_pk_fma_f32 v[80:81], v[48:49], s[100:101], v[80:81] op_sel_hi:[1,0,1]
v_pk_fma_f32 v[82:83], v[50:51], s[100:101], v[82:83] op_sel_hi:[1,0,1]
s_and_b32 s100, s82, 0xffff0000
v_pk_fma_f32 v[96:97], v[48:49], s[100:101], v[96:97] op_sel_hi:[1,0,1]
v_pk_fma_f32 v[98:99], v[50:51], s[100:101], v[98:99] op_sel_hi:[1,0,1]
s_and_b32 s100, s40, 0xffff0000
v_pk_fma_f32 v[80:81], v[52:53], s[100:101], v[80:81] op_sel_hi:[1,0,1]
v_pk_fma_f32 v[82:83], v[54:55], s[100:101], v[82:83] op_sel_hi:[1,0,1]
s_and_b32 s100, s84, 0xffff0000
v_pk_fma_f32 v[96:97], v[52:53], s[100:101], v[96:97] op_sel_hi:[1,0,1]
v_pk_fma_f32 v[98:99], v[54:55], s[100:101], v[98:99] op_sel_hi:[1,0,1]
s_and_b32 s100, s42, 0xffff0000
v_pk_fma_f32 v[80:81], v[56:57], s[100:101], v[80:81] op_sel_hi:[1,0,1]
v_pk_fma_f32 v[82:83], v[58:59], s[100:101], v[82:83] op_sel_hi:[1,0,1]
s_and_b32 s100, s86, 0xffff0000
v_pk_fma_f32 v[96:97], v[56:57], s[100:101], v[96:97] op_sel_hi:[1,0,1]
v_pk_fma_f32 v[98:99], v[58:59], s[100:101], v[98:99] op_sel_hi:[1,0,1]
s_and_b32 s100, s44, 0xffff0000
v_pk_fma_f32 v[80:81], v[60:61], s[100:101], v[80:81] op_sel_hi:[1,0,1]
v_pk_fma_f32 v[82:83], v[62:63], s[100:101], v[82:83] op_sel_hi:[1,0,1]
s_and_b32 s100, s88, 0xffff0000
v_pk_fma_f32 v[96:97], v[60:61], s[100:101], v[96:97] op_sel_hi:[1,0,1]
v_pk_fma_f32 v[98:99], v[62:63], s[100:101], v[98:99] op_sel_hi:[1,0,1]
s_and_b32 s100, s46, 0xffff0000
v_pk_fma_f32 v[80:81], v[64:65], s[100:101], v[80:81] op_sel_hi:[1,0,1]
v_pk_fma_f32 v[82:83], v[66:67], s[100:101], v[82:83] op_sel_hi:[1,0,1]
s_and_b32 s100, s90, 0xffff0000
v_pk_fma_f32 v[96:97], v[64:65], s[100:101], v[96:97] op_sel_hi:[1,0,1]
v_pk_fma_f32 v[98:99], v[66:67], s[100:101], v[98:99] op_sel_hi:[1,0,1]
s_and_b32 s100, s48, 0xffff0000
v_pk_fma_f32 v[80:81], v[68:69], s[100:101], v[80:81] op_sel_hi:[1,0,1]
v_pk_fma_f32 v[82:83], v[70:71], s[100:101], v[82:83] op_sel_hi:[1,0,1]
s_and_b32 s100, s92, 0xffff0000
v_pk_fma_f32 v[96:97], v[68:69], s[100:101], v[96:97] op_sel_hi:[1,0,1]
v_pk_fma_f32 v[98:99], v[70:71], s[100:101], v[98:99] op_sel_hi:[1,0,1]
s_and_b32 s100, s50, 0xffff0000
v_pk_fma_f32 v[80:81], v[72:73], s[100:101], v[80:81] op_sel_hi:[1,0,1]
v_pk_fma_f32 v[82:83], v[74:75], s[100:101], v[82:83] op_sel_hi:[1,0,1]
s_and_b32 s100, s94, 0xffff0000
v_pk_fma_f32 v[96:97], v[72:73], s[100:101], v[96:97] op_sel_hi:[1,0,1]
v_pk_fma_f32 v[98:99], v[74:75], s[100:101], v[98:99] op_sel_hi:[1,0,1]
s_lshl_b32 s100, s37, 16
v_pk_mul_f32 v[84:85], v[44:45], s[100:101] op_sel_hi:[1,0]
v_pk_mul_f32 v[86:87], v[46:47], s[100:101] op_sel_hi:[1,0]
s_lshl_b32 s100, s81, 16
v_pk_mul_f32 v[100:101], v[44:45], s[100:101] op_sel_hi:[1,0]
v_pk_mul_f32 v[102:103], v[46:47], s[100:101] op_sel_hi:[1,0]
s_lshl_b32 s100, s39, 16
v_pk_fma_f32 v[84:85], v[48:49], s[100:101], v[84:85] op_sel_hi:[1,0,1]
v_pk_fma_f32 v[86:87], v[50:51], s[100:101], v[86:87] op_sel_hi:[1,0,1]
s_lshl_b32 s100, s83, 16
v_pk_fma_f32 v[100:101], v[48:49], s[100:101], v[100:101] op_sel_hi:[1,0,1]
v_pk_fma_f32 v[102:103], v[50:51], s[100:101], v[102:103] op_sel_hi:[1,0,1]
s_lshl_b32 s100, s41, 16
v_pk_fma_f32 v[84:85], v[52:53], s[100:101], v[84:85] op_sel_hi:[1,0,1]
v_pk_fma_f32 v[86:87], v[54:55], s[100:101], v[86:87] op_sel_hi:[1,0,1]
s_lshl_b32 s100, s85, 16
v_pk_fma_f32 v[100:101], v[52:53], s[100:101], v[100:101] op_sel_hi:[1,0,1]
v_pk_fma_f32 v[102:103], v[54:55], s[100:101], v[102:103] op_sel_hi:[1,0,1]
s_lshl_b32 s100, s43, 16
v_pk_fma_f32 v[84:85], v[56:57], s[100:101], v[84:85] op_sel_hi:[1,0,1]
v_pk_fma_f32 v[86:87], v[58:59], s[100:101], v[86:87] op_sel_hi:[1,0,1]
s_lshl_b32 s100, s87, 16
v_pk_fma_f32 v[100:101], v[56:57], s[100:101], v[100:101] op_sel_hi:[1,0,1]
v_pk_fma_f32 v[102:103], v[58:59], s[100:101], v[102:103] op_sel_hi:[1,0,1]
s_lshl_b32 s100, s45, 16
v_pk_fma_f32 v[84:85], v[60:61], s[100:101], v[84:85] op_sel_hi:[1,0,1]
v_pk_fma_f32 v[86:87], v[62:63], s[100:101], v[86:87] op_sel_hi:[1,0,1]
s_lshl_b32 s100, s89, 16
v_pk_fma_f32 v[100:101], v[60:61], s[100:101], v[100:101] op_sel_hi:[1,0,1]
v_pk_fma_f32 v[102:103], v[62:63], s[100:101], v[102:103] op_sel_hi:[1,0,1]
s_lshl_b32 s100, s47, 16
v_pk_fma_f32 v[84:85], v[64:65], s[100:101], v[84:85] op_sel_hi:[1,0,1]
v_pk_fma_f32 v[86:87], v[66:67], s[100:101], v[86:87] op_sel_hi:[1,0,1]
s_lshl_b32 s100, s91, 16
v_pk_fma_f32 v[100:101], v[64:65], s[100:101], v[100:101] op_sel_hi:[1,0,1]
v_pk_fma_f32 v[102:103], v[66:67], s[100:101], v[102:103] op_sel_hi:[1,0,1]
s_lshl_b32 s100, s49, 16
v_pk_fma_f32 v[84:85], v[68:69], s[100:101], v[84:85] op_sel_hi:[1,0,1]
v_pk_fma_f32 v[86:87], v[70:71], s[100:101], v[86:87] op_sel_hi:[1,0,1]
s_lshl_b32 s100, s93, 16
v_pk_fma_f32 v[100:101], v[68:69], s[100:101], v[100:101] op_sel_hi:[1,0,1]
v_pk_fma_f32 v[102:103], v[70:71], s[100:101], v[102:103] op_sel_hi:[1,0,1]
s_lshl_b32 s100, s51, 16
v_pk_fma_f32 v[84:85], v[72:73], s[100:101], v[84:85] op_sel_hi:[1,0,1]
v_pk_fma_f32 v[86:87], v[74:75], s[100:101], v[86:87] op_sel_hi:[1,0,1]
s_lshl_b32 s100, s95, 16
v_pk_fma_f32 v[100:101], v[72:73], s[100:101], v[100:101] op_sel_hi:[1,0,1]
v_pk_fma_f32 v[102:103], v[74:75], s[100:101], v[102:103] op_sel_hi:[1,0,1]
s_and_b32 s100, s37, 0xffff0000
v_pk_mul_f32 v[88:89], v[44:45], s[100:101] op_sel_hi:[1,0]
v_pk_mul_f32 v[90:91], v[46:47], s[100:101] op_sel_hi:[1,0]
s_and_b32 s100, s81, 0xffff0000
v_pk_mul_f32 v[104:105], v[44:45], s[100:101] op_sel_hi:[1,0]
v_pk_mul_f32 v[106:107], v[46:47], s[100:101] op_sel_hi:[1,0]
s_and_b32 s100, s39, 0xffff0000
v_pk_fma_f32 v[88:89], v[48:49], s[100:101], v[88:89] op_sel_hi:[1,0,1]
v_pk_fma_f32 v[90:91], v[50:51], s[100:101], v[90:91] op_sel_hi:[1,0,1]
s_and_b32 s100, s83, 0xffff0000
v_pk_fma_f32 v[104:105], v[48:49], s[100:101], v[104:105] op_sel_hi:[1,0,1]
v_pk_fma_f32 v[106:107], v[50:51], s[100:101], v[106:107] op_sel_hi:[1,0,1]
s_and_b32 s100, s41, 0xffff0000
v_pk_fma_f32 v[88:89], v[52:53], s[100:101], v[88:89] op_sel_hi:[1,0,1]
v_pk_fma_f32 v[90:91], v[54:55], s[100:101], v[90:91] op_sel_hi:[1,0,1]
s_and_b32 s100, s85, 0xffff0000
v_pk_fma_f32 v[104:105], v[52:53], s[100:101], v[104:105] op_sel_hi:[1,0,1]
v_pk_fma_f32 v[106:107], v[54:55], s[100:101], v[106:107] op_sel_hi:[1,0,1]
s_and_b32 s100, s43, 0xffff0000
v_pk_fma_f32 v[88:89], v[56:57], s[100:101], v[88:89] op_sel_hi:[1,0,1]
v_pk_fma_f32 v[90:91], v[58:59], s[100:101], v[90:91] op_sel_hi:[1,0,1]
s_and_b32 s100, s87, 0xffff0000
v_pk_fma_f32 v[104:105], v[56:57], s[100:101], v[104:105] op_sel_hi:[1,0,1]
v_pk_fma_f32 v[106:107], v[58:59], s[100:101], v[106:107] op_sel_hi:[1,0,1]
s_and_b32 s100, s45, 0xffff0000
v_pk_fma_f32 v[88:89], v[60:61], s[100:101], v[88:89] op_sel_hi:[1,0,1]
v_pk_fma_f32 v[90:91], v[62:63], s[100:101], v[90:91] op_sel_hi:[1,0,1]
s_and_b32 s100, s89, 0xffff0000
v_pk_fma_f32 v[104:105], v[60:61], s[100:101], v[104:105] op_sel_hi:[1,0,1]
v_pk_fma_f32 v[106:107], v[62:63], s[100:101], v[106:107] op_sel_hi:[1,0,1]
s_and_b32 s100, s47, 0xffff0000
v_pk_fma_f32 v[88:89], v[64:65], s[100:101], v[88:89] op_sel_hi:[1,0,1]
v_pk_fma_f32 v[90:91], v[66:67], s[100:101], v[90:91] op_sel_hi:[1,0,1]
s_and_b32 s100, s91, 0xffff0000
v_pk_fma_f32 v[104:105], v[64:65], s[100:101], v[104:105] op_sel_hi:[1,0,1]
v_pk_fma_f32 v[106:107], v[66:67], s[100:101], v[106:107] op_sel_hi:[1,0,1]
s_and_b32 s100, s49, 0xffff0000
v_pk_fma_f32 v[88:89], v[68:69], s[100:101], v[88:89] op_sel_hi:[1,0,1]
v_pk_fma_f32 v[90:91], v[70:71], s[100:101], v[90:91] op_sel_hi:[1,0,1]
s_and_b32 s100, s93, 0xffff0000
v_pk_fma_f32 v[104:105], v[68:69], s[100:101], v[104:105] op_sel_hi:[1,0,1]
v_pk_fma_f32 v[106:107], v[70:71], s[100:101], v[106:107] op_sel_hi:[1,0,1]
s_and_b32 s100, s51, 0xffff0000
v_pk_fma_f32 v[88:89], v[72:73], s[100:101], v[88:89] op_sel_hi:[1,0,1]
v_pk_fma_f32 v[90:91], v[74:75], s[100:101], v[90:91] op_sel_hi:[1,0,1]
s_and_b32 s100, s95, 0xffff0000
v_pk_fma_f32 v[104:105], v[72:73], s[100:101], v[104:105] op_sel_hi:[1,0,1]
v_pk_fma_f32 v[106:107], v[74:75], s[100:101], v[106:107] op_sel_hi:[1,0,1]
s_lshl_b32 s100, s12, 16
v_pk_mul_f32 v[44:45], v[28:29], s[100:101] op_sel_hi:[1,0]
v_pk_mul_f32 v[46:47], v[30:31], s[100:101] op_sel_hi:[1,0]
s_lshl_b32 s100, s14, 16
v_pk_fma_f32 v[44:45], v[32:33], s[100:101], v[44:45] op_sel_hi:[1,0,1]
v_pk_fma_f32 v[46:47], v[34:35], s[100:101], v[46:47] op_sel_hi:[1,0,1]
s_lshl_b32 s100, s16, 16
v_pk_fma_f32 v[44:45], v[36:37], s[100:101], v[44:45] op_sel_hi:[1,0,1]
v_pk_fma_f32 v[46:47], v[38:39], s[100:101], v[46:47] op_sel_hi:[1,0,1]
s_lshl_b32 s100, s18, 16
v_pk_fma_f32 v[44:45], v[40:41], s[100:101], v[44:45] op_sel_hi:[1,0,1]
v_pk_fma_f32 v[46:47], v[42:43], s[100:101], v[46:47] op_sel_hi:[1,0,1]
v_pk_mul_f32 v[44:45], v[44:45], v[76:77]
v_pk_mul_f32 v[46:47], v[46:47], v[78:79]
s_and_b32 s100, s12, 0xffff0000
v_pk_mul_f32 v[48:49], v[28:29], s[100:101] op_sel_hi:[1,0]
v_pk_mul_f32 v[50:51], v[30:31], s[100:101] op_sel_hi:[1,0]
s_and_b32 s100, s14, 0xffff0000
v_pk_fma_f32 v[48:49], v[32:33], s[100:101], v[48:49] op_sel_hi:[1,0,1]
v_pk_fma_f32 v[50:51], v[34:35], s[100:101], v[50:51] op_sel_hi:[1,0,1]
s_and_b32 s100, s16, 0xffff0000
v_pk_fma_f32 v[48:49], v[36:37], s[100:101], v[48:49] op_sel_hi:[1,0,1]
v_pk_fma_f32 v[50:51], v[38:39], s[100:101], v[50:51] op_sel_hi:[1,0,1]
s_and_b32 s100, s18, 0xffff0000
v_pk_fma_f32 v[48:49], v[40:41], s[100:101], v[48:49] op_sel_hi:[1,0,1]
v_pk_fma_f32 v[50:51], v[42:43], s[100:101], v[50:51] op_sel_hi:[1,0,1]
v_pk_mul_f32 v[48:49], v[48:49], v[80:81]
v_pk_mul_f32 v[50:51], v[50:51], v[82:83]
s_lshl_b32 s100, s13, 16
v_pk_mul_f32 v[52:53], v[28:29], s[100:101] op_sel_hi:[1,0]
v_pk_mul_f32 v[54:55], v[30:31], s[100:101] op_sel_hi:[1,0]
s_lshl_b32 s100, s15, 16
v_pk_fma_f32 v[52:53], v[32:33], s[100:101], v[52:53] op_sel_hi:[1,0,1]
v_pk_fma_f32 v[54:55], v[34:35], s[100:101], v[54:55] op_sel_hi:[1,0,1]
s_lshl_b32 s100, s17, 16
v_pk_fma_f32 v[52:53], v[36:37], s[100:101], v[52:53] op_sel_hi:[1,0,1]
v_pk_fma_f32 v[54:55], v[38:39], s[100:101], v[54:55] op_sel_hi:[1,0,1]
s_lshl_b32 s100, s19, 16
v_pk_fma_f32 v[52:53], v[40:41], s[100:101], v[52:53] op_sel_hi:[1,0,1]
v_pk_fma_f32 v[54:55], v[42:43], s[100:101], v[54:55] op_sel_hi:[1,0,1]
v_pk_mul_f32 v[52:53], v[52:53], v[84:85]
v_pk_mul_f32 v[54:55], v[54:55], v[86:87]
s_and_b32 s100, s13, 0xffff0000
v_pk_mul_f32 v[56:57], v[28:29], s[100:101] op_sel_hi:[1,0]
v_pk_mul_f32 v[58:59], v[30:31], s[100:101] op_sel_hi:[1,0]
s_and_b32 s100, s15, 0xffff0000
v_pk_fma_f32 v[56:57], v[32:33], s[100:101], v[56:57] op_sel_hi:[1,0,1]
v_pk_fma_f32 v[58:59], v[34:35], s[100:101], v[58:59] op_sel_hi:[1,0,1]
s_and_b32 s100, s17, 0xffff0000
v_pk_fma_f32 v[56:57], v[36:37], s[100:101], v[56:57] op_sel_hi:[1,0,1]
v_pk_fma_f32 v[58:59], v[38:39], s[100:101], v[58:59] op_sel_hi:[1,0,1]
s_and_b32 s100, s19, 0xffff0000
v_pk_fma_f32 v[56:57], v[40:41], s[100:101], v[56:57] op_sel_hi:[1,0,1]
v_pk_fma_f32 v[58:59], v[42:43], s[100:101], v[58:59] op_sel_hi:[1,0,1]
v_pk_mul_f32 v[56:57], v[56:57], v[88:89]
v_pk_mul_f32 v[58:59], v[58:59], v[90:91]
s_lshl_b32 s100, s24, 16
v_pk_mul_f32 v[60:61], v[44:45], s[100:101] op_sel_hi:[1,0]
v_pk_mul_f32 v[62:63], v[46:47], s[100:101] op_sel_hi:[1,0]
s_lshl_b32 s100, s26, 16
v_pk_fma_f32 v[60:61], v[48:49], s[100:101], v[60:61] op_sel_hi:[1,0,1]
v_pk_fma_f32 v[62:63], v[50:51], s[100:101], v[62:63] op_sel_hi:[1,0,1]
s_lshl_b32 s100, s28, 16
v_pk_fma_f32 v[60:61], v[52:53], s[100:101], v[60:61] op_sel_hi:[1,0,1]
v_pk_fma_f32 v[62:63], v[54:55], s[100:101], v[62:63] op_sel_hi:[1,0,1]
s_lshl_b32 s100, s30, 16
v_pk_fma_f32 v[60:61], v[56:57], s[100:101], v[60:61] op_sel_hi:[1,0,1]
v_pk_fma_f32 v[62:63], v[58:59], s[100:101], v[62:63] op_sel_hi:[1,0,1]
s_and_b32 s100, s24, 0xffff0000
v_pk_mul_f32 v[64:65], v[44:45], s[100:101] op_sel_hi:[1,0]
v_pk_mul_f32 v[66:67], v[46:47], s[100:101] op_sel_hi:[1,0]
s_and_b32 s100, s26, 0xffff0000
v_pk_fma_f32 v[64:65], v[48:49], s[100:101], v[64:65] op_sel_hi:[1,0,1]
v_pk_fma_f32 v[66:67], v[50:51], s[100:101], v[66:67] op_sel_hi:[1,0,1]
s_and_b32 s100, s28, 0xffff0000
v_pk_fma_f32 v[64:65], v[52:53], s[100:101], v[64:65] op_sel_hi:[1,0,1]
v_pk_fma_f32 v[66:67], v[54:55], s[100:101], v[66:67] op_sel_hi:[1,0,1]
s_and_b32 s100, s30, 0xffff0000
v_pk_fma_f32 v[64:65], v[56:57], s[100:101], v[64:65] op_sel_hi:[1,0,1]
v_pk_fma_f32 v[66:67], v[58:59], s[100:101], v[66:67] op_sel_hi:[1,0,1]
s_lshl_b32 s100, s25, 16
v_pk_mul_f32 v[68:69], v[44:45], s[100:101] op_sel_hi:[1,0]
v_pk_mul_f32 v[70:71], v[46:47], s[100:101] op_sel_hi:[1,0]
s_lshl_b32 s100, s27, 16
v_pk_fma_f32 v[68:69], v[48:49], s[100:101], v[68:69] op_sel_hi:[1,0,1]
v_pk_fma_f32 v[70:71], v[50:51], s[100:101], v[70:71] op_sel_hi:[1,0,1]
s_lshl_b32 s100, s29, 16
v_pk_fma_f32 v[68:69], v[52:53], s[100:101], v[68:69] op_sel_hi:[1,0,1]
v_pk_fma_f32 v[70:71], v[54:55], s[100:101], v[70:71] op_sel_hi:[1,0,1]
s_lshl_b32 s100, s31, 16
v_pk_fma_f32 v[68:69], v[56:57], s[100:101], v[68:69] op_sel_hi:[1,0,1]
v_pk_fma_f32 v[70:71], v[58:59], s[100:101], v[70:71] op_sel_hi:[1,0,1]
s_and_b32 s100, s25, 0xffff0000
v_pk_mul_f32 v[72:73], v[44:45], s[100:101] op_sel_hi:[1,0]
v_pk_mul_f32 v[74:75], v[46:47], s[100:101] op_sel_hi:[1,0]
s_and_b32 s100, s27, 0xffff0000
v_pk_fma_f32 v[72:73], v[48:49], s[100:101], v[72:73] op_sel_hi:[1,0,1]
v_pk_fma_f32 v[74:75], v[50:51], s[100:101], v[74:75] op_sel_hi:[1,0,1]
s_and_b32 s100, s29, 0xffff0000
v_pk_fma_f32 v[72:73], v[52:53], s[100:101], v[72:73] op_sel_hi:[1,0,1]
v_pk_fma_f32 v[74:75], v[54:55], s[100:101], v[74:75] op_sel_hi:[1,0,1]
s_and_b32 s100, s31, 0xffff0000
v_pk_fma_f32 v[72:73], v[56:57], s[100:101], v[72:73] op_sel_hi:[1,0,1]
v_pk_fma_f32 v[74:75], v[58:59], s[100:101], v[74:75] op_sel_hi:[1,0,1]
v_lshlrev_b32 v28, 16, v16
v_and_b32 v32, 0xffff0000, v16
v_lshlrev_b32 v36, 16, v17
v_and_b32 v40, 0xffff0000, v17
v_lshlrev_b32 v29, 16, v18
v_and_b32 v33, 0xffff0000, v18
v_lshlrev_b32 v37, 16, v19
v_and_b32 v41, 0xffff0000, v19
v_lshlrev_b32 v30, 16, v20
v_and_b32 v34, 0xffff0000, v20
v_lshlrev_b32 v38, 16, v21
v_and_b32 v42, 0xffff0000, v21
v_lshlrev_b32 v31, 16, v22
v_and_b32 v35, 0xffff0000, v22
v_lshlrev_b32 v39, 16, v23
v_and_b32 v43, 0xffff0000, v23
v_pk_fma_f32 v[28:29], v[60:61], v[92:93], v[28:29]
v_pk_fma_f32 v[30:31], v[62:63], v[94:95], v[30:31]
v_pk_fma_f32 v[32:33], v[64:65], v[96:97], v[32:33]
v_pk_fma_f32 v[34:35], v[66:67], v[98:99], v[34:35]
v_pk_fma_f32 v[36:37], v[68:69], v[100:101], v[36:37]
v_pk_fma_f32 v[38:39], v[70:71], v[102:103], v[38:39]
v_pk_fma_f32 v[40:41], v[72:73], v[104:105], v[40:41]
v_pk_fma_f32 v[42:43], v[74:75], v[106:107], v[42:43]
v_cvt_pk_bf16_f32 v76, v28, v32
v_cvt_pk_bf16_f32 v77, v36, v40
v_cvt_pk_bf16_f32 v78, v29, v33
v_cvt_pk_bf16_f32 v79, v37, v41
v_cvt_pk_bf16_f32 v80, v30, v34
v_cvt_pk_bf16_f32 v81, v38, v42
v_cvt_pk_bf16_f32 v82, v31, v35
v_cvt_pk_bf16_f32 v83, v39, v43
v_lshrrev_b32 v108, 2, v0
v_lshlrev_b32 v108, 12, v108
v_and_b32 v109, 3, v0
v_lshlrev_b32 v109, 2, v109
v_or3_b32 v108, v108, v109, s3
v_lshlrev_b32 v108, 3, v108
buffer_store_dwordx4 v[76:79], v108, s[32:35], 0 offen
buffer_store_dwordx4 v[80:83], v108, s[32:35], 0 offen offset:16
k3_fin_skip:
s_mov_b64 exec, -1
s_waitcnt lgkmcnt(0)
s_barrier
s_cmp_lg_u32 s65, 0
s_cbranch_scc1 k3_exit
v_mov_b32 v28, 100352
ds_read_b32 v29, v28
s_waitcnt lgkmcnt(0)
v_readfirstlane_b32 s64, v29
s_nop 1
s_cmp_lg_u32 s64, 0
s_cbranch_scc1 k3_fallback
k3_exit:
k3_end:
s_endpgm
.section .rodata,"a"
.p2align 6
.amdhsa_kernel part_kernel
  .amdhsa_next_free_vgpr 128
  .amdhsa_next_free_sgpr 96
  .amdhsa_accum_offset 128
  .amdhsa_group_segment_fixed_size 0
  .amdhsa_kernarg_size 112
  .amdhsa_user_sgpr_count 2
  .amdhsa_user_sgpr_kernarg_segment_ptr 1
  .amdhsa_system_sgpr_workgroup_id_x 1
  .amdhsa_float_denorm_mode_32 3
.end_amdhsa_kernel
.p2align 6
.amdhsa_kernel gath_kernel
  .amdhsa_next_free_vgpr 128
  .amdhsa_next_free_sgpr 100
  .amdhsa_accum_offset 128
  .amdhsa_group_segment_fixed_size 0
  .amdhsa_kernarg_size 112
  .amdhsa_user_sgpr_count 2
  .amdhsa_user_sgpr_kernarg_segment_ptr 1
  .amdhsa_system_sgpr_workgroup_id_x 1
  .amdhsa_float_denorm_mode_32 3
.end_amdhsa_kernel
.p2align 6
.amdhsa_kernel acc_kernel
  .amdhsa_next_free_vgpr 116
  .amdhsa_next_free_sgpr 102
  .amdhsa_accum_offset 116
  .amdhsa_group_segment_fixed_size 0
  .amdhsa_kernarg_size 112
  .amdhsa_user_sgpr_count 2
  .amdhsa_user_sgpr_kernarg_segment_ptr 1
  .amdhsa_system_sgpr_workgroup_id_x 1
  .amdhsa_float_denorm_mode_32 3
.end_amdhsa_kernel
```
